```python
import torch

def _softmax(x, axis=-1):
    return torch.softmax(x, dim=axis)
def _gelu(x):
    return torch.nn.functional.gelu(x, approximate="tanh")
def _silu(x):
    return torch.nn.functional.silu(x)
def _sigmoid(x):
    return torch.sigmoid(x)
def _layernorm(x, axis=-1, eps=1e-5):
    m = x.mean(dim=axis, keepdim=True)
    v = x.var(dim=axis, keepdim=True, unbiased=False)
    return (x - m) / torch.sqrt(v + eps)
def _scatter_add(tgt, idx, src, axis=0):
    return tgt.clone().index_add_(axis, idx, src)
def _segment_sum(src, seg, n):
    out = torch.zeros((n,) + src.shape[1:], dtype=src.dtype)
    return out.index_add_(0, seg, src)
def _pad(x, pw):
    flat = tuple(v for pair in reversed(pw) for v in pair)
    return torch.nn.functional.pad(x, flat)

kernel_name = 'interleave_layers__linear_attn_block__mixer_channel_mlp__prompt'

def setup_inputs():

    _w = (lambda a: (lambda t: t.to(torch.bfloat16) if t.is_floating_point() else t)(torch.as_tensor(a)))
    def _A_setup():
        B, S, D = 1, 2048, 576
        return {
            "x": _w((lambda *s: torch.randn(*s, dtype=torch.bfloat16) * 0.05)(B, S, D)),
            "wqkv": _w((lambda *s: torch.randn(*s, dtype=torch.bfloat16) * 0.1)(D, 3 * D)),
            "wo": _w((lambda *s: torch.randn(*s, dtype=torch.bfloat16) * 0.05)(D, D)),
        }
    _A_in = _A_setup()

    def _B_setup():
        B, S, D, F = 1, 2048, 576, 4608
        return {
            "x": _w((lambda *s: torch.randn(*s, dtype=torch.bfloat16) * 0.05)(B, S, D)),
            "w1": _w((lambda *s: torch.randn(*s, dtype=torch.bfloat16) * 3.2)(D, F) * (D ** -0.5)),
            "b1": _w((lambda *s: torch.randn(*s, dtype=torch.bfloat16) * 1.6)(F)),
            "w2": _w((lambda *s: torch.randn(*s, dtype=torch.bfloat16) * 1.6)(F, D) * (F ** -0.5)),
            "b2": _w((lambda *s: torch.randn(*s, dtype=torch.bfloat16) * 1.6)(D)),
        }
    _B_in = _B_setup()

    return {
        "A_x": _A_in["x"],
        "A_wqkv": _A_in["wqkv"],
        "A_wo": _A_in["wo"],
        "B_x": _B_in["x"],
        "B_w1": _B_in["w1"],
        "B_b1": _B_in["b1"],
        "B_w2": _B_in["w2"],
        "B_b2": _B_in["b2"],
    }

def reference(A_x, A_wqkv, A_wo, B_x, B_w1, B_b1, B_w2, B_b2):
    def _A_ref(x, wqkv, wo):
        B, S, D = x.shape
        H = 32; Dh = D // H
        qkv = (lambda x, *d: x.permute(*d))((x @ wqkv).reshape(B, S, 3, H, Dh), 2, 0, 3, 1, 4)
        q, k, v = qkv[0], qkv[1], qkv[2]
        phi = lambda t: torch.where(t > 0, t + 1, torch.exp(t)) + 1e-6
        pq, pk = phi(q), phi(k)
        kv = torch.einsum("bhsd,bhse->bhde", pk, v)
        z = torch.einsum("bhsd->bhd", pk)
        num = torch.einsum("bhqd,bhde->bhqe", pq, kv)
        den = torch.einsum("bhqd,bhd->bhq", pq, z)[..., None] + 1e-6
        o = num / den
        return (lambda x, *d: x.permute(*d))(o, 0, 2, 1, 3).reshape(B, S, D) @ wo

    def _B_ref(x, w1, b1, w2, b2):
        y = _layernorm(x, axis=-1)
        h = _gelu(torch.einsum("bsd,df->bsf", y, w1) + b1)
        return torch.einsum("bsf,fd->bsd", h, w2) + b2

    x = A_x
    x = x + _A_ref(_layernorm(x, axis=-1), A_wqkv, A_wo)
    x = x + _B_ref(_layernorm(x, axis=-1), B_w1, B_b1, B_w2, B_b2)
    x = x + _A_ref(_layernorm(x, axis=-1), A_wqkv, A_wo)
    x = x + _B_ref(_layernorm(x, axis=-1), B_w1, B_b1, B_w2, B_b2)
    return x
```

```asm
; @launch grid=(256,1,1) block=(256,1,1) lds=163840
.amdgcn_target "amdgcn-amd-amdhsa--gfx950"
.text
.text
.globl interleave_layers__linear_attn_block__mixer_channel_mlp__prompt_kernel
.p2align 8
.type interleave_layers__linear_attn_block__mixer_channel_mlp__prompt_kernel,@function
interleave_layers__linear_attn_block__mixer_channel_mlp__prompt_kernel:
  s_cmp_lt_u32 s2, 256
  s_cbranch_scc1 L_m_go
  s_endpgm
L_m_go:
  s_load_dwordx2 s[4:5], s[0:1], 80
  s_load_dwordx4 s[40:43], s[0:1], 56
  s_load_dwordx8 s[44:51], s[0:1], 0
  s_load_dwordx4 s[52:55], s[0:1], 32
  s_load_dwordx2 s[56:57], s[0:1], 48
  s_load_dwordx2 s[6:7], s[0:1], 72
  v_lshrrev_b32 v1, 6, v0
  v_and_b32 v2, 63, v0
  v_readfirstlane_b32 s16, v1
  v_lshlrev_b32 v3, 4, v2
  s_mov_b32 s63, 0
  s_mov_b32 s10, 268435456
  s_mov_b32 s11, 0x20000
  s_cmp_eq_u32 s16, 3
  s_cbranch_scc0 L_cp_e
  s_getpc_b64 s[86:87]
L_cp0:
  s_lshr_b32 s60, s2, 3
  v_min_u32 v26, 15, v2
  v_lshlrev_b32 v26, 5, v26
  v_add_u32 v26, s60, v26
  v_lshlrev_b32 v26, 7, v26
  s_mov_b32 s60, L_kend-L_cp0-4
  v_min_u32 v26, s60, v26
  global_load_dword v25, v26, s[86:87]
L_cp_e:
  v_lshlrev_b32 v20, 2, v2
  v_mov_b32 v21, -1
  v_mov_b32 v22, 0
  v_add_u32 v20, 81920, v20
  ds_write_b32 v20, v21
  ds_write_b32 v20, v22 offset:256
  v_mov_b32 v7, 0
  v_mov_b32 v13, 0
  v_mov_b32 v249, 0
  s_mov_b32 s3, 0
  s_cmp_eq_u32 s16, 3
  s_cbranch_scc1 L_pl
L_pc:
  v_and_b32 v12, 7, v2
  v_lshrrev_b32 v13, 3, v2
  v_mul_u32_u24 v4, 1152, v12
  v_lshl_add_u32 v4, v13, 4, v4
  s_mul_i32 s59, s2, 9216
  s_mul_i32 s60, s16, 384
  s_add_u32 s59, s59, s60
  s_lshr_b32 s17, s2, 3
  s_and_b32 s18, s2, 7
  s_mul_i32 s33, s18, 3
  s_add_u32 s33, s33, s16
  s_mul_i32 s18, s33, 3
  s_mul_i32 s33, s33, 82944
  s_mul_i32 s60, s17, 36
  s_add_u32 s33, s33, s60
  s_mul_i32 s19, s16, 5120
  v_and_b32 v20, 3, v2
  v_lshrrev_b32 v21, 2, v2
  v_lshrrev_b32 v22, 5, v2
  v_mul_u32_u24 v6, 3456, v21
  v_lshl_add_u32 v6, v20, 4, v6
  v_mul_u32_u24 v7, 26496, v22
  v_sub_u32 v7, v6, v7
  v_mov_b32 v23, 0x40000000
  v_cmp_eq_u32 vcc, 3, v20
  s_nop 1
  v_cndmask_b32 v6, v6, v23, vcc
  v_cndmask_b32 v7, v7, v23, vcc
  s_waitcnt lgkmcnt(0)
  s_mov_b32 s8, s4
  s_mov_b32 s9, s5
  s_mov_b32 s12, s44
  s_mov_b32 s13, s45
  s_mov_b32 s14, 2359296
  s_mov_b32 s15, 0x20000
  s_mov_b32 s20, s46
  s_mov_b32 s21, s47
  s_mov_b32 s22, 1990656
  s_mov_b32 s23, 0x20000
  buffer_load_dwordx4 v[32:35], v4, s[12:15], s59 offen offset:0
  buffer_load_dwordx4 v[36:39], v4, s[12:15], s59 offen offset:128
  buffer_load_dwordx4 v[40:43], v4, s[12:15], s59 offen offset:256
  s_mov_b32 m0, s19
  s_nop 0
  buffer_load_dwordx4 v6, s[20:23], s33 offen offset:0  lds
  s_add_u32 s33, s33, 128
  buffer_load_dwordx4 v6, s[20:23], s33 offen offset:1024  lds
  s_add_u32 s33, s33, 128
  buffer_load_dwordx4 v6, s[20:23], s33 offen offset:2048  lds
  s_add_u32 s33, s33, 51968
  buffer_load_dwordx4 v7, s[20:23], s33 offen offset:3072  lds
  s_add_u32 m0, s19, 4096
  s_add_u32 s33, s33, 5376
  s_mov_b32 exec_hi, 0
  buffer_load_dwordx4 v7, s[20:23], s33 offen  lds
  s_mov_b64 exec, -1
  s_barrier
  s_mov_b32 s36, s6
  s_mov_b32 s37, s7
  s_mov_b32 s38, 256
  s_mov_b32 s39, 0x20000
  s_or_b32 s60, s2, s16
  s_cmp_eq_u32 s60, 0
  s_cbranch_scc0 L_pc_nt
  s_memrealtime s[60:61]
  v_lshlrev_b32 v23, 7, v2
  s_waitcnt lgkmcnt(0)
  s_or_b32 s60, s60, 1
  v_mov_b32 v24, s60
  s_mov_b64 exec, 1
  buffer_store_dword v24, v23, s[36:39], 0 offen sc1
  s_mov_b64 exec, -1
L_pc_nt:
  v_lshlrev_b32 v5, 9, v13
  v_lshl_add_u32 v5, v12, 4, v5
  s_lshr_b32 s58, s2, 2
  s_mul_i32 s58, s58, 36864
  s_and_b32 s59, s2, 3
  s_lshl_b32 s59, s59, 7
  s_add_u32 s58, s58, s59
  s_mul_i32 s59, s16, 12288
  s_add_u32 s24, s58, s59
  s_add_u32 s24, s24, 0
  s_add_u32 s25, s24, 4096
  s_add_u32 s26, s24, 8192
  s_mul_i32 s27, s17, 73728
  s_add_u32 s27, s27, 134217728
  s_add_u32 s60, s18, 0
  s_lshr_b32 s61, s60, 1
  s_lshl_b32 s61, s61, 11
  s_and_b32 s60, s60, 1
  s_lshl_b32 s60, s60, 9
  s_add_u32 s61, s61, s60
  s_add_u32 s28, s27, s61
  s_add_u32 s60, s18, 1
  s_lshr_b32 s61, s60, 1
  s_lshl_b32 s61, s61, 11
  s_and_b32 s60, s60, 1
  s_lshl_b32 s60, s60, 9
  s_add_u32 s61, s61, s60
  s_add_u32 s29, s27, s61
  s_add_u32 s60, s18, 2
  s_lshr_b32 s61, s60, 1
  s_lshl_b32 s61, s61, 11
  s_and_b32 s60, s60, 1
  s_lshl_b32 s60, s60, 9
  s_add_u32 s61, s61, s60
  s_add_u32 s30, s27, s61
  s_lshl_b32 s32, s2, 4
  s_add_u32 s32, s32, 159399936
  v_and_b32 v10, 31, v2
  v_lshlrev_b32 v10, 4, v10
  v_lshl_add_u32 v10, v22, 10, v10
  v_bfe_u32 v23, v2, 4, 1
  v_lshl_add_u32 v23, v23, 2, v20
  v_lshlrev_b32 v24, 3, v23
  v_add_u32 v8, 1024, v24
  v_subrev_u32 v25, 40, v24
  v_cmp_gt_u32 vcc, 5, v23
  s_nop 1
  v_cndmask_b32 v8, v25, v8, vcc
  v_mov_b32 v25, 32
  v_cmp_eq_u32 vcc, 7, v23
  s_nop 1
  v_cndmask_b32 v8, v8, v25, vcc
  v_add_u32 v9, 2048, v24
  v_subrev_u32 v25, 32, v24
  v_cmp_gt_u32 vcc, 6, v23
  s_nop 1
  v_cndmask_b32 v9, v25, v9, vcc
  v_cmp_lt_u32 vcc, 31, v2
  s_nop 1
  v_cndmask_b32 v8, v8, v9, vcc
  v_lshrrev_b32 v9, 10, v8
  v_lshlrev_b32 v9, 9, v9
  v_sub_u32 v9, v8, v9
  v_and_b32 v21, 3, v21
  v_lshlrev_b32 v21, 6, v21
  v_add_u32 v21, s19, v21
  v_add_u32 v8, v8, v21
  v_add_u32 v9, v9, v21
  v_bfe_u32 v14, v2, 5, 1
  v_lshl_add_u32 v14, v12, 1, v14
  v_lshlrev_b32 v14, 4, v14
  s_lshl_b32 s60, s16, 2
  s_add_u32 s60, s60, 81920
  v_add_u32 v14, s60, v14
  v_lshlrev_b32 v15, 5, v12
  v_add_u32 v15, 81920, v15
  v_and_b32 v16, 24, v2
  v_cmp_eq_u32 s[34:35], 0, v16
  v_mov_b32 v17, 0
  v_mov_b32 v18, 82176
  v_mov_b32 v19, 1
  s_mov_b32 s49, 0x40000
  s_waitcnt vmcnt(7)
  v_lshlrev_b32 v44, 16, v32
  v_and_b32 v45, 0xffff0000, v32
  v_lshlrev_b32 v46, 16, v33
  v_and_b32 v47, 0xffff0000, v33
  v_lshlrev_b32 v48, 16, v34
  v_and_b32 v49, 0xffff0000, v34
  v_lshlrev_b32 v50, 16, v35
  v_and_b32 v51, 0xffff0000, v35
  s_waitcnt vmcnt(6)
  v_lshlrev_b32 v52, 16, v36
  v_and_b32 v53, 0xffff0000, v36
  v_lshlrev_b32 v54, 16, v37
  v_and_b32 v55, 0xffff0000, v37
  v_lshlrev_b32 v56, 16, v38
  v_and_b32 v57, 0xffff0000, v38
  v_lshlrev_b32 v58, 16, v39
  v_and_b32 v59, 0xffff0000, v39
  s_waitcnt vmcnt(5)
  v_lshlrev_b32 v60, 16, v40
  v_and_b32 v61, 0xffff0000, v40
  v_lshlrev_b32 v62, 16, v41
  v_and_b32 v63, 0xffff0000, v41
  v_lshlrev_b32 v64, 16, v42
  v_and_b32 v65, 0xffff0000, v42
  v_lshlrev_b32 v66, 16, v43
  v_and_b32 v67, 0xffff0000, v43
  s_mov_b64 exec, 1
  ds_add_u32 v18, v19 offset:20
  s_mov_b64 exec, -1
  v_add_f32 v24, v44, v45
  v_add_f32 v26, v46, v47
  v_mul_f32 v25, v44, v44
  v_mul_f32 v27, v45, v45
  v_add_f32 v24, v24, v48
  v_add_f32 v26, v26, v49
  v_add_f32 v24, v24, v50
  v_add_f32 v26, v26, v51
  v_add_f32 v24, v24, v52
  v_add_f32 v26, v26, v53
  v_add_f32 v24, v24, v54
  v_add_f32 v26, v26, v55
  v_add_f32 v24, v24, v56
  v_add_f32 v26, v26, v57
  v_add_f32 v24, v24, v58
  v_add_f32 v26, v26, v59
  v_add_f32 v24, v24, v60
  v_add_f32 v26, v26, v61
  v_add_f32 v24, v24, v62
  v_add_f32 v26, v26, v63
  v_add_f32 v24, v24, v64
  v_add_f32 v26, v26, v65
  v_add_f32 v24, v24, v66
  v_add_f32 v26, v26, v67
  v_fmac_f32 v25, v46, v46
  v_fmac_f32 v27, v47, v47
  v_fmac_f32 v25, v48, v48
  v_fmac_f32 v27, v49, v49
  v_fmac_f32 v25, v50, v50
  v_fmac_f32 v27, v51, v51
  v_fmac_f32 v25, v52, v52
  v_fmac_f32 v27, v53, v53
  v_fmac_f32 v25, v54, v54
  v_fmac_f32 v27, v55, v55
  v_fmac_f32 v25, v56, v56
  v_fmac_f32 v27, v57, v57
  v_fmac_f32 v25, v58, v58
  v_fmac_f32 v27, v59, v59
  v_fmac_f32 v25, v60, v60
  v_fmac_f32 v27, v61, v61
  v_fmac_f32 v25, v62, v62
  v_fmac_f32 v27, v63, v63
  v_fmac_f32 v25, v64, v64
  v_fmac_f32 v27, v65, v65
  v_fmac_f32 v25, v66, v66
  v_fmac_f32 v27, v67, v67
  v_add_f32 v24, v24, v26
  v_add_f32 v25, v25, v27
  s_nop 1
  v_permlane32_swap_b32 v24, v25
  v_add_f32 v24, v24, v25
  v_mov_b32 v25, v24
  s_nop 1
  v_permlane16_swap_b32 v24, v25
  v_add_f32 v24, v24, v25
  s_nop 1
  v_add_f32 v24, v24, v24 row_ror:8
  s_mov_b64 exec, s[34:35]
  ds_write_b32 v14, v24
  s_mov_b64 exec, -1
L_pc_sw:
  ds_read_b128 v[20:23], v15
  ds_read_b128 v[28:31], v15 offset:16
  s_waitcnt lgkmcnt(0)
  v_max3_u32 v24, v20, v21, v22
  v_max3_u32 v25, v28, v29, v30
  v_max_u32 v24, v24, v25
  v_cmp_eq_u32 vcc, -1, v24
  s_sub_u32 s49, s49, 1
  s_cmp_eq_u32 s49, 0
  s_cbranch_scc1 L_pc_sk
  s_nop 2
  s_cbranch_vccnz L_pc_sw
L_pc_sk:
  v_add_f32 v20, v20, v21
  v_add_f32 v28, v28, v29
  v_add_f32 v20, v20, v22
  v_add_f32 v28, v28, v30
  v_mul_f32 v20, 0x3ae38e39, v20
  v_mul_f32 v28, 0x3ae38e39, v28
  v_fma_f32 v28, -v20, v20, v28
  v_max_f32 v28, 0, v28
  v_add_f32 v28, 0x3727c5ac, v28
  v_rsq_f32 v28, v28
  v_sub_f32 v44, v44, v20
  v_sub_f32 v45, v45, v20
  v_sub_f32 v46, v46, v20
  v_sub_f32 v47, v47, v20
  v_sub_f32 v48, v48, v20
  v_sub_f32 v49, v49, v20
  v_sub_f32 v50, v50, v20
  v_sub_f32 v51, v51, v20
  v_mul_f32 v44, v44, v28
  v_mul_f32 v45, v45, v28
  v_mul_f32 v46, v46, v28
  v_mul_f32 v47, v47, v28
  v_mul_f32 v48, v48, v28
  v_mul_f32 v49, v49, v28
  v_mul_f32 v50, v50, v28
  v_mul_f32 v51, v51, v28
  v_cvt_pk_bf16_f32 v68, v44, v45
  v_cvt_pk_bf16_f32 v69, v46, v47
  v_cvt_pk_bf16_f32 v70, v48, v49
  v_cvt_pk_bf16_f32 v71, v50, v51
  buffer_store_dwordx4 v[68:71], v5, s[8:11], s24 offen sc1
  v_sub_f32 v52, v52, v20
  v_sub_f32 v53, v53, v20
  v_sub_f32 v54, v54, v20
  v_sub_f32 v55, v55, v20
  v_sub_f32 v56, v56, v20
  v_sub_f32 v57, v57, v20
  v_sub_f32 v58, v58, v20
  v_sub_f32 v59, v59, v20
  v_mul_f32 v52, v52, v28
  v_mul_f32 v53, v53, v28
  v_mul_f32 v54, v54, v28
  v_mul_f32 v55, v55, v28
  v_mul_f32 v56, v56, v28
  v_mul_f32 v57, v57, v28
  v_mul_f32 v58, v58, v28
  v_mul_f32 v59, v59, v28
  v_cvt_pk_bf16_f32 v72, v52, v53
  v_cvt_pk_bf16_f32 v73, v54, v55
  v_cvt_pk_bf16_f32 v74, v56, v57
  v_cvt_pk_bf16_f32 v75, v58, v59
  buffer_store_dwordx4 v[72:75], v5, s[8:11], s25 offen sc1
  v_sub_f32 v60, v60, v20
  v_sub_f32 v61, v61, v20
  v_sub_f32 v62, v62, v20
  v_sub_f32 v63, v63, v20
  v_sub_f32 v64, v64, v20
  v_sub_f32 v65, v65, v20
  v_sub_f32 v66, v66, v20
  v_sub_f32 v67, v67, v20
  v_mul_f32 v60, v60, v28
  v_mul_f32 v61, v61, v28
  v_mul_f32 v62, v62, v28
  v_mul_f32 v63, v63, v28
  v_mul_f32 v64, v64, v28
  v_mul_f32 v65, v65, v28
  v_mul_f32 v66, v66, v28
  v_mul_f32 v67, v67, v28
  v_cvt_pk_bf16_f32 v76, v60, v61
  v_cvt_pk_bf16_f32 v77, v62, v63
  v_cvt_pk_bf16_f32 v78, v64, v65
  v_cvt_pk_bf16_f32 v79, v66, v67
  buffer_store_dwordx4 v[76:79], v5, s[8:11], s26 offen sc1
  s_waitcnt vmcnt(5)
  ds_read_b64_tr_b16 v[80:81], v8 offset:0
  ds_read_b64_tr_b16 v[82:83], v8 offset:256
  ds_read_b64_tr_b16 v[84:85], v8 offset:512
  ds_read_b64_tr_b16 v[86:87], v8 offset:768
  s_waitcnt vmcnt(3)
  ds_read_b64_tr_b16 v[88:89], v9 offset:3072
  ds_read_b64_tr_b16 v[90:91], v9 offset:3328
  s_mov_b64 exec, 1
  ds_add_u32 v18, v19 offset:20
  s_mov_b64 exec, -1
  s_waitcnt lgkmcnt(5)
  buffer_store_dwordx4 v[80:83], v10, s[8:11], s28 offen sc1
  s_waitcnt lgkmcnt(3)
  buffer_store_dwordx4 v[84:87], v10, s[8:11], s29 offen sc1
  s_waitcnt lgkmcnt(1)
  buffer_store_dwordx4 v[88:91], v10, s[8:11], s30 offen sc1
  buffer_load_dword v160, v17, s[36:39], 0 offen sc1
  s_mov_b32 s49, 0x40000
  s_waitcnt vmcnt(0)
L_pc_tg:
  v_readfirstlane_b32 s61, v160
  s_sub_u32 s49, s49, 1
  s_cmp_eq_u32 s49, 0
  s_cbranch_scc1 L_pc_tk
  s_cmp_eq_u32 s61, 0
  s_cbranch_scc0 L_pc_tk
  buffer_load_dword v160, v17, s[36:39], 0 offen sc1
  s_waitcnt vmcnt(0)
  s_branch L_pc_tg
L_pc_tk:
  s_mov_b64 exec, 1
  ds_add_rtn_u32 v20, v18, v19
  s_waitcnt lgkmcnt(0)
  v_readfirstlane_b32 s60, v20
  s_nop 0
  s_cmp_eq_u32 s60, 2
  s_cbranch_scc0 L_pc_ns
  buffer_store_dword v160, v17, s[8:11], s32 offen sc1
L_pc_ns:
  s_mov_b64 exec, -1
  s_branch L_a0
L_pl:
  s_lshl_b32 s58, s2, 10
  s_add_u32 s58, s58, 9699328
  s_add_u32 s59, s58, 33554432
  v_mov_b32 v28, 0
  v_mov_b32 v29, 0
  v_mov_b32 v30, 0
  v_mov_b32 v31, 0
  v_and_b32 v20, 3, v2
  v_bfe_u32 v21, v2, 2, 3
  v_lshrrev_b32 v22, 5, v2
  v_lshlrev_b32 v22, 6, v22
  v_lshl_add_u32 v22, v20, 4, v22
  v_mov_b32 v18, 82176
  s_waitcnt lgkmcnt(0)
  s_mov_b32 s8, s4
  s_mov_b32 s9, s5
  s_mov_b32 s12, s44
  s_mov_b32 s13, s45
  s_mov_b32 s14, 2359296
  s_mov_b32 s15, 0x20000
  s_mov_b32 s24, s48
  s_mov_b32 s25, s49
  s_mov_b32 s26, 663552
  s_mov_b32 s27, 0x20000
  s_mov_b32 s44, s54
  s_mov_b32 s45, s55
  s_mov_b32 s46, 9216
  s_mov_b32 s47, 0x20000
  s_mov_b32 s64, s52
  s_mov_b32 s65, s53
  s_mov_b32 s66, 5308416
  s_mov_b32 s67, 0x20000
  buffer_store_dwordx4 v[28:31], v3, s[8:11], s58 offen sc1
  buffer_store_dwordx4 v[28:31], v3, s[8:11], s59 offen sc1
  s_barrier
  s_cmp_lt_u32 s2, 241
  s_cbranch_scc0 L_plx
  s_mov_b32 s49, 0x400000
L_pl_g1:
  ds_read_b32 v27, v18 offset:20
  s_waitcnt lgkmcnt(0)
  v_readfirstlane_b32 s60, v27
  s_sub_u32 s49, s49, 1
  s_cmp_eq_u32 s49, 0
  s_cbranch_scc1 L_pl_g1e
  s_cmp_lt_u32 s60, 4
  s_cbranch_scc1 L_pl_g1
L_pl_g1e:
  s_cmp_lt_u32 s2, 160
  s_cbranch_scc0 L_plo
  s_and_b32 s58, s2, 7
  s_lshr_b32 s59, s2, 5
  s_bfe_u32 s100, s2, 0x20003
  s_cmp_lt_u32 s59, 4
  s_cselect_b32 s59, s59, 8
  s_cselect_b32 s62, 4, 0
  s_cmp_lt_u32 s58, 4
  s_cselect_b32 s62, s62, 0
  s_xor_b32 s62, s62, s59
  s_mul_i32 s61, s58, 9
  s_add_u32 s61, s61, s62
  s_lshl_b32 s61, s61, 7
  s_mul_i32 s68, s100, 1327104
  s_add_u32 s68, s68, s61
  v_mul_u32_u24 v170, 9216, v21
  v_add_u32 v170, v170, v22
  v_lshlrev_b32 v174, 1, v2
  s_mov_b32 m0, 90112
  s_nop 0
  buffer_load_dwordx4 v170, s[64:67], s68 offen offset:0 nt lds
  s_add_u32 s68, s68, 72704
  buffer_load_dwordx4 v170, s[64:67], s68 offen offset:1024 nt lds
  s_add_u32 s68, s68, 72704
  buffer_load_dwordx4 v170, s[64:67], s68 offen offset:2048 nt lds
  s_add_u32 s68, s68, 72704
  buffer_load_dwordx4 v170, s[64:67], s68 offen offset:3072 nt lds
  s_add_u32 s68, s68, 76800
  s_mov_b32 m0, 94208
  s_nop 0
  buffer_load_dwordx4 v170, s[64:67], s68 offen offset:0 nt lds
  s_add_u32 s68, s68, 72704
  buffer_load_dwordx4 v170, s[64:67], s68 offen offset:1024 nt lds
  s_add_u32 s68, s68, 72704
  buffer_load_dwordx4 v170, s[64:67], s68 offen offset:2048 nt lds
  s_add_u32 s68, s68, 72704
  buffer_load_dwordx4 v170, s[64:67], s68 offen offset:3072 nt lds
  s_add_u32 s68, s68, 76800
  s_mov_b32 m0, 98304
  s_nop 0
  buffer_load_dwordx4 v170, s[64:67], s68 offen offset:0 nt lds
  s_add_u32 s68, s68, 72704
  buffer_load_dwordx4 v170, s[64:67], s68 offen offset:1024 nt lds
  s_add_u32 s68, s68, 72704
  buffer_load_dwordx4 v170, s[64:67], s68 offen offset:2048 nt lds
  s_add_u32 s68, s68, 72704
  buffer_load_dwordx4 v170, s[64:67], s68 offen offset:3072 nt lds
  s_add_u32 s68, s68, 76800
  s_mov_b32 m0, 102400
  s_nop 0
  buffer_load_dwordx4 v170, s[64:67], s68 offen offset:0 nt lds
  s_add_u32 s68, s68, 72704
  buffer_load_dwordx4 v170, s[64:67], s68 offen offset:1024 nt lds
  s_add_u32 s68, s68, 72704
  buffer_load_dwordx4 v170, s[64:67], s68 offen offset:2048 nt lds
  s_add_u32 s68, s68, 72704
  buffer_load_dwordx4 v170, s[64:67], s68 offen offset:3072 nt lds
  s_add_u32 s68, s68, 76800
  s_mov_b32 m0, 106496
  s_nop 0
  buffer_load_dwordx4 v170, s[64:67], s68 offen offset:0 nt lds
  s_add_u32 s68, s68, 72704
  buffer_load_dwordx4 v170, s[64:67], s68 offen offset:1024 nt lds
  buffer_load_ushort v174, v174, s[44:47], s61 offen
  s_mul_i32 s101, s100, 9
  s_lshr_b32 s62, s59, 1
  s_and_b32 s87, s59, 1
  s_lshl_b32 s87, s87, 1
  s_lshl_b32 s88, s58, 2
  s_add_u32 s87, s87, s88
  s_mul_i32 s87, s87, 336896
  s_add_u32 s87, s87, 140509184
  s_add_u32 s88, s62, 91
  s_add_u32 s89, s62, 90
  s_add_u32 s96, s62, 163
  s_cmp_lt_u32 s59, 4
  s_cselect_b32 s60, 5, 4
  s_cselect_b32 s61, 3, 2
  s_cselect_b32 s62, s62, s88
  s_cselect_b32 s96, s89, s96
  s_lshl_b32 s61, s61, 10
  s_sub_u32 s99, 0, s61
  s_cmp_eq_u32 s59, 8
  s_cselect_b32 s60, 5, s60
  s_cselect_b32 s86, 0, s61
  s_cselect_b32 s61, 336896, s61
  s_cselect_b32 s99, s61, s99
  s_cselect_b32 s62, 2, s62
  s_cselect_b32 s96, 92, s96
  s_cselect_b32 s97, 336896, 0
  s_add_u32 s98, s97, 336896
  v_lshrrev_b32 v20, 5, v2
  v_mul_u32_u24 v20, s98, v20
  v_and_b32 v177, 31, v2
  v_lshl_add_u32 v177, v177, 4, v20
  s_add_u32 s86, s86, s98
  s_lshl_b32 s60, s60, 10
  s_lshl_b32 s96, s96, 10
  s_add_u32 s96, s96, s87
  s_lshr_b32 s88, s100, 1
  s_lshl_b32 s88, s88, 9
  s_add_u32 s96, s96, s88
  s_and_b32 s88, s100, 1
  s_lshl_b32 s88, s88, 3
  s_add_u32 s96, s96, s88
  s_add_u32 s97, s97, s96
  s_lshl_b32 s62, s62, 10
  s_add_u32 s87, s87, s62
  s_lshr_b32 s62, s101, 1
  s_mul_i32 s62, s62, s60
  s_add_u32 s87, s87, s62
  s_add_u32 s86, s86, s87
  s_and_b32 s101, s101, 1
  s_mul_i32 s62, s101, s61
  s_add_u32 s87, s87, s62
  s_mul_i32 s62, s101, s99
  s_add_u32 s86, s86, s62
  s_sub_u32 s62, s60, s61
  s_sub_u32 s60, s60, s99
  s_cmp_eq_u32 s101, 0
  s_cselect_b32 s88, s61, s62
  s_cselect_b32 s89, s62, s61
  s_cselect_b32 s90, s99, s60
  s_cselect_b32 s91, s60, s99
  s_cmp_lt_u32 s100, 2
  s_cselect_b32 s93, 0xffff, 0
  v_and_b32 v20, 3, v2
  v_bfe_u32 v21, v2, 4, 1
  v_lshl_add_u32 v21, v21, 2, v20
  v_bfe_u32 v22, v2, 2, 2
  v_lshlrev_b32 v22, 6, v22
  v_lshrrev_b32 v20, 5, v2
  v_lshl_add_u32 v22, v20, 10, v22
  v_lshl_add_u32 v171, v21, 3, v22
  v_add_u32 v171, 90112, v171
  v_mov_b32 v175, 0
  v_mov_b32 v176, 0
  v_mov_b32 v179, 0x3f803f80
  s_mov_b32 s49, 0x400000
L_pl_g3:
  ds_read_b32 v27, v18 offset:0
  s_waitcnt lgkmcnt(0)
  v_readfirstlane_b32 s60, v27
  s_sub_u32 s49, s49, 1
  s_cmp_eq_u32 s49, 0
  s_cbranch_scc1 L_pl_g3e
  s_cmp_lt_u32 s60, 3
  s_cbranch_scc1 L_pl_g3
L_pl_g3e:
  s_waitcnt vmcnt(17)
  ds_read_b64_tr_b16 v[184:185], v171 offset:0
  ds_read_b64_tr_b16 v[186:187], v171 offset:256
  ds_read_b64_tr_b16 v[188:189], v171 offset:512
  ds_read_b64_tr_b16 v[190:191], v171 offset:768
  s_waitcnt vmcnt(15)
  ds_read_b64_tr_b16 v[192:193], v171 offset:2048
  ds_read_b64_tr_b16 v[194:195], v171 offset:2304
  ds_read_b64_tr_b16 v[196:197], v171 offset:2560
  ds_read_b64_tr_b16 v[198:199], v171 offset:2816
  s_waitcnt vmcnt(13)
  ds_read_b64_tr_b16 v[200:201], v171 offset:4096
  ds_read_b64_tr_b16 v[202:203], v171 offset:4352
  ds_read_b64_tr_b16 v[204:205], v171 offset:4608
  ds_read_b64_tr_b16 v[206:207], v171 offset:4864
  s_waitcnt lgkmcnt(10)
  buffer_store_dwordx4 v[184:187], v3, s[8:11], s87 offen sc1
  s_add_u32 s87, s87, s88
  v_dot2c_f32_bf16 v175, v179, v184
  v_dot2c_f32_bf16 v175, v179, v185
  v_dot2c_f32_bf16 v175, v179, v186
  v_dot2c_f32_bf16 v175, v179, v187
  s_waitcnt vmcnt(12)
  ds_read_b64_tr_b16 v[208:209], v171 offset:6144
  ds_read_b64_tr_b16 v[210:211], v171 offset:6400
  s_waitcnt lgkmcnt(10)
  buffer_store_dwordx4 v[188:191], v3, s[8:11], s86 offen sc1
  s_add_u32 s86, s86, s90
  v_dot2c_f32_bf16 v176, v179, v188
  v_dot2c_f32_bf16 v176, v179, v189
  v_dot2c_f32_bf16 v176, v179, v190
  v_dot2c_f32_bf16 v176, v179, v191
  ds_read_b64_tr_b16 v[212:213], v171 offset:6656
  ds_read_b64_tr_b16 v[214:215], v171 offset:6912
  s_waitcnt lgkmcnt(10)
  buffer_store_dwordx4 v[192:195], v3, s[8:11], s87 offen sc1
  s_add_u32 s87, s87, s89
  v_dot2c_f32_bf16 v175, v179, v192
  v_dot2c_f32_bf16 v175, v179, v193
  v_dot2c_f32_bf16 v175, v179, v194
  v_dot2c_f32_bf16 v175, v179, v195
  s_waitcnt vmcnt(12)
  ds_read_b64_tr_b16 v[216:217], v171 offset:8192
  ds_read_b64_tr_b16 v[218:219], v171 offset:8448
  s_waitcnt lgkmcnt(10)
  buffer_store_dwordx4 v[196:199], v3, s[8:11], s86 offen sc1
  s_add_u32 s86, s86, s91
  v_dot2c_f32_bf16 v176, v179, v196
  v_dot2c_f32_bf16 v176, v179, v197
  v_dot2c_f32_bf16 v176, v179, v198
  v_dot2c_f32_bf16 v176, v179, v199
  ds_read_b64_tr_b16 v[220:221], v171 offset:8704
  ds_read_b64_tr_b16 v[222:223], v171 offset:8960
  s_waitcnt lgkmcnt(10)
  buffer_store_dwordx4 v[200:203], v3, s[8:11], s87 offen sc1
  s_add_u32 s87, s87, s88
  v_dot2c_f32_bf16 v175, v179, v200
  v_dot2c_f32_bf16 v175, v179, v201
  v_dot2c_f32_bf16 v175, v179, v202
  v_dot2c_f32_bf16 v175, v179, v203
  s_waitcnt vmcnt(12)
  ds_read_b64_tr_b16 v[224:225], v171 offset:10240
  ds_read_b64_tr_b16 v[226:227], v171 offset:10496
  s_waitcnt lgkmcnt(10)
  buffer_store_dwordx4 v[204:207], v3, s[8:11], s86 offen sc1
  s_add_u32 s86, s86, s90
  v_dot2c_f32_bf16 v176, v179, v204
  v_dot2c_f32_bf16 v176, v179, v205
  v_dot2c_f32_bf16 v176, v179, v206
  v_dot2c_f32_bf16 v176, v179, v207
  ds_read_b64_tr_b16 v[228:229], v171 offset:10752
  ds_read_b64_tr_b16 v[230:231], v171 offset:11008
  s_waitcnt lgkmcnt(10)
  buffer_store_dwordx4 v[208:211], v3, s[8:11], s87 offen sc1
  s_add_u32 s87, s87, s89
  v_dot2c_f32_bf16 v175, v179, v208
  v_dot2c_f32_bf16 v175, v179, v209
  v_dot2c_f32_bf16 v175, v179, v210
  v_dot2c_f32_bf16 v175, v179, v211
  s_waitcnt vmcnt(12)
  ds_read_b64_tr_b16 v[184:185], v171 offset:12288
  ds_read_b64_tr_b16 v[186:187], v171 offset:12544
  s_waitcnt lgkmcnt(10)
  buffer_store_dwordx4 v[212:215], v3, s[8:11], s86 offen sc1
  s_add_u32 s86, s86, s91
  v_dot2c_f32_bf16 v176, v179, v212
  v_dot2c_f32_bf16 v176, v179, v213
  v_dot2c_f32_bf16 v176, v179, v214
  v_dot2c_f32_bf16 v176, v179, v215
  ds_read_b64_tr_b16 v[188:189], v171 offset:12800
  ds_read_b64_tr_b16 v[190:191], v171 offset:13056
  s_waitcnt lgkmcnt(10)
  buffer_store_dwordx4 v[216:219], v3, s[8:11], s87 offen sc1
  s_add_u32 s87, s87, s88
  v_dot2c_f32_bf16 v175, v179, v216
  v_dot2c_f32_bf16 v175, v179, v217
  v_dot2c_f32_bf16 v175, v179, v218
  v_dot2c_f32_bf16 v175, v179, v219
  s_waitcnt vmcnt(12)
  ds_read_b64_tr_b16 v[192:193], v171 offset:14336
  ds_read_b64_tr_b16 v[194:195], v171 offset:14592
  s_waitcnt lgkmcnt(10)
  buffer_store_dwordx4 v[220:223], v3, s[8:11], s86 offen sc1
  s_add_u32 s86, s86, s90
  v_dot2c_f32_bf16 v176, v179, v220
  v_dot2c_f32_bf16 v176, v179, v221
  v_dot2c_f32_bf16 v176, v179, v222
  v_dot2c_f32_bf16 v176, v179, v223
  ds_read_b64_tr_b16 v[196:197], v171 offset:14848
  ds_read_b64_tr_b16 v[198:199], v171 offset:15104
  s_waitcnt lgkmcnt(10)
  buffer_store_dwordx4 v[224:227], v3, s[8:11], s87 offen sc1
  s_add_u32 s87, s87, s89
  v_dot2c_f32_bf16 v175, v179, v224
  v_dot2c_f32_bf16 v175, v179, v225
  v_dot2c_f32_bf16 v175, v179, v226
  v_dot2c_f32_bf16 v175, v179, v227
  s_waitcnt vmcnt(12)
  ds_read_b64_tr_b16 v[200:201], v171 offset:16384
  ds_read_b64_tr_b16 v[202:203], v171 offset:16640
  s_waitcnt lgkmcnt(10)
  buffer_store_dwordx4 v[228:231], v3, s[8:11], s86 offen sc1
  s_add_u32 s86, s86, s91
  v_dot2c_f32_bf16 v176, v179, v228
  v_dot2c_f32_bf16 v176, v179, v229
  v_dot2c_f32_bf16 v176, v179, v230
  v_dot2c_f32_bf16 v176, v179, v231
  ds_read_b64_tr_b16 v[204:205], v171 offset:16896
  ds_read_b64_tr_b16 v[206:207], v171 offset:17152
  s_waitcnt lgkmcnt(10)
  buffer_store_dwordx4 v[184:187], v3, s[8:11], s87 offen sc1
  s_add_u32 s87, s87, s88
  v_dot2c_f32_bf16 v175, v179, v184
  v_dot2c_f32_bf16 v175, v179, v185
  v_dot2c_f32_bf16 v175, v179, v186
  v_dot2c_f32_bf16 v175, v179, v187
  s_waitcnt lgkmcnt(8)
  buffer_store_dwordx4 v[188:191], v3, s[8:11], s86 offen sc1
  s_add_u32 s86, s86, s90
  v_dot2c_f32_bf16 v176, v179, v188
  v_dot2c_f32_bf16 v176, v179, v189
  v_dot2c_f32_bf16 v176, v179, v190
  v_dot2c_f32_bf16 v176, v179, v191
  s_waitcnt lgkmcnt(6)
  buffer_store_dwordx4 v[192:195], v3, s[8:11], s87 offen sc1
  s_add_u32 s87, s87, s89
  v_dot2c_f32_bf16 v175, v179, v192
  v_dot2c_f32_bf16 v175, v179, v193
  v_dot2c_f32_bf16 v175, v179, v194
  v_dot2c_f32_bf16 v175, v179, v195
  s_waitcnt lgkmcnt(4)
  buffer_store_dwordx4 v[196:199], v3, s[8:11], s86 offen sc1
  s_add_u32 s86, s86, s91
  v_dot2c_f32_bf16 v176, v179, v196
  v_dot2c_f32_bf16 v176, v179, v197
  v_dot2c_f32_bf16 v176, v179, v198
  v_dot2c_f32_bf16 v176, v179, v199
  s_waitcnt lgkmcnt(2)
  buffer_store_dwordx4 v[200:203], v3, s[8:11], s87 offen sc1
  v_dot2c_f32_bf16 v175, v179, v200
  v_dot2c_f32_bf16 v175, v179, v201
  v_dot2c_f32_bf16 v175, v179, v202
  v_dot2c_f32_bf16 v175, v179, v203
  s_waitcnt lgkmcnt(0)
  buffer_store_dwordx4 v[204:207], v3, s[8:11], s86 offen sc1
  v_dot2c_f32_bf16 v176, v179, v204
  v_dot2c_f32_bf16 v176, v179, v205
  v_dot2c_f32_bf16 v176, v179, v206
  v_dot2c_f32_bf16 v176, v179, v207
  s_nop 2
  v_permlane32_swap_b32 v175, v176
  v_add_f32 v175, v175, v176
  v_cvt_pk_bf16_f32 v20, v175, v175
  v_and_b32 v176, 0xffff0000, v20
  v_sub_f32 v176, v175, v176
  v_cvt_pk_bf16_f32 v21, v176, 0
  s_waitcnt vmcnt(18)
  v_and_b32 v174, s93, v174
  v_lshl_or_b32 v21, v174, 16, v21
  buffer_store_dwordx2 v[20:21], v177, s[8:11], s96 offen sc1
  s_cmp_eq_u32 s96, s97
  s_cbranch_scc1 L_a0
  buffer_store_dwordx2 v[20:21], v177, s[8:11], s97 offen sc1
  s_branch L_a0
L_plo:
  s_mul_i32 s62, s2, 4
  s_sub_u32 s62, s62, 640
  s_mul_i32 s60, s62, 1821
  s_lshr_b32 s60, s60, 16
  s_mul_i32 s61, s60, 36
  s_sub_u32 s61, s62, s61
  s_mul_i32 s28, s61, 7282
  s_lshr_b32 s28, s28, 16
  s_mul_i32 s69, s28, 9
  s_sub_u32 s69, s61, s69
  s_mul_i32 s68, s28, 144
  s_mul_i32 s89, s69, 18
  s_cmp_lt_u32 s69, 8
  s_cselect_b32 s89, s89, 16
  s_cselect_b32 s90, 4, 18
  s_cselect_b32 s91, 2, 1
  s_cselect_b32 s93, 8, 36
  s_cselect_b32 s96, 3, 1
  s_mul_i32 s90, s90, 1152
  s_sub_u32 s90, s90, 1024
  s_mul_i32 s93, s93, 1152
  s_add_u32 s68, s68, s89
  s_mul_i32 s68, s68, 1152
  s_lshl_b32 s62, s60, 7
  s_add_u32 s68, s68, s62
  v_lshrrev_b32 v24, s91, v21
  v_mul_u32_u24 v172, s93, v24
  v_and_b32 v23, s96, v21
  v_mul_u32_u24 v23, 1152, v23
  v_add3_u32 v172, v172, v23, v22
  s_mov_b32 m0, 90112
  s_nop 0
  buffer_load_dwordx4 v172, s[24:27], s68 offen  lds
  s_add_u32 s68, s68, s90
  buffer_load_dwordx4 v172, s[24:27], s68 offen offset:1024  lds
  s_mul_i32 s32, s60, 72
  s_add_u32 s32, s32, s61
  s_lshl_b32 s32, s32, 10
  s_add_u32 s32, s32, 138412032
  s_mul_i32 s62, s2, 4
  s_sub_u32 s62, s62, 639
  s_mul_i32 s60, s62, 1821
  s_lshr_b32 s60, s60, 16
  s_mul_i32 s61, s60, 36
  s_sub_u32 s61, s62, s61
  s_mul_i32 s29, s61, 7282
  s_lshr_b32 s29, s29, 16
  s_mul_i32 s69, s29, 9
  s_sub_u32 s69, s61, s69
  s_mul_i32 s68, s29, 144
  s_mul_i32 s89, s69, 18
  s_cmp_lt_u32 s69, 8
  s_cselect_b32 s89, s89, 16
  s_cselect_b32 s90, 4, 18
  s_cselect_b32 s91, 2, 1
  s_cselect_b32 s93, 8, 36
  s_cselect_b32 s96, 3, 1
  s_mul_i32 s90, s90, 1152
  s_sub_u32 s90, s90, 1024
  s_mul_i32 s93, s93, 1152
  s_add_u32 s68, s68, s89
  s_mul_i32 s68, s68, 1152
  s_lshl_b32 s62, s60, 7
  s_add_u32 s68, s68, s62
  v_lshrrev_b32 v24, s91, v21
  v_mul_u32_u24 v172, s93, v24
  v_and_b32 v23, s96, v21
  v_mul_u32_u24 v23, 1152, v23
  v_add3_u32 v172, v172, v23, v22
  s_mov_b32 m0, 92160
  s_nop 0
  buffer_load_dwordx4 v172, s[24:27], s68 offen  lds
  s_add_u32 s68, s68, s90
  buffer_load_dwordx4 v172, s[24:27], s68 offen offset:1024  lds
  s_mul_i32 s33, s60, 72
  s_add_u32 s33, s33, s61
  s_lshl_b32 s33, s33, 10
  s_add_u32 s33, s33, 138412032
  s_mul_i32 s62, s2, 4
  s_sub_u32 s62, s62, 638
  s_mul_i32 s60, s62, 1821
  s_lshr_b32 s60, s60, 16
  s_mul_i32 s61, s60, 36
  s_sub_u32 s61, s62, s61
  s_mul_i32 s30, s61, 7282
  s_lshr_b32 s30, s30, 16
  s_mul_i32 s69, s30, 9
  s_sub_u32 s69, s61, s69
  s_mul_i32 s68, s30, 144
  s_mul_i32 s89, s69, 18
  s_cmp_lt_u32 s69, 8
  s_cselect_b32 s89, s89, 16
  s_cselect_b32 s90, 4, 18
  s_cselect_b32 s91, 2, 1
  s_cselect_b32 s93, 8, 36
  s_cselect_b32 s96, 3, 1
  s_mul_i32 s90, s90, 1152
  s_sub_u32 s90, s90, 1024
  s_mul_i32 s93, s93, 1152
  s_add_u32 s68, s68, s89
  s_mul_i32 s68, s68, 1152
  s_lshl_b32 s62, s60, 7
  s_add_u32 s68, s68, s62
  v_lshrrev_b32 v24, s91, v21
  v_mul_u32_u24 v172, s93, v24
  v_and_b32 v23, s96, v21
  v_mul_u32_u24 v23, 1152, v23
  v_add3_u32 v172, v172, v23, v22
  s_mov_b32 m0, 94208
  s_nop 0
  buffer_load_dwordx4 v172, s[24:27], s68 offen  lds
  s_add_u32 s68, s68, s90
  buffer_load_dwordx4 v172, s[24:27], s68 offen offset:1024  lds
  s_mul_i32 s34, s60, 72
  s_add_u32 s34, s34, s61
  s_lshl_b32 s34, s34, 10
  s_add_u32 s34, s34, 138412032
  s_mul_i32 s62, s2, 4
  s_sub_u32 s62, s62, 637
  s_mul_i32 s60, s62, 1821
  s_lshr_b32 s60, s60, 16
  s_mul_i32 s61, s60, 36
  s_sub_u32 s61, s62, s61
  s_mul_i32 s31, s61, 7282
  s_lshr_b32 s31, s31, 16
  s_mul_i32 s69, s31, 9
  s_sub_u32 s69, s61, s69
  s_mul_i32 s68, s31, 144
  s_mul_i32 s89, s69, 18
  s_cmp_lt_u32 s69, 8
  s_cselect_b32 s89, s89, 16
  s_cselect_b32 s90, 4, 18
  s_cselect_b32 s91, 2, 1
  s_cselect_b32 s93, 8, 36
  s_cselect_b32 s96, 3, 1
  s_mul_i32 s90, s90, 1152
  s_sub_u32 s90, s90, 1024
  s_mul_i32 s93, s93, 1152
  s_add_u32 s68, s68, s89
  s_mul_i32 s68, s68, 1152
  s_lshl_b32 s62, s60, 7
  s_add_u32 s68, s68, s62
  v_lshrrev_b32 v24, s91, v21
  v_mul_u32_u24 v172, s93, v24
  v_and_b32 v23, s96, v21
  v_mul_u32_u24 v23, 1152, v23
  v_add3_u32 v172, v172, v23, v22
  s_mov_b32 m0, 96256
  s_nop 0
  buffer_load_dwordx4 v172, s[24:27], s68 offen  lds
  s_add_u32 s68, s68, s90
  buffer_load_dwordx4 v172, s[24:27], s68 offen offset:1024  lds
  s_mul_i32 s35, s60, 72
  s_add_u32 s35, s35, s61
  s_lshl_b32 s35, s35, 10
  s_add_u32 s35, s35, 138412032
  v_and_b32 v20, 3, v2
  v_bfe_u32 v21, v2, 4, 1
  v_lshl_add_u32 v21, v21, 2, v20
  v_bfe_u32 v22, v2, 2, 2
  v_lshlrev_b32 v22, 6, v22
  v_lshrrev_b32 v20, 5, v2
  v_lshl_add_u32 v22, v20, 10, v22
  v_lshl_add_u32 v171, v21, 3, v22
  v_add_u32 v171, 90112, v171
  v_and_b32 v23, 1, v21
  v_lshl_add_u32 v22, v23, 3, v22
  v_lshrrev_b32 v21, 1, v21
  v_add_u32 v22, 90112, v22
  v_add_u32 v32, s28, v21
  v_and_b32 v32, 3, v32
  v_lshl_add_u32 v32, v32, 4, v22
  v_add_u32 v33, s29, v21
  v_and_b32 v33, 3, v33
  v_lshl_add_u32 v33, v33, 4, v22
  v_add_u32 v34, s30, v21
  v_and_b32 v34, 3, v34
  v_lshl_add_u32 v34, v34, 4, v22
  v_add_u32 v35, s31, v21
  v_and_b32 v35, 3, v35
  v_lshl_add_u32 v35, v35, 4, v22
  s_mov_b32 s49, 0x400000
L_pl_g4:
  ds_read_b32 v27, v18 offset:0
  s_waitcnt lgkmcnt(0)
  v_readfirstlane_b32 s60, v27
  s_sub_u32 s49, s49, 1
  s_cmp_eq_u32 s49, 0
  s_cbranch_scc1 L_pl_g4e
  s_cmp_lt_u32 s60, 3
  s_cbranch_scc1 L_pl_g4
L_pl_g4e:
  s_waitcnt vmcnt(6)
  ds_read_b64_tr_b16 v[184:185], v32 offset:0
  ds_read_b64_tr_b16 v[186:187], v32 offset:256
  ds_read_b64_tr_b16 v[188:189], v32 offset:512
  ds_read_b64_tr_b16 v[190:191], v32 offset:768
  s_waitcnt vmcnt(4)
  ds_read_b64_tr_b16 v[192:193], v33 offset:2048
  ds_read_b64_tr_b16 v[194:195], v33 offset:2304
  ds_read_b64_tr_b16 v[196:197], v33 offset:2560
  ds_read_b64_tr_b16 v[198:199], v33 offset:2816
  s_waitcnt vmcnt(2)
  ds_read_b64_tr_b16 v[200:201], v34 offset:4096
  ds_read_b64_tr_b16 v[202:203], v34 offset:4352
  ds_read_b64_tr_b16 v[204:205], v34 offset:4608
  ds_read_b64_tr_b16 v[206:207], v34 offset:4864
  s_waitcnt vmcnt(0)
  ds_read_b64_tr_b16 v[208:209], v35 offset:6144
  ds_read_b64_tr_b16 v[210:211], v35 offset:6400
  ds_read_b64_tr_b16 v[212:213], v35 offset:6656
  ds_read_b64_tr_b16 v[214:215], v35 offset:6912
  s_waitcnt lgkmcnt(14)
  buffer_store_dwordx4 v[184:187], v3, s[8:11], s32 offen sc1
  s_add_u32 s32, s32, 36864
  s_waitcnt lgkmcnt(12)
  buffer_store_dwordx4 v[188:191], v3, s[8:11], s32 offen sc1
  s_waitcnt lgkmcnt(10)
  buffer_store_dwordx4 v[192:195], v3, s[8:11], s33 offen sc1
  s_add_u32 s33, s33, 36864
  s_waitcnt lgkmcnt(8)
  buffer_store_dwordx4 v[196:199], v3, s[8:11], s33 offen sc1
  s_waitcnt lgkmcnt(6)
  buffer_store_dwordx4 v[200:203], v3, s[8:11], s34 offen sc1
  s_add_u32 s34, s34, 36864
  s_waitcnt lgkmcnt(4)
  buffer_store_dwordx4 v[204:207], v3, s[8:11], s34 offen sc1
  s_waitcnt lgkmcnt(2)
  buffer_store_dwordx4 v[208:211], v3, s[8:11], s35 offen sc1
  s_add_u32 s35, s35, 36864
  s_waitcnt lgkmcnt(0)
  buffer_store_dwordx4 v[212:215], v3, s[8:11], s35 offen sc1
  s_branch L_a0
L_plx:
  s_cmp_lt_u32 s2, 249
  s_cbranch_scc0 L_a0
  s_mov_b32 s64, s56
  s_mov_b32 s65, s57
  s_and_b32 s58, s2, 7
  s_mul_i32 s68, s58, 663552
  s_add_u32 s68, s68, 590848
  v_mul_u32_u24 v170, 1152, v21
  v_add_u32 v170, v170, v22
  s_mov_b32 m0, 90112
  s_nop 0
  buffer_load_dwordx4 v170, s[64:67], s68 offen offset:0 nt lds
  s_add_u32 s68, s68, 8192
  buffer_load_dwordx4 v170, s[64:67], s68 offen offset:1024 nt lds
  s_add_u32 s68, s68, 8192
  buffer_load_dwordx4 v170, s[64:67], s68 offen offset:2048 nt lds
  s_add_u32 s68, s68, 8192
  buffer_load_dwordx4 v170, s[64:67], s68 offen offset:3072 nt lds
  s_add_u32 s68, s68, 12288
  s_mov_b32 m0, 94208
  s_nop 0
  buffer_load_dwordx4 v170, s[64:67], s68 offen offset:0 nt lds
  s_add_u32 s68, s68, 8192
  buffer_load_dwordx4 v170, s[64:67], s68 offen offset:1024 nt lds
  s_add_u32 s68, s68, 8192
  buffer_load_dwordx4 v170, s[64:67], s68 offen offset:2048 nt lds
  s_add_u32 s68, s68, 8192
  buffer_load_dwordx4 v170, s[64:67], s68 offen offset:3072 nt lds
L_a0:
  s_and_b32 s17, s2, 7
  s_lshr_b32 s18, s2, 3
  s_lshr_b32 s19, s17, 2
  s_lshl_b32 s19, s19, 2
  s_and_b32 s20, s18, 3
  s_add_u32 s19, s19, s20
  s_and_b32 s20, s17, 3
  s_lshl_b32 s20, s20, 3
  s_lshr_b32 s21, s18, 2
  s_add_u32 s20, s20, s21
  s_lshl_b32 s21, s19, 3
  s_lshl_b32 s22, s16, 1
  s_add_u32 s21, s21, s22
  s_mul_i32 s22, s21, 36864
  s_add_u32 s22, s22, 0
  s_mul_i32 s24, s20, 73728
  s_add_u32 s24, s24, 134217728
  s_lshl_b32 s25, s16, 11
  s_add_u32 s24, s24, s25
  v_lshlrev_b32 v13, 2, v0
  v_add_u32 v4, 65536, v3
  s_mul_i32 s28, s16, 1280
  s_add_u32 s28, s28, 72448
  v_and_b32 v5, 31, v2
  v_lshlrev_b32 v5, 6, v5
  v_lshrrev_b32 v9, 5, v2
  v_lshl_add_u32 v5, v9, 5, v5
  v_add_u32 v5, s28, v5
  v_bfe_u32 v6, v2, 2, 2
  v_lshl_add_u32 v6, v9, 2, v6
  v_lshlrev_b32 v6, 6, v6
  v_and_b32 v7, 1, v2
  v_lshl_add_u32 v6, v7, 5, v6
  v_bfe_u32 v7, v2, 4, 1
  v_lshl_add_u32 v6, v7, 4, v6
  v_bfe_u32 v7, v2, 1, 1
  v_lshl_add_u32 v6, v7, 3, v6
  s_add_u32 s28, s28, 1280
  v_add_u32 v6, s28, v6
  v_lshlrev_b32 v7, 2, v2
  s_mul_i32 s28, s16, 2560
  v_add_u32 v15, s28, v3
  v_lshlrev_b32 v14, 3, v2
  v_add_u32 v14, s28, v14
  v_and_b32 v8, 27, v2
  v_cmp_eq_u32 s[30:31], 18, v8
  v_mov_b32 v8, 0x3f803f80
  s_mov_b32 s32, 0xfff00000
  s_mov_b32 s33, 0xfff00000
  s_lshl_b32 s26, s21, 5
  s_add_u32 s26, s26, s20
  s_lshl_b32 s27, s26, 8
  s_lshl_b32 s26, s26, 10
  s_add_u32 s26, s26, 7077888
  s_add_u32 s27, s27, 9175040
  v_and_b32 v5, 15, v2
  v_lshrrev_b32 v9, 4, v2
  v_lshlrev_b32 v164, 4, v5
  v_lshl_add_u32 v164, v9, 9, v164
  v_add_u32 v15, s28, v164
  v_and_b32 v9, 1, v9
  v_lshlrev_b32 v14, 3, v5
  v_lshl_add_u32 v14, v9, 8, v14
  v_add_u32 v14, s28, v14
  v_lshlrev_b32 v5, 6, v5
  v_lshl_add_u32 v5, v9, 5, v5
  v_lshrrev_b32 v9, 5, v2
  v_lshl_add_u32 v5, v9, 3, v5
  s_mul_i32 s28, s16, 1280
  s_add_u32 s28, s28, 73472
  v_add_u32 v5, s28, v5
  v_lshl_add_u32 v165, v9, 10, v164
  v_add_u32 v166, 65536, v165
  v_and_b32 v9, 11, v2
  v_cmp_eq_u32 s[30:31], 2, v9
  s_lshl_b32 s56, s19, 9
  s_lshl_b32 s57, s20, 7
  s_sub_u32 s57, s57, 512
  v_mov_b32 v161, s56
  v_mov_b32 v162, s57
  v_cmp_lt_u32 vcc, 31, v2
  s_nop 1
  v_cndmask_b32 v161, v161, v162, vcc
  v_add_u32 v161, v161, v3
  s_mov_b32 s56, 159399936
  v_mov_b32 v162, 82192
  s_and_b32 s57, s2, 7
  s_lshl_b32 s57, s57, 10
  s_add_u32 s57, s57, 159383552
  s_lshl_b32 s58, s2, 2
  s_add_u32 s58, s58, 159383552
  s_mov_b32 s49, 0x40000
  s_cmp_eq_u32 s16, 0
  s_cbranch_scc0 L_a0p_go
  ds_write_b32 v162, v160
  s_mov_b32 exec_hi, 255
L_a0p_poll:
  buffer_load_dword v250, v161, s[8:11], s56 offen sc1
  s_waitcnt vmcnt(0) lgkmcnt(0)
  v_cmp_ne_u32 vcc, v250, v160
  s_nop 4
  s_cbranch_vccz L_a0p_ok
  s_sub_u32 s49, s49, 1
  s_cmp_eq_u32 s49, 0
  s_cbranch_scc0 L_a0p_poll
L_a0p_ok:
  s_mov_b64 exec, -1
L_a0p_go:
  s_barrier
  s_mov_b32 m0, s25
  s_nop 0
  buffer_load_dwordx4 v3, s[8:11], s24 offen offset:0 sc1 lds
  buffer_load_dwordx4 v3, s[8:11], s24 offen offset:1024 sc1 lds
  s_addk_i32 s24, 8192
  buffer_load_dwordx4 a[0:3], v164, s[8:11], s22 offen offset:0 sc1
  buffer_load_dwordx4 a[4:7], v164, s[8:11], s22 offen offset:256 sc1
  buffer_load_dwordx4 a[8:11], v164, s[8:11], s22 offen offset:2048 sc1
  buffer_load_dwordx4 a[12:15], v164, s[8:11], s22 offen offset:2304 sc1
  s_add_u32 m0, s25, 8192
  s_nop 0
  buffer_load_dwordx4 v3, s[8:11], s24 offen offset:0 sc1 lds
  buffer_load_dwordx4 v3, s[8:11], s24 offen offset:1024 sc1 lds
  s_addk_i32 s24, 8192
  s_addk_i32 s22, 4096
  buffer_load_dwordx4 a[16:19], v164, s[8:11], s22 offen offset:0 sc1
  buffer_load_dwordx4 a[20:23], v164, s[8:11], s22 offen offset:256 sc1
  buffer_load_dwordx4 a[24:27], v164, s[8:11], s22 offen offset:2048 sc1
  buffer_load_dwordx4 a[28:31], v164, s[8:11], s22 offen offset:2304 sc1
  s_add_u32 m0, s25, 16384
  s_nop 0
  buffer_load_dwordx4 v3, s[8:11], s24 offen offset:0 sc1 lds
  buffer_load_dwordx4 v3, s[8:11], s24 offen offset:1024 sc1 lds
  s_addk_i32 s24, 8192
  s_addk_i32 s22, 4096
  buffer_load_dwordx4 a[32:35], v164, s[8:11], s22 offen offset:0 sc1
  buffer_load_dwordx4 a[36:39], v164, s[8:11], s22 offen offset:256 sc1
  buffer_load_dwordx4 a[40:43], v164, s[8:11], s22 offen offset:2048 sc1
  buffer_load_dwordx4 a[44:47], v164, s[8:11], s22 offen offset:2304 sc1
  ds_read_b32 v161, v162
  s_waitcnt lgkmcnt(0)
  v_readfirstlane_b32 s3, v161
  s_waitcnt vmcnt(16)
  s_barrier
  ds_read_b128 v[80:83], v165 offset:0
  ds_read_b128 v[84:87], v165 offset:256
  ds_read_b128 v[88:91], v165 offset:1024
  ds_read_b128 v[92:95], v165 offset:1280
  ds_read_b128 v[96:99], v165 offset:4096
  ds_read_b128 v[100:103], v165 offset:4352
  ds_read_b128 v[104:107], v165 offset:5120
  s_waitcnt vmcnt(15) lgkmcnt(6)
  v_mfma_f32_16x16x32_bf16 v[16:19], a[0:3], v[80:83], 0
  s_add_u32 m0, s25, 24576
  s_nop 0
  buffer_load_dwordx4 v3, s[8:11], s24 offen offset:0 sc1 lds
  buffer_load_dwordx4 v3, s[8:11], s24 offen offset:1024 sc1 lds
  s_addk_i32 s24, 8192
  s_addk_i32 s22, 4096
  buffer_load_dwordx4 a[48:51], v164, s[8:11], s22 offen offset:0 sc1
  s_cmp_eq_u32 s16, 0
  s_cbranch_scc0 L_f2_ns
  v_mov_b32 v161, s3
  v_lshlrev_b32 v162, 10, v2
  s_mov_b64 exec, 0xff
  buffer_store_dword v161, v162, s[8:11], s58 offen sc1
  s_mov_b64 exec, -1
L_f2_ns:
  s_waitcnt vmcnt(17)
  v_mfma_f32_16x16x32_bf16 v[20:23], a[4:7], v[80:83], 0
  ds_read_b128 v[108:111], v165 offset:5376
  s_waitcnt lgkmcnt(6)
  v_mfma_f32_16x16x32_bf16 v[24:27], a[0:3], v[84:87], 0
  v_mfma_f32_16x16x32_bf16 v[28:31], a[4:7], v[84:87], 0
  s_waitcnt vmcnt(13)
  s_barrier
  ds_read_b128 v[80:83], v165 offset:8192
  s_waitcnt lgkmcnt(6)
  v_mfma_f32_16x16x32_bf16 v[32:35], a[0:3], v[88:91], 0
  buffer_load_dwordx4 a[52:55], v164, s[8:11], s22 offen offset:256 sc1
  v_mfma_f32_16x16x32_bf16 v[36:39], a[4:7], v[88:91], 0
  ds_read_b128 v[84:87], v165 offset:8448
  s_waitcnt lgkmcnt(6)
  v_mfma_f32_16x16x32_bf16 v[40:43], a[0:3], v[92:95], 0
  v_mfma_f32_16x16x32_bf16 v[44:47], a[4:7], v[92:95], 0
  ds_read_b128 v[88:91], v165 offset:9216
  s_waitcnt lgkmcnt(6)
  v_mfma_f32_16x16x32_bf16 v[16:19], a[8:11], v[96:99], v[16:19]
  buffer_load_dwordx4 a[56:59], v164, s[8:11], s22 offen offset:2048 sc1
  v_mfma_f32_16x16x32_bf16 v[20:23], a[12:15], v[96:99], v[20:23]
  ds_read_b128 v[92:95], v165 offset:9472
  s_waitcnt lgkmcnt(6)
  v_mfma_f32_16x16x32_bf16 v[24:27], a[8:11], v[100:103], v[24:27]
  v_mfma_f32_16x16x32_bf16 v[28:31], a[12:15], v[100:103], v[28:31]
  ds_read_b128 v[96:99], v165 offset:12288
  s_waitcnt lgkmcnt(6)
  v_mfma_f32_16x16x32_bf16 v[32:35], a[8:11], v[104:107], v[32:35]
  buffer_load_dwordx4 a[60:63], v164, s[8:11], s22 offen offset:2304 sc1
  s_add_u32 m0, s25, 32768
  s_nop 0
  buffer_load_dwordx4 v3, s[8:11], s24 offen offset:0 sc1 lds
  buffer_load_dwordx4 v3, s[8:11], s24 offen offset:1024 sc1 lds
  s_addk_i32 s24, 8192
  s_addk_i32 s22, 4096
  buffer_load_dwordx4 a[0:3], v164, s[8:11], s22 offen offset:0 sc1
  v_mfma_f32_16x16x32_bf16 v[36:39], a[12:15], v[104:107], v[36:39]
  ds_read_b128 v[100:103], v165 offset:12544
  s_waitcnt lgkmcnt(6)
  v_mfma_f32_16x16x32_bf16 v[40:43], a[8:11], v[108:111], v[40:43]
  v_mfma_f32_16x16x32_bf16 v[44:47], a[12:15], v[108:111], v[44:47]
  ds_read_b128 v[104:107], v165 offset:13312
  s_waitcnt vmcnt(18) lgkmcnt(6)
  v_mfma_f32_16x16x32_bf16 v[16:19], a[16:19], v[80:83], v[16:19]
  buffer_load_dwordx4 a[4:7], v164, s[8:11], s22 offen offset:256 sc1
  buffer_load_dwordx4 a[8:11], v164, s[8:11], s22 offen offset:2048 sc1
  s_waitcnt vmcnt(19)
  v_mfma_f32_16x16x32_bf16 v[20:23], a[20:23], v[80:83], v[20:23]
  ds_read_b128 v[108:111], v165 offset:13568
  s_waitcnt lgkmcnt(6)
  v_mfma_f32_16x16x32_bf16 v[24:27], a[16:19], v[84:87], v[24:27]
  v_mfma_f32_16x16x32_bf16 v[28:31], a[20:23], v[84:87], v[28:31]
  s_waitcnt vmcnt(15)
  s_barrier
  ds_read_b128 v[80:83], v165 offset:16384
  s_waitcnt lgkmcnt(6)
  v_mfma_f32_16x16x32_bf16 v[32:35], a[16:19], v[88:91], v[32:35]
  buffer_load_dwordx4 a[12:15], v164, s[8:11], s22 offen offset:2304 sc1
  v_mfma_f32_16x16x32_bf16 v[36:39], a[20:23], v[88:91], v[36:39]
  ds_read_b128 v[84:87], v165 offset:16640
  s_waitcnt lgkmcnt(6)
  v_mfma_f32_16x16x32_bf16 v[40:43], a[16:19], v[92:95], v[40:43]
  v_mfma_f32_16x16x32_bf16 v[44:47], a[20:23], v[92:95], v[44:47]
  ds_read_b128 v[88:91], v165 offset:17408
  s_waitcnt lgkmcnt(6)
  v_mfma_f32_16x16x32_bf16 v[16:19], a[24:27], v[96:99], v[16:19]
  s_add_u32 m0, s25, 40960
  s_nop 0
  buffer_load_dwordx4 v3, s[8:11], s24 offen offset:0 sc1 lds
  buffer_load_dwordx4 v3, s[8:11], s24 offen offset:1024 sc1 lds
  s_addk_i32 s24, 8192
  s_addk_i32 s22, 4096
  buffer_load_dwordx4 a[16:19], v164, s[8:11], s22 offen offset:0 sc1
  v_mfma_f32_16x16x32_bf16 v[20:23], a[28:31], v[96:99], v[20:23]
  ds_read_b128 v[92:95], v165 offset:17664
  s_waitcnt lgkmcnt(6)
  v_mfma_f32_16x16x32_bf16 v[24:27], a[24:27], v[100:103], v[24:27]
  v_mfma_f32_16x16x32_bf16 v[28:31], a[28:31], v[100:103], v[28:31]
  ds_read_b128 v[96:99], v165 offset:20480
  s_waitcnt lgkmcnt(6)
  v_mfma_f32_16x16x32_bf16 v[32:35], a[24:27], v[104:107], v[32:35]
  buffer_load_dwordx4 a[20:23], v164, s[8:11], s22 offen offset:256 sc1
  v_mfma_f32_16x16x32_bf16 v[36:39], a[28:31], v[104:107], v[36:39]
  ds_read_b128 v[100:103], v165 offset:20736
  s_waitcnt lgkmcnt(6)
  v_mfma_f32_16x16x32_bf16 v[40:43], a[24:27], v[108:111], v[40:43]
  v_mfma_f32_16x16x32_bf16 v[44:47], a[28:31], v[108:111], v[44:47]
  ds_read_b128 v[104:107], v165 offset:21504
  s_waitcnt vmcnt(19) lgkmcnt(6)
  v_mfma_f32_16x16x32_bf16 v[16:19], a[32:35], v[80:83], v[16:19]
  buffer_load_dwordx4 a[24:27], v164, s[8:11], s22 offen offset:2048 sc1
  s_waitcnt vmcnt(19)
  v_mfma_f32_16x16x32_bf16 v[20:23], a[36:39], v[80:83], v[20:23]
  ds_read_b128 v[108:111], v165 offset:21760
  s_waitcnt lgkmcnt(6)
  v_mfma_f32_16x16x32_bf16 v[24:27], a[32:35], v[84:87], v[24:27]
  v_mfma_f32_16x16x32_bf16 v[28:31], a[36:39], v[84:87], v[28:31]
  s_waitcnt vmcnt(15)
  s_barrier
  ds_read_b128 v[80:83], v165 offset:24576
  s_waitcnt lgkmcnt(6)
  v_mfma_f32_16x16x32_bf16 v[32:35], a[32:35], v[88:91], v[32:35]
  buffer_load_dwordx4 a[28:31], v164, s[8:11], s22 offen offset:2304 sc1
  v_mfma_f32_16x16x32_bf16 v[36:39], a[36:39], v[88:91], v[36:39]
  ds_read_b128 v[84:87], v165 offset:24832
  s_waitcnt lgkmcnt(6)
  v_mfma_f32_16x16x32_bf16 v[40:43], a[32:35], v[92:95], v[40:43]
  v_mfma_f32_16x16x32_bf16 v[44:47], a[36:39], v[92:95], v[44:47]
  ds_read_b128 v[88:91], v165 offset:25600
  s_waitcnt lgkmcnt(6)
  v_mfma_f32_16x16x32_bf16 v[16:19], a[40:43], v[96:99], v[16:19]
  s_add_u32 m0, s25, 49152
  s_nop 0
  buffer_load_dwordx4 v3, s[8:11], s24 offen offset:0 sc1 lds
  buffer_load_dwordx4 v3, s[8:11], s24 offen offset:1024 sc1 lds
  s_addk_i32 s24, 8192
  s_addk_i32 s22, 4096
  buffer_load_dwordx4 a[32:35], v164, s[8:11], s22 offen offset:0 sc1
  v_mfma_f32_16x16x32_bf16 v[20:23], a[44:47], v[96:99], v[20:23]
  ds_read_b128 v[92:95], v165 offset:25856
  v_bfe_u32 v10, v0, 2, 5
  s_waitcnt lgkmcnt(6)
  v_mfma_f32_16x16x32_bf16 v[24:27], a[40:43], v[100:103], v[24:27]
  v_mfma_f32_16x16x32_bf16 v[28:31], a[44:47], v[100:103], v[28:31]
  ds_read_b128 v[96:99], v165 offset:28672
  s_waitcnt lgkmcnt(6)
  v_mfma_f32_16x16x32_bf16 v[32:35], a[40:43], v[104:107], v[32:35]
  buffer_load_dwordx4 a[36:39], v164, s[8:11], s22 offen offset:256 sc1
  v_lshrrev_b32 v12, 1, v0
  v_mfma_f32_16x16x32_bf16 v[36:39], a[44:47], v[104:107], v[36:39]
  ds_read_b128 v[100:103], v165 offset:28928
  s_waitcnt lgkmcnt(6)
  v_mfma_f32_16x16x32_bf16 v[40:43], a[40:43], v[108:111], v[40:43]
  v_mfma_f32_16x16x32_bf16 v[44:47], a[44:47], v[108:111], v[44:47]
  ds_read_b128 v[104:107], v165 offset:29696
  s_waitcnt vmcnt(19) lgkmcnt(6)
  v_mfma_f32_16x16x32_bf16 v[16:19], a[48:51], v[80:83], v[16:19]
  buffer_load_dwordx4 a[40:43], v164, s[8:11], s22 offen offset:2048 sc1
  v_cmp_gt_u32 s[34:35], 19, v10
  s_waitcnt vmcnt(19)
  v_mfma_f32_16x16x32_bf16 v[20:23], a[52:55], v[80:83], v[20:23]
  ds_read_b128 v[108:111], v165 offset:29952
  s_waitcnt lgkmcnt(6)
  v_mfma_f32_16x16x32_bf16 v[24:27], a[48:51], v[84:87], v[24:27]
  v_mfma_f32_16x16x32_bf16 v[28:31], a[52:55], v[84:87], v[28:31]
  s_waitcnt vmcnt(15)
  s_barrier
  ds_read_b128 v[80:83], v165 offset:32768
  v_cmp_eq_u32 s[36:37], 22, v10
  s_waitcnt lgkmcnt(6)
  v_mfma_f32_16x16x32_bf16 v[32:35], a[48:51], v[88:91], v[32:35]
  buffer_load_dwordx4 a[44:47], v164, s[8:11], s22 offen offset:2304 sc1
  v_mfma_f32_16x16x32_bf16 v[36:39], a[52:55], v[88:91], v[36:39]
  ds_read_b128 v[84:87], v165 offset:33024
  s_waitcnt lgkmcnt(6)
  v_mfma_f32_16x16x32_bf16 v[40:43], a[48:51], v[92:95], v[40:43]
  s_or_b64 s[34:35], s[34:35], s[36:37]
  v_mfma_f32_16x16x32_bf16 v[44:47], a[52:55], v[92:95], v[44:47]
  ds_read_b128 v[88:91], v165 offset:33792
  s_waitcnt lgkmcnt(6)
  v_mfma_f32_16x16x32_bf16 v[16:19], a[56:59], v[96:99], v[16:19]
  s_add_u32 m0, s25, 57344
  s_nop 0
  buffer_load_dwordx4 v3, s[8:11], s24 offen offset:0 sc1 lds
  buffer_load_dwordx4 v3, s[8:11], s24 offen offset:1024 sc1 lds
  s_addk_i32 s24, 8192
  s_addk_i32 s22, 4096
  buffer_load_dwordx4 a[48:51], v164, s[8:11], s22 offen offset:0 sc1
  v_mfma_f32_16x16x32_bf16 v[20:23], a[60:63], v[96:99], v[20:23]
  ds_read_b128 v[92:95], v165 offset:34048
  s_waitcnt lgkmcnt(6)
  v_mfma_f32_16x16x32_bf16 v[24:27], a[56:59], v[100:103], v[24:27]
  v_cmp_gt_u32 s[38:39], 19, v12
  v_mfma_f32_16x16x32_bf16 v[28:31], a[60:63], v[100:103], v[28:31]
  ds_read_b128 v[96:99], v165 offset:36864
  s_waitcnt lgkmcnt(6)
  v_mfma_f32_16x16x32_bf16 v[32:35], a[56:59], v[104:107], v[32:35]
  buffer_load_dwordx4 a[52:55], v164, s[8:11], s22 offen offset:256 sc1
  v_mfma_f32_16x16x32_bf16 v[36:39], a[60:63], v[104:107], v[36:39]
  ds_read_b128 v[100:103], v165 offset:37120
  v_cmp_eq_u32 s[36:37], 22, v12
  s_waitcnt lgkmcnt(6)
  v_mfma_f32_16x16x32_bf16 v[40:43], a[56:59], v[108:111], v[40:43]
  v_mfma_f32_16x16x32_bf16 v[44:47], a[60:63], v[108:111], v[44:47]
  ds_read_b128 v[104:107], v165 offset:37888
  s_waitcnt vmcnt(19) lgkmcnt(6)
  v_mfma_f32_16x16x32_bf16 v[16:19], a[0:3], v[80:83], v[16:19]
  buffer_load_dwordx4 a[56:59], v164, s[8:11], s22 offen offset:2048 sc1
  s_or_b64 s[38:39], s[38:39], s[36:37]
  s_waitcnt vmcnt(19)
  v_mfma_f32_16x16x32_bf16 v[20:23], a[4:7], v[80:83], v[20:23]
  ds_read_b128 v[108:111], v165 offset:38144
  s_waitcnt lgkmcnt(6)
  v_mfma_f32_16x16x32_bf16 v[24:27], a[0:3], v[84:87], v[24:27]
  v_mfma_f32_16x16x32_bf16 v[28:31], a[4:7], v[84:87], v[28:31]
  s_waitcnt vmcnt(15)
  s_barrier
  ds_read_b128 v[80:83], v165 offset:40960
  s_waitcnt lgkmcnt(6)
  v_mfma_f32_16x16x32_bf16 v[32:35], a[0:3], v[88:91], v[32:35]
  buffer_load_dwordx4 a[60:63], v164, s[8:11], s22 offen offset:2304 sc1
  s_mul_i32 s28, s20, 2560
  v_mfma_f32_16x16x32_bf16 v[36:39], a[4:7], v[88:91], v[36:39]
  ds_read_b128 v[84:87], v165 offset:41216
  s_waitcnt lgkmcnt(6)
  v_mfma_f32_16x16x32_bf16 v[40:43], a[0:3], v[92:95], v[40:43]
  v_mfma_f32_16x16x32_bf16 v[44:47], a[4:7], v[92:95], v[44:47]
  ds_read_b128 v[88:91], v165 offset:41984
  s_add_u32 s28, s28, 9699328
  s_waitcnt lgkmcnt(6)
  v_mfma_f32_16x16x32_bf16 v[16:19], a[8:11], v[96:99], v[16:19]
  s_add_u32 m0, s25, 65536
  s_nop 0
  buffer_load_dwordx4 v3, s[8:11], s24 offen offset:0 sc1 lds
  buffer_load_dwordx4 v3, s[8:11], s24 offen offset:1024 sc1 lds
  s_addk_i32 s22, 4096
  buffer_load_dwordx4 a[0:3], v164, s[8:11], s22 offen offset:0 sc1
  v_mfma_f32_16x16x32_bf16 v[20:23], a[12:15], v[96:99], v[20:23]
  ds_read_b128 v[92:95], v165 offset:42240
  s_waitcnt lgkmcnt(6)
  v_mfma_f32_16x16x32_bf16 v[24:27], a[8:11], v[100:103], v[24:27]
  s_lshr_b32 s51, s2, 6
  v_mfma_f32_16x16x32_bf16 v[28:31], a[12:15], v[100:103], v[28:31]
  ds_read_b128 v[96:99], v165 offset:45056
  s_waitcnt lgkmcnt(6)
  v_mfma_f32_16x16x32_bf16 v[32:35], a[8:11], v[104:107], v[32:35]
  buffer_load_dwordx4 a[4:7], v164, s[8:11], s22 offen offset:256 sc1
  v_mfma_f32_16x16x32_bf16 v[36:39], a[12:15], v[104:107], v[36:39]
  ds_read_b128 v[100:103], v165 offset:45312
  s_waitcnt lgkmcnt(6)
  v_mfma_f32_16x16x32_bf16 v[40:43], a[8:11], v[108:111], v[40:43]
  s_mul_i32 s52, s51, 5
  v_mfma_f32_16x16x32_bf16 v[44:47], a[12:15], v[108:111], v[44:47]
  ds_read_b128 v[104:107], v165 offset:46080
  s_waitcnt vmcnt(19) lgkmcnt(6)
  v_mfma_f32_16x16x32_bf16 v[16:19], a[16:19], v[80:83], v[16:19]
  buffer_load_dwordx4 a[8:11], v164, s[8:11], s22 offen offset:2048 sc1
  s_waitcnt vmcnt(19)
  v_mfma_f32_16x16x32_bf16 v[20:23], a[20:23], v[80:83], v[20:23]
  ds_read_b128 v[108:111], v165 offset:46336
  s_lshl_b32 s53, s51, 2
  s_waitcnt lgkmcnt(6)
  v_mfma_f32_16x16x32_bf16 v[24:27], a[16:19], v[84:87], v[24:27]
  v_mfma_f32_16x16x32_bf16 v[28:31], a[20:23], v[84:87], v[28:31]
  s_waitcnt vmcnt(15)
  s_barrier
  ds_read_b128 v[80:83], v165 offset:49152
  s_waitcnt lgkmcnt(6)
  v_mfma_f32_16x16x32_bf16 v[32:35], a[16:19], v[88:91], v[32:35]
  buffer_load_dwordx4 a[12:15], v164, s[8:11], s22 offen offset:2304 sc1
  s_add_u32 s53, s53, 2
  v_mfma_f32_16x16x32_bf16 v[36:39], a[20:23], v[88:91], v[36:39]
  ds_read_b128 v[84:87], v165 offset:49408
  s_waitcnt lgkmcnt(6)
  v_mfma_f32_16x16x32_bf16 v[40:43], a[16:19], v[92:95], v[40:43]
  v_mfma_f32_16x16x32_bf16 v[44:47], a[20:23], v[92:95], v[44:47]
  ds_read_b128 v[88:91], v165 offset:50176
  s_waitcnt lgkmcnt(6)
  v_mfma_f32_16x16x32_bf16 v[16:19], a[24:27], v[96:99], v[16:19]
  s_addk_i32 s22, 4096
  buffer_load_dwordx4 a[16:19], v164, s[8:11], s22 offen offset:0 sc1
  v_mfma_f32_16x16x32_bf16 v[20:23], a[28:31], v[96:99], v[20:23]
  ds_read_b128 v[92:95], v165 offset:50432
  s_cmp_lt_u32 s51, 2
  s_cselect_b32 s52, s52, s53
  s_waitcnt lgkmcnt(6)
  v_mfma_f32_16x16x32_bf16 v[24:27], a[24:27], v[100:103], v[24:27]
  v_mfma_f32_16x16x32_bf16 v[28:31], a[28:31], v[100:103], v[28:31]
  ds_read_b128 v[96:99], v165 offset:53248
  s_waitcnt lgkmcnt(6)
  v_mfma_f32_16x16x32_bf16 v[32:35], a[24:27], v[104:107], v[32:35]
  buffer_load_dwordx4 a[20:23], v164, s[8:11], s22 offen offset:256 sc1
  v_mfma_f32_16x16x32_bf16 v[36:39], a[28:31], v[104:107], v[36:39]
  ds_read_b128 v[100:103], v165 offset:53504
  s_waitcnt lgkmcnt(6)
  v_mfma_f32_16x16x32_bf16 v[40:43], a[24:27], v[108:111], v[40:43]
  s_mul_i32 s50, s52, 36864
  v_mfma_f32_16x16x32_bf16 v[44:47], a[28:31], v[108:111], v[44:47]
  ds_read_b128 v[104:107], v165 offset:54272
  s_waitcnt vmcnt(17) lgkmcnt(6)
  v_mfma_f32_16x16x32_bf16 v[16:19], a[32:35], v[80:83], v[16:19]
  buffer_load_dwordx4 a[24:27], v164, s[8:11], s22 offen offset:2048 sc1
  s_waitcnt vmcnt(17)
  v_mfma_f32_16x16x32_bf16 v[20:23], a[36:39], v[80:83], v[20:23]
  ds_read_b128 v[108:111], v165 offset:54528
  s_waitcnt lgkmcnt(6)
  v_mfma_f32_16x16x32_bf16 v[24:27], a[32:35], v[84:87], v[24:27]
  s_mul_i32 s53, s16, 9216
  v_mfma_f32_16x16x32_bf16 v[28:31], a[36:39], v[84:87], v[28:31]
  s_waitcnt vmcnt(13)
  s_barrier
  ds_read_b128 v[80:83], v165 offset:57344
  s_waitcnt lgkmcnt(6)
  v_mfma_f32_16x16x32_bf16 v[32:35], a[32:35], v[88:91], v[32:35]
  buffer_load_dwordx4 a[28:31], v164, s[8:11], s22 offen offset:2304 sc1
  v_mfma_f32_16x16x32_bf16 v[36:39], a[36:39], v[88:91], v[36:39]
  ds_read_b128 v[84:87], v165 offset:57600
  s_add_u32 s50, s50, s53
  s_waitcnt lgkmcnt(6)
  v_mfma_f32_16x16x32_bf16 v[40:43], a[32:35], v[92:95], v[40:43]
  v_mfma_f32_16x16x32_bf16 v[44:47], a[36:39], v[92:95], v[44:47]
  ds_read_b128 v[88:91], v165 offset:58368
  s_waitcnt lgkmcnt(6)
  v_mfma_f32_16x16x32_bf16 v[16:19], a[40:43], v[96:99], v[16:19]
  s_addk_i32 s22, 4096
  buffer_load_dwordx4 a[32:35], v164, s[8:11], s22 offen offset:0 sc1
  s_add_u32 s50, s50, 138412032
  v_mfma_f32_16x16x32_bf16 v[20:23], a[44:47], v[96:99], v[20:23]
  ds_read_b128 v[92:95], v165 offset:58624
  s_waitcnt lgkmcnt(6)
  v_mfma_f32_16x16x32_bf16 v[24:27], a[40:43], v[100:103], v[24:27]
  v_mfma_f32_16x16x32_bf16 v[28:31], a[44:47], v[100:103], v[28:31]
  ds_read_b128 v[96:99], v165 offset:61440
  s_waitcnt lgkmcnt(6)
  v_mfma_f32_16x16x32_bf16 v[32:35], a[40:43], v[104:107], v[32:35]
  buffer_load_dwordx4 a[36:39], v164, s[8:11], s22 offen offset:256 sc1
  s_lshl_b32 s54, s20, 7
  v_mfma_f32_16x16x32_bf16 v[36:39], a[44:47], v[104:107], v[36:39]
  ds_read_b128 v[100:103], v165 offset:61696
  s_waitcnt lgkmcnt(6)
  v_mfma_f32_16x16x32_bf16 v[40:43], a[40:43], v[108:111], v[40:43]
  v_mfma_f32_16x16x32_bf16 v[44:47], a[44:47], v[108:111], v[44:47]
  ds_read_b128 v[104:107], v165 offset:62464
  s_add_u32 s54, s54, 9846784
  s_waitcnt vmcnt(15) lgkmcnt(6)
  v_mfma_f32_16x16x32_bf16 v[16:19], a[48:51], v[80:83], v[16:19]
  buffer_load_dwordx4 a[40:43], v164, s[8:11], s22 offen offset:2048 sc1
  s_waitcnt vmcnt(15)
  v_mfma_f32_16x16x32_bf16 v[20:23], a[52:55], v[80:83], v[20:23]
  ds_read_b128 v[108:111], v165 offset:62720
  s_waitcnt lgkmcnt(6)
  v_mfma_f32_16x16x32_bf16 v[24:27], a[48:51], v[84:87], v[24:27]
  v_lshlrev_b32 v10, 12, v2
  v_mfma_f32_16x16x32_bf16 v[28:31], a[52:55], v[84:87], v[28:31]
  s_waitcnt vmcnt(11)
  s_barrier
  ds_read_b128 v[80:83], v166 offset:0
  s_waitcnt lgkmcnt(6)
  v_mfma_f32_16x16x32_bf16 v[32:35], a[48:51], v[88:91], v[32:35]
  buffer_load_dwordx4 a[44:47], v164, s[8:11], s22 offen offset:2304 sc1
  v_mfma_f32_16x16x32_bf16 v[36:39], a[52:55], v[88:91], v[36:39]
  ds_read_b128 v[84:87], v166 offset:256
  s_waitcnt lgkmcnt(6)
  v_mfma_f32_16x16x32_bf16 v[40:43], a[48:51], v[92:95], v[40:43]
  v_mov_b32 v11, 1
  v_mfma_f32_16x16x32_bf16 v[44:47], a[52:55], v[92:95], v[44:47]
  ds_read_b128 v[88:91], v166 offset:1024
  s_waitcnt lgkmcnt(6)
  v_mfma_f32_16x16x32_bf16 v[16:19], a[56:59], v[96:99], v[16:19]
  s_addk_i32 s22, 4096
  buffer_load_dwordx4 a[48:51], v164, s[8:11], s22 offen offset:0 sc1
  v_mfma_f32_16x16x32_bf16 v[20:23], a[60:63], v[96:99], v[20:23]
  ds_read_b128 v[92:95], v166 offset:1280
  s_waitcnt lgkmcnt(6)
  v_mfma_f32_16x16x32_bf16 v[24:27], a[56:59], v[100:103], v[24:27]
  v_mfma_f32_16x16x32_bf16 v[28:31], a[60:63], v[100:103], v[28:31]
  ds_read_b128 v[96:99], v166 offset:4096
  s_waitcnt lgkmcnt(6)
  v_mfma_f32_16x16x32_bf16 v[32:35], a[56:59], v[104:107], v[32:35]
  buffer_load_dwordx4 a[52:55], v164, s[8:11], s22 offen offset:256 sc1
  v_mfma_f32_16x16x32_bf16 v[36:39], a[60:63], v[104:107], v[36:39]
  ds_read_b128 v[100:103], v166 offset:4352
  s_waitcnt lgkmcnt(6)
  v_mfma_f32_16x16x32_bf16 v[40:43], a[56:59], v[108:111], v[40:43]
  v_mfma_f32_16x16x32_bf16 v[44:47], a[60:63], v[108:111], v[44:47]
  ds_read_b128 v[104:107], v166 offset:5120
  s_waitcnt vmcnt(13) lgkmcnt(6)
  v_mfma_f32_16x16x32_bf16 v[16:19], a[0:3], v[80:83], v[16:19]
  buffer_load_dwordx4 a[56:59], v164, s[8:11], s22 offen offset:2048 sc1
  s_waitcnt vmcnt(13)
  v_mfma_f32_16x16x32_bf16 v[20:23], a[4:7], v[80:83], v[20:23]
  ds_read_b128 v[108:111], v166 offset:5376
  s_waitcnt lgkmcnt(6)
  v_mfma_f32_16x16x32_bf16 v[24:27], a[0:3], v[84:87], v[24:27]
  v_mfma_f32_16x16x32_bf16 v[28:31], a[4:7], v[84:87], v[28:31]
  ds_read_b128 v[80:83], v165 offset:0
  s_waitcnt lgkmcnt(6)
  v_mfma_f32_16x16x32_bf16 v[32:35], a[0:3], v[88:91], v[32:35]
  buffer_load_dwordx4 a[60:63], v164, s[8:11], s22 offen offset:2304 sc1
  v_mfma_f32_16x16x32_bf16 v[36:39], a[4:7], v[88:91], v[36:39]
  ds_read_b128 v[84:87], v165 offset:256
  s_waitcnt lgkmcnt(6)
  v_mfma_f32_16x16x32_bf16 v[40:43], a[0:3], v[92:95], v[40:43]
  v_mfma_f32_16x16x32_bf16 v[44:47], a[4:7], v[92:95], v[44:47]
  ds_read_b128 v[88:91], v165 offset:1024
  s_waitcnt vmcnt(13) lgkmcnt(6)
  v_mfma_f32_16x16x32_bf16 v[16:19], a[8:11], v[96:99], v[16:19]
  s_addk_i32 s22, 4096
  buffer_load_dwordx4 a[0:3], v164, s[8:11], s22 offen offset:0 sc1
  s_waitcnt vmcnt(13)
  v_mfma_f32_16x16x32_bf16 v[20:23], a[12:15], v[96:99], v[20:23]
  ds_read_b128 v[92:95], v165 offset:1280
  s_waitcnt lgkmcnt(6)
  v_mfma_f32_16x16x32_bf16 v[24:27], a[8:11], v[100:103], v[24:27]
  v_mfma_f32_16x16x32_bf16 v[28:31], a[12:15], v[100:103], v[28:31]
  ds_read_b128 v[96:99], v165 offset:4096
  s_waitcnt lgkmcnt(6)
  v_mfma_f32_16x16x32_bf16 v[32:35], a[8:11], v[104:107], v[32:35]
  buffer_load_dwordx4 a[4:7], v164, s[8:11], s22 offen offset:256 sc1
  v_mfma_f32_16x16x32_bf16 v[36:39], a[12:15], v[104:107], v[36:39]
  ds_read_b128 v[100:103], v165 offset:4352
  s_waitcnt lgkmcnt(6)
  v_mfma_f32_16x16x32_bf16 v[40:43], a[8:11], v[108:111], v[40:43]
  v_mfma_f32_16x16x32_bf16 v[44:47], a[12:15], v[108:111], v[44:47]
  ds_read_b128 v[104:107], v165 offset:5120
  s_waitcnt vmcnt(13) lgkmcnt(6)
  v_mfma_f32_16x16x32_bf16 v[48:51], a[16:19], v[80:83], 0
  buffer_load_dwordx4 a[8:11], v164, s[8:11], s22 offen offset:2048 sc1
  s_waitcnt vmcnt(13)
  v_mfma_f32_16x16x32_bf16 v[52:55], a[20:23], v[80:83], 0
  ds_read_b128 v[108:111], v165 offset:5376
  s_waitcnt lgkmcnt(6)
  v_mfma_f32_16x16x32_bf16 v[56:59], a[16:19], v[84:87], 0
  v_mfma_f32_16x16x32_bf16 v[60:63], a[20:23], v[84:87], 0
  ds_read_b128 v[80:83], v165 offset:8192
  s_waitcnt lgkmcnt(6)
  v_mfma_f32_16x16x32_bf16 v[64:67], a[16:19], v[88:91], 0
  buffer_load_dwordx4 a[12:15], v164, s[8:11], s22 offen offset:2304 sc1
  v_mul_f32 v128, 0x3fb8aa3b, v16
  v_mul_f32 v129, 0x3fb8aa3b, v17
  v_mfma_f32_16x16x32_bf16 v[68:71], a[20:23], v[88:91], 0
  ds_read_b128 v[84:87], v165 offset:8448
  v_mul_f32 v130, 0x3fb8aa3b, v18
  s_waitcnt lgkmcnt(6)
  v_mfma_f32_16x16x32_bf16 v[72:75], a[16:19], v[92:95], 0
  v_mul_f32 v131, 0x3fb8aa3b, v19
  v_exp_f32 v128, v128 clamp
  v_mfma_f32_16x16x32_bf16 v[76:79], a[20:23], v[92:95], 0
  ds_read_b128 v[88:91], v165 offset:9216
  s_waitcnt vmcnt(13) lgkmcnt(6)
  v_mfma_f32_16x16x32_bf16 v[48:51], a[24:27], v[96:99], v[48:51]
  s_addk_i32 s22, 4096
  buffer_load_dwordx4 a[16:19], v164, s[8:11], s22 offen offset:0 sc1
  v_exp_f32 v129, v129 clamp
  s_waitcnt vmcnt(13)
  v_mfma_f32_16x16x32_bf16 v[52:55], a[28:31], v[96:99], v[52:55]
  ds_read_b128 v[92:95], v165 offset:9472
  v_exp_f32 v130, v130 clamp
  s_waitcnt lgkmcnt(6)
  v_mfma_f32_16x16x32_bf16 v[56:59], a[24:27], v[100:103], v[56:59]
  v_exp_f32 v131, v131 clamp
  v_mfma_f32_16x16x32_bf16 v[60:63], a[28:31], v[100:103], v[60:63]
  ds_read_b128 v[96:99], v165 offset:12288
  v_max_f32 v16, 0x358637bd, v16
  v_max_f32 v17, 0x358637bd, v17
  s_waitcnt lgkmcnt(6)
  v_mfma_f32_16x16x32_bf16 v[64:67], a[24:27], v[104:107], v[64:67]
  buffer_load_dwordx4 a[20:23], v164, s[8:11], s22 offen offset:256 sc1
  v_max_f32 v18, 0x358637bd, v18
  v_mfma_f32_16x16x32_bf16 v[68:71], a[28:31], v[104:107], v[68:71]
  ds_read_b128 v[100:103], v165 offset:12544
  v_max_f32 v19, 0x358637bd, v19
  v_add_f32 v16, v16, v128
  s_waitcnt lgkmcnt(6)
  v_mfma_f32_16x16x32_bf16 v[72:75], a[24:27], v[108:111], v[72:75]
  v_add_f32 v17, v17, v129
  v_add_f32 v18, v18, v130
  v_mfma_f32_16x16x32_bf16 v[76:79], a[28:31], v[108:111], v[76:79]
  ds_read_b128 v[104:107], v165 offset:13312
  v_add_f32 v19, v19, v131
  s_waitcnt vmcnt(13) lgkmcnt(6)
  v_mfma_f32_16x16x32_bf16 v[48:51], a[32:35], v[80:83], v[48:51]
  buffer_load_dwordx4 a[24:27], v164, s[8:11], s22 offen offset:2048 sc1
  v_mul_f32 v128, 0x3fb8aa3b, v20
  v_mul_f32 v129, 0x3fb8aa3b, v21
  s_waitcnt vmcnt(13)
  v_mfma_f32_16x16x32_bf16 v[52:55], a[36:39], v[80:83], v[52:55]
  ds_read_b128 v[108:111], v165 offset:13568
  v_mul_f32 v130, 0x3fb8aa3b, v22
  v_mul_f32 v131, 0x3fb8aa3b, v23
  s_waitcnt lgkmcnt(6)
  v_mfma_f32_16x16x32_bf16 v[56:59], a[32:35], v[84:87], v[56:59]
  v_exp_f32 v128, v128 clamp
  v_mfma_f32_16x16x32_bf16 v[60:63], a[36:39], v[84:87], v[60:63]
  ds_read_b128 v[80:83], v165 offset:16384
  v_exp_f32 v129, v129 clamp
  s_waitcnt lgkmcnt(6)
  v_mfma_f32_16x16x32_bf16 v[64:67], a[32:35], v[88:91], v[64:67]
  buffer_load_dwordx4 a[28:31], v164, s[8:11], s22 offen offset:2304 sc1
  v_mfma_f32_16x16x32_bf16 v[68:71], a[36:39], v[88:91], v[68:71]
  ds_read_b128 v[84:87], v165 offset:16640
  v_exp_f32 v130, v130 clamp
  s_waitcnt lgkmcnt(6)
  v_mfma_f32_16x16x32_bf16 v[72:75], a[32:35], v[92:95], v[72:75]
  v_exp_f32 v131, v131 clamp
  v_mfma_f32_16x16x32_bf16 v[76:79], a[36:39], v[92:95], v[76:79]
  ds_read_b128 v[88:91], v165 offset:17408
  v_max_f32 v20, 0x358637bd, v20
  v_max_f32 v21, 0x358637bd, v21
  s_waitcnt vmcnt(13) lgkmcnt(6)
  v_mfma_f32_16x16x32_bf16 v[48:51], a[40:43], v[96:99], v[48:51]
  s_addk_i32 s22, 4096
  buffer_load_dwordx4 a[32:35], v164, s[8:11], s22 offen offset:0 sc1
  buffer_load_dwordx4 v[232:235], v3, s[8:11], s57 offen sc1
  v_max_f32 v22, 0x358637bd, v22
  v_max_f32 v23, 0x358637bd, v23
  s_waitcnt vmcnt(14)
  v_mfma_f32_16x16x32_bf16 v[52:55], a[44:47], v[96:99], v[52:55]
  ds_read_b128 v[92:95], v165 offset:17664
  v_add_f32 v20, v20, v128
  s_waitcnt lgkmcnt(6)
  v_mfma_f32_16x16x32_bf16 v[56:59], a[40:43], v[100:103], v[56:59]
  v_add_f32 v21, v21, v129
  v_add_f32 v22, v22, v130
  v_mfma_f32_16x16x32_bf16 v[60:63], a[44:47], v[100:103], v[60:63]
  ds_read_b128 v[96:99], v165 offset:20480
  v_add_f32 v23, v23, v131
  v_cvt_pk_bf16_f32 v112, v16, v17
  s_waitcnt lgkmcnt(6)
  v_mfma_f32_16x16x32_bf16 v[64:67], a[40:43], v[104:107], v[64:67]
  buffer_load_dwordx4 a[36:39], v164, s[8:11], s22 offen offset:256 sc1
  v_cvt_pk_bf16_f32 v113, v18, v19
  v_mfma_f32_16x16x32_bf16 v[68:71], a[44:47], v[104:107], v[68:71]
  ds_read_b128 v[100:103], v165 offset:20736
  v_cvt_pk_bf16_f32 v114, v20, v21
  v_cvt_pk_bf16_f32 v115, v22, v23
  s_waitcnt lgkmcnt(6)
  v_mfma_f32_16x16x32_bf16 v[72:75], a[40:43], v[108:111], v[72:75]
  v_cvt_pk_bf16_f32 v120, v32, v33
  v_cvt_pk_bf16_f32 v121, v34, v35
  v_mfma_f32_16x16x32_bf16 v[76:79], a[44:47], v[108:111], v[76:79]
  ds_read_b128 v[104:107], v165 offset:21504
  v_cvt_pk_bf16_f32 v122, v36, v37
  s_waitcnt vmcnt(14) lgkmcnt(6)
  v_mfma_f32_16x16x32_bf16 v[48:51], a[48:51], v[80:83], v[48:51]
  buffer_load_dwordx4 a[40:43], v164, s[8:11], s22 offen offset:2048 sc1
  v_cvt_pk_bf16_f32 v123, v38, v39
  v_cvt_pk_bf16_f32 v124, v40, v41
  s_waitcnt vmcnt(14)
  v_mfma_f32_16x16x32_bf16 v[52:55], a[52:55], v[80:83], v[52:55]
  ds_read_b128 v[108:111], v165 offset:21760
  v_cvt_pk_bf16_f32 v125, v42, v43
  v_cvt_pk_bf16_f32 v126, v44, v45
  s_waitcnt lgkmcnt(6)
  v_mfma_f32_16x16x32_bf16 v[56:59], a[48:51], v[84:87], v[56:59]
  v_cvt_pk_bf16_f32 v127, v46, v47
  v_mfma_f32_16x16x32_bf16 v[60:63], a[52:55], v[84:87], v[60:63]
  ds_read_b128 v[80:83], v165 offset:24576
  v_cndmask_b32 v124, v124, v8, s[30:31]
  v_cndmask_b32 v125, v125, v8, s[30:31]
  s_waitcnt lgkmcnt(6)
  v_mfma_f32_16x16x32_bf16 v[64:67], a[48:51], v[88:91], v[64:67]
  buffer_load_dwordx4 a[44:47], v164, s[8:11], s22 offen offset:2304 sc1
  v_cndmask_b32 v126, v126, v8, s[30:31]
  v_cndmask_b32 v127, v127, v8, s[30:31]
  v_mfma_f32_16x16x32_bf16 v[68:71], a[52:55], v[88:91], v[68:71]
  ds_read_b128 v[84:87], v165 offset:24832
  v_mfma_f32_16x16x32_bf16 v[136:139], v[112:115], v[120:123], 0
  s_waitcnt lgkmcnt(6)
  v_mfma_f32_16x16x32_bf16 v[72:75], a[48:51], v[92:95], v[72:75]
  v_mfma_f32_16x16x32_bf16 v[140:143], v[112:115], v[124:127], 0
  v_mul_f32 v128, 0x3fb8aa3b, v24
  v_mfma_f32_16x16x32_bf16 v[76:79], a[52:55], v[92:95], v[76:79]
  ds_read_b128 v[88:91], v165 offset:25600
  v_mul_f32 v129, 0x3fb8aa3b, v25
  v_mul_f32 v130, 0x3fb8aa3b, v26
  s_waitcnt vmcnt(14) lgkmcnt(6)
  v_mfma_f32_16x16x32_bf16 v[48:51], a[56:59], v[96:99], v[48:51]
  s_addk_i32 s22, 4096
  buffer_load_dwordx4 a[48:51], v164, s[8:11], s22 offen offset:0 sc1
  v_mul_f32 v131, 0x3fb8aa3b, v27
  s_waitcnt vmcnt(14)
  v_mfma_f32_16x16x32_bf16 v[52:55], a[60:63], v[96:99], v[52:55]
  ds_read_b128 v[92:95], v165 offset:25856
  v_exp_f32 v128, v128 clamp
  s_waitcnt lgkmcnt(6)
  v_mfma_f32_16x16x32_bf16 v[56:59], a[56:59], v[100:103], v[56:59]
  v_exp_f32 v129, v129 clamp
  v_mfma_f32_16x16x32_bf16 v[60:63], a[60:63], v[100:103], v[60:63]
  ds_read_b128 v[96:99], v165 offset:28672
  v_exp_f32 v130, v130 clamp
  s_waitcnt lgkmcnt(6)
  v_mfma_f32_16x16x32_bf16 v[64:67], a[56:59], v[104:107], v[64:67]
  buffer_load_dwordx4 a[52:55], v164, s[8:11], s22 offen offset:256 sc1
  v_exp_f32 v131, v131 clamp
  v_mfma_f32_16x16x32_bf16 v[68:71], a[60:63], v[104:107], v[68:71]
  ds_read_b128 v[100:103], v165 offset:28928
  v_max_f32 v24, 0x358637bd, v24
  s_waitcnt lgkmcnt(6)
  v_mfma_f32_16x16x32_bf16 v[72:75], a[56:59], v[108:111], v[72:75]
  v_max_f32 v25, 0x358637bd, v25
  v_max_f32 v26, 0x358637bd, v26
  v_mfma_f32_16x16x32_bf16 v[76:79], a[60:63], v[108:111], v[76:79]
  ds_read_b128 v[104:107], v165 offset:29696
  v_max_f32 v27, 0x358637bd, v27
  s_waitcnt vmcnt(14) lgkmcnt(6)
  v_mfma_f32_16x16x32_bf16 v[48:51], a[0:3], v[80:83], v[48:51]
  buffer_load_dwordx4 a[56:59], v164, s[8:11], s22 offen offset:2048 sc1
  v_add_f32 v24, v24, v128
  v_add_f32 v25, v25, v129
  s_waitcnt vmcnt(14)
  v_mfma_f32_16x16x32_bf16 v[52:55], a[4:7], v[80:83], v[52:55]
  ds_read_b128 v[108:111], v165 offset:29952
  v_add_f32 v26, v26, v130
  v_add_f32 v27, v27, v131
  s_waitcnt lgkmcnt(6)
  v_mfma_f32_16x16x32_bf16 v[56:59], a[0:3], v[84:87], v[56:59]
  v_mul_f32 v128, 0x3fb8aa3b, v28
  v_mfma_f32_16x16x32_bf16 v[60:63], a[4:7], v[84:87], v[60:63]
  ds_read_b128 v[80:83], v165 offset:32768
  v_mul_f32 v129, 0x3fb8aa3b, v29
  v_mul_f32 v130, 0x3fb8aa3b, v30
  s_waitcnt lgkmcnt(6)
  v_mfma_f32_16x16x32_bf16 v[64:67], a[0:3], v[88:91], v[64:67]
  buffer_load_dwordx4 a[60:63], v164, s[8:11], s22 offen offset:2304 sc1
  v_mul_f32 v131, 0x3fb8aa3b, v31
  v_mfma_f32_16x16x32_bf16 v[68:71], a[4:7], v[88:91], v[68:71]
  ds_read_b128 v[84:87], v165 offset:33024
  v_exp_f32 v128, v128 clamp
  s_waitcnt lgkmcnt(6)
  v_mfma_f32_16x16x32_bf16 v[72:75], a[0:3], v[92:95], v[72:75]
  v_exp_f32 v129, v129 clamp
  v_mfma_f32_16x16x32_bf16 v[76:79], a[4:7], v[92:95], v[76:79]
  ds_read_b128 v[88:91], v165 offset:33792
  v_exp_f32 v130, v130 clamp
  s_waitcnt vmcnt(14) lgkmcnt(6)
  v_mfma_f32_16x16x32_bf16 v[48:51], a[8:11], v[96:99], v[48:51]
  s_addk_i32 s22, 4096
  buffer_load_dwordx4 a[0:3], v164, s[8:11], s22 offen offset:0 sc1
  v_exp_f32 v131, v131 clamp
  s_waitcnt vmcnt(14)
  v_mfma_f32_16x16x32_bf16 v[52:55], a[12:15], v[96:99], v[52:55]
  ds_read_b128 v[92:95], v165 offset:34048
  v_max_f32 v28, 0x358637bd, v28
  s_waitcnt lgkmcnt(6)
  v_mfma_f32_16x16x32_bf16 v[56:59], a[8:11], v[100:103], v[56:59]
  v_max_f32 v29, 0x358637bd, v29
  v_max_f32 v30, 0x358637bd, v30
  v_mfma_f32_16x16x32_bf16 v[60:63], a[12:15], v[100:103], v[60:63]
  ds_read_b128 v[96:99], v165 offset:36864
  v_max_f32 v31, 0x358637bd, v31
  v_add_f32 v28, v28, v128
  s_waitcnt lgkmcnt(6)
  v_mfma_f32_16x16x32_bf16 v[64:67], a[8:11], v[104:107], v[64:67]
  buffer_load_dwordx4 a[4:7], v164, s[8:11], s22 offen offset:256 sc1
  v_add_f32 v29, v29, v129
  v_mfma_f32_16x16x32_bf16 v[68:71], a[12:15], v[104:107], v[68:71]
  ds_read_b128 v[100:103], v165 offset:37120
  v_add_f32 v30, v30, v130
  v_add_f32 v31, v31, v131
  s_waitcnt lgkmcnt(6)
  v_mfma_f32_16x16x32_bf16 v[72:75], a[8:11], v[108:111], v[72:75]
  v_cvt_pk_bf16_f32 v116, v24, v25
  v_cvt_pk_bf16_f32 v117, v26, v27
  v_mfma_f32_16x16x32_bf16 v[76:79], a[12:15], v[108:111], v[76:79]
  ds_read_b128 v[104:107], v165 offset:37888
  v_cvt_pk_bf16_f32 v118, v28, v29
  s_waitcnt vmcnt(14) lgkmcnt(6)
  v_mfma_f32_16x16x32_bf16 v[48:51], a[16:19], v[80:83], v[48:51]
  buffer_load_dwordx4 a[8:11], v164, s[8:11], s22 offen offset:2048 sc1
  v_cvt_pk_bf16_f32 v119, v30, v31
  s_nop 1
  v_mfma_f32_16x16x32_bf16 v[144:147], v[116:119], v[120:123], 0
  s_waitcnt vmcnt(14)
  v_mfma_f32_16x16x32_bf16 v[52:55], a[20:23], v[80:83], v[52:55]
  ds_read_b128 v[108:111], v165 offset:38144
  v_mfma_f32_16x16x32_bf16 v[148:151], v[116:119], v[124:127], 0
  s_waitcnt lgkmcnt(6)
  v_mfma_f32_16x16x32_bf16 v[56:59], a[16:19], v[84:87], v[56:59]
  v_mfma_f32_16x16x32_bf16 v[60:63], a[20:23], v[84:87], v[60:63]
  ds_read_b128 v[80:83], v165 offset:40960
  s_mov_b32 exec_lo, 0xff00ff00
  s_mov_b32 exec_hi, 0xff00ff00
  ds_write2_b64 v5, v[124:125], v[126:127] offset0:64 offset1:66
  s_mov_b32 exec_lo, 0xfff0fff0
  s_mov_b32 exec_hi, 0xfff0fff0
  ds_write2_b64 v5, v[116:117], v[118:119] offset1:2
  s_mov_b64 exec, -1
  s_waitcnt lgkmcnt(8)
  v_mfma_f32_16x16x32_bf16 v[64:67], a[16:19], v[88:91], v[64:67]
  buffer_load_dwordx4 a[12:15], v164, s[8:11], s22 offen offset:2304 sc1
  v_mfma_f32_16x16x32_bf16 v[68:71], a[20:23], v[88:91], v[68:71]
  ds_read_b128 v[84:87], v165 offset:41216
  ds_read_b64_tr_b16 v[152:153], v6
  s_waitcnt lgkmcnt(9)
  v_mfma_f32_16x16x32_bf16 v[72:75], a[16:19], v[92:95], v[72:75]
  ds_read_b64_tr_b16 v[154:155], v6 offset:768
  v_mfma_f32_16x16x32_bf16 v[76:79], a[20:23], v[92:95], v[76:79]
  ds_read_b128 v[88:91], v165 offset:41984
  ds_read_b64_tr_b16 v[156:157], v6 offset:512
  s_waitcnt lgkmcnt(2)
  v_lshlrev_b32 v132, 16, v154
  s_waitcnt vmcnt(14)
  v_mfma_f32_16x16x32_bf16 v[48:51], a[24:27], v[96:99], v[48:51]
  s_addk_i32 s22, 4096
  buffer_load_dwordx4 a[16:19], v164, s[8:11], s22 offen offset:0 sc1
  v_and_b32 v133, 0xffff0000, v154
  v_lshlrev_b32 v134, 16, v155
  s_waitcnt vmcnt(14)
  v_mfma_f32_16x16x32_bf16 v[52:55], a[28:31], v[96:99], v[52:55]
  ds_read_b128 v[92:95], v165 offset:42240
  v_and_b32 v135, 0xffff0000, v155
  v_mfma_f32_16x16x32_bf16 v[56:59], a[24:27], v[100:103], v[56:59]
  v_mul_f32 v128, 0x3fb8aa3b, v132
  v_mul_f32 v129, 0x3fb8aa3b, v133
  v_mfma_f32_16x16x32_bf16 v[60:63], a[28:31], v[100:103], v[60:63]
  ds_read_b128 v[96:99], v165 offset:45056
  v_mul_f32 v130, 0x3fb8aa3b, v134
  v_mul_f32 v131, 0x3fb8aa3b, v135
  v_mfma_f32_16x16x32_bf16 v[64:67], a[24:27], v[104:107], v[64:67]
  buffer_load_dwordx4 a[20:23], v164, s[8:11], s22 offen offset:256 sc1
  v_exp_f32 v128, v128 clamp
  v_mfma_f32_16x16x32_bf16 v[68:71], a[28:31], v[104:107], v[68:71]
  ds_read_b128 v[100:103], v165 offset:45312
  v_exp_f32 v129, v129 clamp
  v_mfma_f32_16x16x32_bf16 v[72:75], a[24:27], v[108:111], v[72:75]
  v_mfma_f32_16x16x32_bf16 v[76:79], a[28:31], v[108:111], v[76:79]
  ds_read_b128 v[104:107], v165 offset:46080
  v_exp_f32 v130, v130 clamp
  s_waitcnt vmcnt(14)
  v_mfma_f32_16x16x32_bf16 v[48:51], a[32:35], v[80:83], v[48:51]
  buffer_load_dwordx4 a[24:27], v164, s[8:11], s22 offen offset:2048 sc1
  v_exp_f32 v131, v131 clamp
  s_waitcnt vmcnt(13)
  v_mfma_f32_16x16x32_bf16 v[52:55], a[36:39], v[80:83], v[52:55]
  ds_read_b128 v[108:111], v165 offset:46336
  v_max_f32 v132, 0x358637bd, v132
  v_max_f32 v133, 0x358637bd, v133
  v_mfma_f32_16x16x32_bf16 v[56:59], a[32:35], v[84:87], v[56:59]
  v_max_f32 v134, 0x358637bd, v134
  v_max_f32 v135, 0x358637bd, v135
  v_mfma_f32_16x16x32_bf16 v[60:63], a[36:39], v[84:87], v[60:63]
  ds_read_b128 v[80:83], v165 offset:49152
  v_add_f32 v132, v132, v128
  s_waitcnt lgkmcnt(7)
  v_mfma_f32_16x16x32_bf16 v[64:67], a[32:35], v[88:91], v[64:67]
  buffer_load_dwordx4 a[28:31], v164, s[8:11], s22 offen offset:2304 sc1
  v_add_f32 v133, v133, v129
  v_add_f32 v134, v134, v130
  v_mfma_f32_16x16x32_bf16 v[68:71], a[36:39], v[88:91], v[68:71]
  ds_read_b128 v[84:87], v165 offset:49408
  v_add_f32 v135, v135, v131
  v_cvt_pk_bf16_f32 v154, v132, v133
  s_waitcnt lgkmcnt(6)
  v_mfma_f32_16x16x32_bf16 v[72:75], a[32:35], v[92:95], v[72:75]
  v_cvt_pk_bf16_f32 v155, v134, v135
  v_mfma_f32_16x16x32_bf16 v[76:79], a[36:39], v[92:95], v[76:79]
  ds_read_b128 v[88:91], v165 offset:50176
  buffer_store_dwordx4 v[152:155], v3, s[8:11], s26 offen sc1
  buffer_store_dword v156, v7, s[8:11], s27 offen sc1
  s_waitcnt vmcnt(15) lgkmcnt(6)
  v_mfma_f32_16x16x32_bf16 v[48:51], a[40:43], v[96:99], v[48:51]
  s_barrier
  v_xor_b32 v232, s3, v232
  v_xor_b32 v233, s3, v233
  s_waitcnt vmcnt(14)
  v_mfma_f32_16x16x32_bf16 v[52:55], a[44:47], v[96:99], v[52:55]
  ds_read_b128 v[92:95], v165 offset:50432
  v_xor_b32 v234, s3, v234
  v_xor_b32 v235, s3, v235
  s_waitcnt lgkmcnt(6)
  v_mfma_f32_16x16x32_bf16 v[56:59], a[40:43], v[100:103], v[56:59]
  v_or3_b32 v232, v232, v233, v234
  v_or_b32 v232, v232, v235
  v_mfma_f32_16x16x32_bf16 v[60:63], a[44:47], v[100:103], v[60:63]
  ds_read_b128 v[96:99], v165 offset:53248
  v_cmp_ne_u32 vcc, 0, v232
  buffer_load_dwordx4 a[224:227], v3, s[8:11], s50 offen offset:0 sc1
  s_waitcnt lgkmcnt(6)
  v_mfma_f32_16x16x32_bf16 v[64:67], a[40:43], v[104:107], v[64:67]
  v_mfma_f32_16x16x32_bf16 v[68:71], a[44:47], v[104:107], v[68:71]
  ds_read_b128 v[100:103], v165 offset:53504
  s_cbranch_vccnz L_f2_w
L_f2_k:
  s_waitcnt lgkmcnt(6)
  v_mfma_f32_16x16x32_bf16 v[72:75], a[40:43], v[108:111], v[72:75]
  v_mfma_f32_16x16x32_bf16 v[76:79], a[44:47], v[108:111], v[76:79]
  ds_read_b128 v[104:107], v165 offset:54272
  s_waitcnt vmcnt(14) lgkmcnt(6)
  v_mfma_f32_16x16x32_bf16 v[48:51], a[48:51], v[80:83], v[48:51]
  s_waitcnt vmcnt(13)
  v_mfma_f32_16x16x32_bf16 v[52:55], a[52:55], v[80:83], v[52:55]
  ds_read_b128 v[108:111], v165 offset:54528
  buffer_load_dwordx4 a[204:207], v3, s[8:11], s50 offen offset:1024 sc1
  s_waitcnt lgkmcnt(6)
  v_mfma_f32_16x16x32_bf16 v[56:59], a[48:51], v[84:87], v[56:59]
  v_mfma_f32_16x16x32_bf16 v[60:63], a[52:55], v[84:87], v[60:63]
  ds_read_b128 v[80:83], v165 offset:57344
  s_waitcnt lgkmcnt(6)
  v_mfma_f32_16x16x32_bf16 v[64:67], a[48:51], v[88:91], v[64:67]
  s_and_b32 s64, s2, 3
  s_lshl_b32 s64, s64, 1
  s_bfe_u32 s65, s2, 0x10003
  s_add_u32 s64, s64, s65
  s_lshl_b32 s64, s64, 2
  s_add_u32 s64, s64, s16
  s_mul_i32 s64, s64, 336896
  s_lshr_b32 s65, s2, 4
  s_mul_i32 s65, s65, 3072
  s_add_u32 s64, s64, s65
  s_add_u32 s64, s64, 140509184
  buffer_load_dwordx4 v[168:171], v3, s[8:11], s64 offen offset:0 sc1
  buffer_load_dwordx4 v[172:175], v3, s[8:11], s64 offen offset:1024 sc1
  buffer_load_dwordx4 v[176:179], v3, s[8:11], s64 offen offset:2048 sc1
  v_mfma_f32_16x16x32_bf16 v[68:71], a[52:55], v[88:91], v[68:71]
  ds_read_b128 v[84:87], v165 offset:57600
  s_waitcnt lgkmcnt(6)
  v_mfma_f32_16x16x32_bf16 v[72:75], a[48:51], v[92:95], v[72:75]
  v_mfma_f32_16x16x32_bf16 v[76:79], a[52:55], v[92:95], v[76:79]
  ds_read_b128 v[88:91], v165 offset:58368
  buffer_load_dwordx4 a[184:187], v3, s[8:11], s50 offen offset:2048 sc1
  s_waitcnt vmcnt(17) lgkmcnt(6)
  v_mfma_f32_16x16x32_bf16 v[48:51], a[56:59], v[96:99], v[48:51]
  s_waitcnt vmcnt(16)
  v_mfma_f32_16x16x32_bf16 v[52:55], a[60:63], v[96:99], v[52:55]
  ds_read_b128 v[92:95], v165 offset:58624
  s_waitcnt lgkmcnt(6)
  v_mfma_f32_16x16x32_bf16 v[56:59], a[56:59], v[100:103], v[56:59]
  v_mfma_f32_16x16x32_bf16 v[60:63], a[60:63], v[100:103], v[60:63]
  ds_read_b128 v[96:99], v165 offset:61440
  s_waitcnt lgkmcnt(6)
  v_mfma_f32_16x16x32_bf16 v[64:67], a[56:59], v[104:107], v[64:67]
  v_mfma_f32_16x16x32_bf16 v[68:71], a[60:63], v[104:107], v[68:71]
  ds_read_b128 v[100:103], v165 offset:61696
  buffer_load_dwordx4 a[164:167], v3, s[8:11], s50 offen offset:3072 sc1
  s_waitcnt lgkmcnt(6)
  v_mfma_f32_16x16x32_bf16 v[72:75], a[56:59], v[108:111], v[72:75]
  v_mfma_f32_16x16x32_bf16 v[76:79], a[60:63], v[108:111], v[76:79]
  ds_read_b128 v[104:107], v165 offset:62464
  s_waitcnt vmcnt(16) lgkmcnt(6)
  v_mfma_f32_16x16x32_bf16 v[48:51], a[0:3], v[80:83], v[48:51]
  s_waitcnt vmcnt(15)
  v_mfma_f32_16x16x32_bf16 v[52:55], a[4:7], v[80:83], v[52:55]
  ds_read_b128 v[108:111], v165 offset:62720
  s_waitcnt lgkmcnt(6)
  v_mfma_f32_16x16x32_bf16 v[56:59], a[0:3], v[84:87], v[56:59]
  v_mfma_f32_16x16x32_bf16 v[60:63], a[4:7], v[84:87], v[60:63]
  ds_read_b128 v[80:83], v166 offset:0
  s_waitcnt lgkmcnt(6)
  v_mfma_f32_16x16x32_bf16 v[64:67], a[0:3], v[88:91], v[64:67]
  v_mfma_f32_16x16x32_bf16 v[68:71], a[4:7], v[88:91], v[68:71]
  ds_read_b128 v[84:87], v166 offset:256
  s_waitcnt lgkmcnt(6)
  v_mfma_f32_16x16x32_bf16 v[72:75], a[0:3], v[92:95], v[72:75]
  v_mfma_f32_16x16x32_bf16 v[76:79], a[4:7], v[92:95], v[76:79]
  ds_read_b128 v[88:91], v166 offset:1024
  s_addk_i32 s50, 4096
  buffer_load_dwordx4 a[144:147], v3, s[8:11], s50 offen offset:0 sc1
  s_waitcnt vmcnt(15) lgkmcnt(6)
  v_mfma_f32_16x16x32_bf16 v[48:51], a[8:11], v[96:99], v[48:51]
  s_waitcnt vmcnt(14)
  v_mfma_f32_16x16x32_bf16 v[52:55], a[12:15], v[96:99], v[52:55]
  ds_read_b128 v[92:95], v166 offset:1280
  s_waitcnt lgkmcnt(6)
  v_mfma_f32_16x16x32_bf16 v[56:59], a[8:11], v[100:103], v[56:59]
  v_mfma_f32_16x16x32_bf16 v[60:63], a[12:15], v[100:103], v[60:63]
  ds_read_b128 v[96:99], v166 offset:4096
  s_waitcnt lgkmcnt(6)
  v_mfma_f32_16x16x32_bf16 v[64:67], a[8:11], v[104:107], v[64:67]
  v_mfma_f32_16x16x32_bf16 v[68:71], a[12:15], v[104:107], v[68:71]
  ds_read_b128 v[100:103], v166 offset:4352
  s_waitcnt lgkmcnt(6)
  v_mfma_f32_16x16x32_bf16 v[72:75], a[8:11], v[108:111], v[72:75]
  v_mfma_f32_16x16x32_bf16 v[76:79], a[12:15], v[108:111], v[76:79]
  ds_read_b128 v[104:107], v166 offset:5120
  s_waitcnt vmcnt(13) lgkmcnt(6)
  v_mfma_f32_16x16x32_bf16 v[48:51], a[16:19], v[80:83], v[48:51]
  buffer_load_dwordx4 a[124:127], v3, s[8:11], s50 offen offset:1024 sc1
  s_waitcnt vmcnt(13)
  v_mfma_f32_16x16x32_bf16 v[52:55], a[20:23], v[80:83], v[52:55]
  ds_read_b128 v[108:111], v166 offset:5376
  s_waitcnt lgkmcnt(6)
  v_mfma_f32_16x16x32_bf16 v[56:59], a[16:19], v[84:87], v[56:59]
  v_mfma_f32_16x16x32_bf16 v[60:63], a[20:23], v[84:87], v[60:63]
  s_waitcnt lgkmcnt(5)
  v_mfma_f32_16x16x32_bf16 v[64:67], a[16:19], v[88:91], v[64:67]
  v_mfma_f32_16x16x32_bf16 v[68:71], a[20:23], v[88:91], v[68:71]
  s_waitcnt lgkmcnt(4)
  v_mfma_f32_16x16x32_bf16 v[72:75], a[16:19], v[92:95], v[72:75]
  buffer_load_dwordx4 a[104:107], v3, s[8:11], s50 offen offset:2048 sc1
  v_mfma_f32_16x16x32_bf16 v[76:79], a[20:23], v[92:95], v[76:79]
  s_waitcnt vmcnt(13) lgkmcnt(3)
  v_mfma_f32_16x16x32_bf16 v[48:51], a[24:27], v[96:99], v[48:51]
  s_waitcnt vmcnt(12)
  v_mfma_f32_16x16x32_bf16 v[52:55], a[28:31], v[96:99], v[52:55]
  s_waitcnt lgkmcnt(2)
  v_mfma_f32_16x16x32_bf16 v[56:59], a[24:27], v[100:103], v[56:59]
  v_mfma_f32_16x16x32_bf16 v[60:63], a[28:31], v[100:103], v[60:63]
  s_waitcnt lgkmcnt(1)
  v_mfma_f32_16x16x32_bf16 v[64:67], a[24:27], v[104:107], v[64:67]
  buffer_load_dwordx4 a[84:87], v3, s[8:11], s50 offen offset:3072 sc1
  v_mfma_f32_16x16x32_bf16 v[68:71], a[28:31], v[104:107], v[68:71]
  s_waitcnt lgkmcnt(0)
  v_mfma_f32_16x16x32_bf16 v[72:75], a[24:27], v[108:111], v[72:75]
  v_mfma_f32_16x16x32_bf16 v[76:79], a[28:31], v[108:111], v[76:79]
  v_mul_f32 v128, 0x3fb8aa3b, v48
  v_mul_f32 v129, 0x3fb8aa3b, v49
  v_mul_f32 v130, 0x3fb8aa3b, v50
  v_mul_f32 v131, 0x3fb8aa3b, v51
  v_exp_f32 v128, v128 clamp
  v_exp_f32 v129, v129 clamp
  s_addk_i32 s50, 4096
  buffer_load_dwordx4 a[64:67], v3, s[8:11], s50 offen offset:0 sc1
  v_exp_f32 v130, v130 clamp
  v_exp_f32 v131, v131 clamp
  v_max_f32 v48, 0x358637bd, v48
  v_max_f32 v49, 0x358637bd, v49
  v_max_f32 v50, 0x358637bd, v50
  v_max_f32 v51, 0x358637bd, v51
  v_add_f32 v48, v48, v128
  v_add_f32 v49, v49, v129
  v_add_f32 v50, v50, v130
  v_add_f32 v51, v51, v131
  s_add_u32 s50, s50, 28672
  buffer_load_dwordx4 a[228:231], v3, s[8:11], s50 offen offset:0 sc1
  v_mul_f32 v128, 0x3fb8aa3b, v52
  v_mul_f32 v129, 0x3fb8aa3b, v53
  v_mul_f32 v130, 0x3fb8aa3b, v54
  v_mul_f32 v131, 0x3fb8aa3b, v55
  v_exp_f32 v128, v128 clamp
  v_exp_f32 v129, v129 clamp
  v_exp_f32 v130, v130 clamp
  buffer_load_dwordx4 a[208:211], v3, s[8:11], s50 offen offset:1024 sc1
  v_exp_f32 v131, v131 clamp
  v_max_f32 v52, 0x358637bd, v52
  v_max_f32 v53, 0x358637bd, v53
  v_max_f32 v54, 0x358637bd, v54
  v_max_f32 v55, 0x358637bd, v55
  v_add_f32 v52, v52, v128
  buffer_load_dwordx4 a[188:191], v3, s[8:11], s50 offen offset:2048 sc1
  v_add_f32 v53, v53, v129
  v_add_f32 v54, v54, v130
  v_add_f32 v55, v55, v131
  v_cvt_pk_bf16_f32 v112, v48, v49
  v_cvt_pk_bf16_f32 v113, v50, v51
  buffer_load_dwordx4 a[168:171], v3, s[8:11], s50 offen offset:3072 sc1
  v_cvt_pk_bf16_f32 v114, v52, v53
  v_cvt_pk_bf16_f32 v115, v54, v55
  v_cvt_pk_bf16_f32 v120, v64, v65
  v_cvt_pk_bf16_f32 v121, v66, v67
  v_cvt_pk_bf16_f32 v122, v68, v69
  v_cvt_pk_bf16_f32 v123, v70, v71
  v_cvt_pk_bf16_f32 v124, v72, v73
  s_addk_i32 s50, 4096
  buffer_load_dwordx4 a[148:151], v3, s[8:11], s50 offen offset:0 sc1
  v_cvt_pk_bf16_f32 v125, v74, v75
  v_cvt_pk_bf16_f32 v126, v76, v77
  v_cvt_pk_bf16_f32 v127, v78, v79
  v_cndmask_b32 v124, v124, v8, s[30:31]
  v_cndmask_b32 v125, v125, v8, s[30:31]
  v_cndmask_b32 v126, v126, v8, s[30:31]
  v_cndmask_b32 v127, v127, v8, s[30:31]
  v_mfma_f32_16x16x32_bf16 v[136:139], v[112:115], v[120:123], v[136:139]
  buffer_load_dwordx4 a[128:131], v3, s[8:11], s50 offen offset:1024 sc1
  v_mfma_f32_16x16x32_bf16 v[140:143], v[112:115], v[124:127], v[140:143]
  v_mul_f32 v128, 0x3fb8aa3b, v56
  v_mul_f32 v129, 0x3fb8aa3b, v57
  v_mul_f32 v130, 0x3fb8aa3b, v58
  v_mul_f32 v131, 0x3fb8aa3b, v59
  buffer_load_dwordx4 a[108:111], v3, s[8:11], s50 offen offset:2048 sc1
  v_exp_f32 v128, v128 clamp
  v_exp_f32 v129, v129 clamp
  v_exp_f32 v130, v130 clamp
  v_exp_f32 v131, v131 clamp
  v_max_f32 v56, 0x358637bd, v56
  buffer_load_dwordx4 a[88:91], v3, s[8:11], s50 offen offset:3072 sc1
  v_max_f32 v57, 0x358637bd, v57
  v_max_f32 v58, 0x358637bd, v58
  v_max_f32 v59, 0x358637bd, v59
  v_add_f32 v56, v56, v128
  v_add_f32 v57, v57, v129
  v_add_f32 v58, v58, v130
  v_add_f32 v59, v59, v131
  v_mul_f32 v128, 0x3fb8aa3b, v60
  s_addk_i32 s50, 4096
  buffer_load_dwordx4 a[68:71], v3, s[8:11], s50 offen offset:0 sc1
  v_mul_f32 v129, 0x3fb8aa3b, v61
  v_mul_f32 v130, 0x3fb8aa3b, v62
  v_mul_f32 v131, 0x3fb8aa3b, v63
  v_exp_f32 v128, v128 clamp
  v_exp_f32 v129, v129 clamp
  v_exp_f32 v130, v130 clamp
  v_exp_f32 v131, v131 clamp
  v_max_f32 v60, 0x358637bd, v60
  v_max_f32 v61, 0x358637bd, v61
  v_max_f32 v62, 0x358637bd, v62
  s_add_u32 s50, s50, 28672
  buffer_load_dwordx4 a[232:235], v3, s[8:11], s50 offen offset:0 sc1
  v_max_f32 v63, 0x358637bd, v63
  v_add_f32 v60, v60, v128
  v_add_f32 v61, v61, v129
  v_add_f32 v62, v62, v130
  v_add_f32 v63, v63, v131
  v_cvt_pk_bf16_f32 v116, v56, v57
  v_cvt_pk_bf16_f32 v117, v58, v59
  v_cvt_pk_bf16_f32 v118, v60, v61
  buffer_load_dwordx4 a[212:215], v3, s[8:11], s50 offen offset:1024 sc1
  v_cvt_pk_bf16_f32 v119, v62, v63
  s_nop 1
  v_mfma_f32_16x16x32_bf16 v[144:147], v[116:119], v[120:123], v[144:147]
  v_mfma_f32_16x16x32_bf16 v[148:151], v[116:119], v[124:127], v[148:151]
  s_mov_b32 exec_lo, 0xff00ff00
  s_mov_b32 exec_hi, 0xff00ff00
  ds_write2_b64 v5, v[124:125], v[126:127] offset0:64 offset1:66
  s_mov_b32 exec_lo, 0xfff0fff0
  s_mov_b32 exec_hi, 0xfff0fff0
  ds_write2_b64 v5, v[116:117], v[118:119] offset1:2
  s_mov_b64 exec, -1
  ds_read_b64_tr_b16 v[152:153], v6
  buffer_load_dwordx4 a[192:195], v3, s[8:11], s50 offen offset:2048 sc1
  ds_read_b64_tr_b16 v[154:155], v6 offset:768
  ds_read_b64_tr_b16 v[156:157], v6 offset:512
  ds_write_b128 v15, v[136:139]
  ds_write_b128 v15, v[140:143] offset:256
  s_mov_b32 exec_hi, 0
  ds_write_b64 v14, v[144:145] offset:2048
  ds_write_b64 v14, v[148:149] offset:2176
  s_mov_b64 exec, -1
  buffer_load_dwordx4 a[172:175], v3, s[8:11], s50 offen offset:3072 sc1
  s_addk_i32 s50, 4096
  buffer_load_dwordx4 a[152:155], v3, s[8:11], s50 offen offset:0 sc1
  buffer_load_dwordx4 a[132:135], v3, s[8:11], s50 offen offset:1024 sc1
  buffer_load_dwordx4 a[112:115], v3, s[8:11], s50 offen offset:2048 sc1
  buffer_load_dwordx4 a[92:95], v3, s[8:11], s50 offen offset:3072 sc1
  s_addk_i32 s50, 4096
  buffer_load_dwordx4 a[72:75], v3, s[8:11], s50 offen offset:0 sc1
  s_add_u32 s50, s50, 28672
  buffer_load_dwordx4 a[236:239], v3, s[8:11], s50 offen offset:0 sc1
  s_waitcnt lgkmcnt(0)
  s_barrier
  ds_read_b32 v16, v13 offset:0
  ds_read_b32 v17, v13 offset:2560
  ds_read_b32 v18, v13 offset:5120
  ds_read_b32 v19, v13 offset:7680
  ds_read_b32 v20, v13 offset:1024
  ds_read_b32 v21, v13 offset:3584
  ds_read_b32 v22, v13 offset:6144
  ds_read_b32 v23, v13 offset:8704
  ds_read_b32 v24, v13 offset:2048
  ds_read_b32 v25, v13 offset:4608
  ds_read_b32 v26, v13 offset:7168
  ds_read_b32 v27, v13 offset:9728
  v_lshlrev_b32 v132, 16, v154
  v_and_b32 v133, 0xffff0000, v154
  v_lshlrev_b32 v134, 16, v155
  v_and_b32 v135, 0xffff0000, v155
  v_mul_f32 v128, 0x3fb8aa3b, v132
  v_mul_f32 v129, 0x3fb8aa3b, v133
  v_mul_f32 v130, 0x3fb8aa3b, v134
  v_mul_f32 v131, 0x3fb8aa3b, v135
  v_exp_f32 v128, v128 clamp
  v_exp_f32 v129, v129 clamp
  v_exp_f32 v130, v130 clamp
  v_exp_f32 v131, v131 clamp
  v_max_f32 v132, 0x358637bd, v132
  v_max_f32 v133, 0x358637bd, v133
  v_max_f32 v134, 0x358637bd, v134
  v_max_f32 v135, 0x358637bd, v135
  v_add_f32 v132, v132, v128
  v_add_f32 v133, v133, v129
  v_add_f32 v134, v134, v130
  v_add_f32 v135, v135, v131
  v_cvt_pk_bf16_f32 v154, v132, v133
  v_cvt_pk_bf16_f32 v155, v134, v135
  s_waitcnt lgkmcnt(10)
  v_add_f32 v16, v16, v17
  s_waitcnt lgkmcnt(8)
  v_add_f32 v18, v18, v19
  v_add_f32 v16, v16, v18
  s_waitcnt lgkmcnt(6)
  v_add_f32 v20, v20, v21
  s_waitcnt lgkmcnt(4)
  v_add_f32 v22, v22, v23
  v_add_f32 v20, v20, v22
  s_waitcnt lgkmcnt(2)
  v_add_f32 v24, v24, v25
  s_waitcnt lgkmcnt(0)
  v_add_f32 v26, v26, v27
  v_add_f32 v24, v24, v26
  s_mov_b64 exec, s[34:35]
  buffer_atomic_add_f32 v16, v13, s[8:11], s28 offen
  buffer_atomic_add_f32 v20, v13, s[8:11], s28 offen offset:1024
  s_mov_b64 exec, -1
  s_add_u32 s26, s26, 32768
  s_add_u32 s27, s27, 8192
  buffer_store_dwordx4 v[152:155], v3, s[8:11], s26 offen sc1
  buffer_store_dword v156, v7, s[8:11], s27 offen sc1
  s_cmp_eq_u32 s16, 0
  s_cbranch_scc0 L_a0_end
  s_mov_b64 exec, s[38:39]
  buffer_atomic_add_f32 v24, v13, s[8:11], s28 offen offset:2048
  s_mov_b64 exec, -1
L_a0_end:
  s_branch L_ab
L_f2_w:
  s_mov_b32 s49, 0x40000
L_f2_l:
  s_nop 15
  s_nop 15
  s_nop 15
  s_nop 15
  s_nop 15
  s_nop 15
  s_nop 15
  s_nop 15
  buffer_load_dwordx4 v[232:235], v3, s[8:11], s57 offen sc1
  s_waitcnt vmcnt(0)
  v_xor_b32 v232, s3, v232
  v_xor_b32 v233, s3, v233
  v_xor_b32 v234, s3, v234
  v_xor_b32 v235, s3, v235
  v_or3_b32 v232, v232, v233, v234
  v_or_b32 v232, v232, v235
  v_cmp_ne_u32 vcc, 0, v232
  s_sub_u32 s49, s49, 1
  s_cmp_eq_u32 s49, 0
  s_cbranch_scc1 L_f2_k
  s_nop 2
  s_cbranch_vccnz L_f2_l
  s_branch L_f2_k
L_a1:
  s_and_b32 s17, s2, 7
  s_lshr_b32 s18, s2, 3
  s_lshr_b32 s19, s17, 2
  s_lshl_b32 s19, s19, 2
  s_and_b32 s20, s18, 3
  s_add_u32 s19, s19, s20
  s_and_b32 s20, s17, 3
  s_lshl_b32 s20, s20, 3
  s_lshr_b32 s21, s18, 2
  s_add_u32 s20, s20, s21
  s_lshl_b32 s21, s19, 3
  s_lshl_b32 s22, s16, 1
  s_add_u32 s21, s21, s22
  s_mul_i32 s22, s21, 36864
  s_add_u32 s22, s22, 33554432
  v_lshlrev_b32 v13, 2, v0
  v_add_u32 v4, 65536, v3
  s_mul_i32 s28, s16, 1280
  s_add_u32 s28, s28, 72448
  v_and_b32 v5, 31, v2
  v_lshlrev_b32 v5, 6, v5
  v_lshrrev_b32 v9, 5, v2
  v_lshl_add_u32 v5, v9, 5, v5
  v_add_u32 v5, s28, v5
  v_bfe_u32 v6, v2, 2, 2
  v_lshl_add_u32 v6, v9, 2, v6
  v_lshlrev_b32 v6, 6, v6
  v_and_b32 v7, 1, v2
  v_lshl_add_u32 v6, v7, 5, v6
  v_bfe_u32 v7, v2, 4, 1
  v_lshl_add_u32 v6, v7, 4, v6
  v_bfe_u32 v7, v2, 1, 1
  v_lshl_add_u32 v6, v7, 3, v6
  s_add_u32 s28, s28, 1280
  v_add_u32 v6, s28, v6
  v_lshlrev_b32 v7, 2, v2
  s_mul_i32 s28, s16, 2560
  v_add_u32 v15, s28, v3
  v_lshlrev_b32 v14, 3, v2
  v_add_u32 v14, s28, v14
  v_and_b32 v8, 27, v2
  v_cmp_eq_u32 s[30:31], 18, v8
  v_mov_b32 v8, 0x3f803f80
  s_mov_b32 s32, 0xfff00000
  s_mov_b32 s33, 0xfff00000
  s_lshl_b32 s26, s21, 5
  s_add_u32 s26, s26, s20
  s_lshl_b32 s27, s26, 8
  s_lshl_b32 s26, s26, 10
  s_add_u32 s26, s26, 40632320
  s_add_u32 s27, s27, 42729472
  v_and_b32 v5, 15, v2
  v_lshrrev_b32 v9, 4, v2
  v_lshlrev_b32 v164, 4, v5
  v_lshl_add_u32 v164, v9, 9, v164
  v_add_u32 v15, s28, v164
  v_and_b32 v9, 1, v9
  v_lshlrev_b32 v14, 3, v5
  v_lshl_add_u32 v14, v9, 8, v14
  v_add_u32 v14, s28, v14
  v_lshlrev_b32 v5, 6, v5
  v_lshl_add_u32 v5, v9, 5, v5
  v_lshrrev_b32 v9, 5, v2
  v_lshl_add_u32 v5, v9, 3, v5
  s_mul_i32 s28, s16, 1280
  s_add_u32 s28, s28, 73472
  v_add_u32 v5, s28, v5
  v_lshl_add_u32 v165, v9, 10, v164
  v_add_u32 v166, 65536, v165
  v_and_b32 v9, 11, v2
  v_cmp_eq_u32 s[30:31], 2, v9
  s_lshr_b32 s51, s2, 6
  s_mul_i32 s52, s51, 5
  s_lshl_b32 s53, s51, 2
  s_add_u32 s53, s53, 2
  s_cmp_lt_u32 s51, 2
  s_cselect_b32 s52, s52, s53
  s_mul_i32 s50, s52, 36864
  s_mul_i32 s53, s16, 9216
  s_add_u32 s50, s50, s53
  s_add_u32 s50, s50, 138412032
  s_lshl_b32 s28, s19, 2
  s_bfe_u32 s29, s2, 0x20000
  s_add_u32 s28, s28, s29
  s_lshl_b32 s28, s28, 9
  s_add_u32 s28, s28, 43384832
  v_lshlrev_b32 v10, 7, v2
  s_mov_b32 s49, 0x40000
  s_waitcnt vmcnt(0)
  s_cmp_eq_u32 s16, 0
  s_cbranch_scc1 L_da_w0
  s_sub_u32 s29, s16, 1
  s_mul_i32 s56, s29, 24576
  s_mul_i32 s57, s20, 73728
  s_add_u32 s57, s57, s56
  s_add_u32 s57, s57, 134217728
  s_add_u32 m0, s56, 0
  s_nop 0
  buffer_load_dwordx4 v3, s[8:11], s57 offen offset:0 sc1 lds
  buffer_load_dwordx4 v3, s[8:11], s57 offen offset:1024 sc1 lds
  buffer_load_dwordx4 v3, s[8:11], s57 offen offset:2048 sc1 lds
  buffer_load_dwordx4 v3, s[8:11], s57 offen offset:3072 sc1 lds
  s_addk_i32 s57, 4096
  s_add_u32 m0, s56, 4096
  s_nop 0
  buffer_load_dwordx4 v3, s[8:11], s57 offen offset:0 sc1 lds
  buffer_load_dwordx4 v3, s[8:11], s57 offen offset:1024 sc1 lds
  buffer_load_dwordx4 v3, s[8:11], s57 offen offset:2048 sc1 lds
  buffer_load_dwordx4 v3, s[8:11], s57 offen offset:3072 sc1 lds
  s_addk_i32 s57, 4096
  s_add_u32 m0, s56, 8192
  s_nop 0
  buffer_load_dwordx4 v3, s[8:11], s57 offen offset:0 sc1 lds
  buffer_load_dwordx4 v3, s[8:11], s57 offen offset:1024 sc1 lds
  buffer_load_dwordx4 v3, s[8:11], s57 offen offset:2048 sc1 lds
  buffer_load_dwordx4 v3, s[8:11], s57 offen offset:3072 sc1 lds
  s_addk_i32 s57, 4096
  s_add_u32 m0, s56, 12288
  s_nop 0
  buffer_load_dwordx4 v3, s[8:11], s57 offen offset:0 sc1 lds
  buffer_load_dwordx4 v3, s[8:11], s57 offen offset:1024 sc1 lds
  buffer_load_dwordx4 v3, s[8:11], s57 offen offset:2048 sc1 lds
  buffer_load_dwordx4 v3, s[8:11], s57 offen offset:3072 sc1 lds
  s_addk_i32 s57, 4096
  s_add_u32 m0, s56, 16384
  s_nop 0
  buffer_load_dwordx4 v3, s[8:11], s57 offen offset:0 sc1 lds
  buffer_load_dwordx4 v3, s[8:11], s57 offen offset:1024 sc1 lds
  buffer_load_dwordx4 v3, s[8:11], s57 offen offset:2048 sc1 lds
  buffer_load_dwordx4 v3, s[8:11], s57 offen offset:3072 sc1 lds
  s_addk_i32 s57, 4096
  s_add_u32 m0, s56, 20480
  s_nop 0
  buffer_load_dwordx4 v3, s[8:11], s57 offen offset:0 sc1 lds
  buffer_load_dwordx4 v3, s[8:11], s57 offen offset:1024 sc1 lds
  buffer_load_dwordx4 v3, s[8:11], s57 offen offset:2048 sc1 lds
  buffer_load_dwordx4 v3, s[8:11], s57 offen offset:3072 sc1 lds
  buffer_load_dwordx4 a[224:227], v3, s[8:11], s50 offen offset:0 sc1
  buffer_load_dwordx4 a[204:207], v3, s[8:11], s50 offen offset:1024 sc1
  buffer_load_dwordx4 a[184:187], v3, s[8:11], s50 offen offset:2048 sc1
  buffer_load_dwordx4 a[164:167], v3, s[8:11], s50 offen offset:3072 sc1
  s_addk_i32 s50, 4096
  buffer_load_dwordx4 a[144:147], v3, s[8:11], s50 offen offset:0 sc1
  buffer_load_dwordx4 a[124:127], v3, s[8:11], s50 offen offset:1024 sc1
  buffer_load_dwordx4 a[104:107], v3, s[8:11], s50 offen offset:2048 sc1
  buffer_load_dwordx4 a[84:87], v3, s[8:11], s50 offen offset:3072 sc1
  s_waitcnt vmcnt(8)
  s_branch L_da_go
L_da_w0:
  buffer_load_dwordx4 a[224:227], v3, s[8:11], s50 offen offset:0 sc1
  buffer_load_dwordx4 a[204:207], v3, s[8:11], s50 offen offset:1024 sc1
  buffer_load_dwordx4 a[184:187], v3, s[8:11], s50 offen offset:2048 sc1
  buffer_load_dwordx4 a[164:167], v3, s[8:11], s50 offen offset:3072 sc1
  s_addk_i32 s50, 4096
  buffer_load_dwordx4 a[144:147], v3, s[8:11], s50 offen offset:0 sc1
  buffer_load_dwordx4 a[124:127], v3, s[8:11], s50 offen offset:1024 sc1
  buffer_load_dwordx4 a[104:107], v3, s[8:11], s50 offen offset:2048 sc1
  buffer_load_dwordx4 a[84:87], v3, s[8:11], s50 offen offset:3072 sc1
  s_mov_b64 exec, 15
L_da_poll:
  buffer_load_dword v250, v10, s[8:11], s28 offen sc1
  s_waitcnt vmcnt(0)
  v_cmp_gt_u32 vcc, 8, v250
  s_nop 4
  s_cbranch_vccz L_da_ok
  s_sub_u32 s49, s49, 1
  s_cmp_eq_u32 s49, 0
  s_cbranch_scc0 L_da_poll
L_da_ok:
  s_mov_b64 exec, -1
L_da_go:
  s_barrier
  buffer_load_dwordx4 a[0:3], v164, s[8:11], s22 offen offset:0 sc1
  buffer_load_dwordx4 a[4:7], v164, s[8:11], s22 offen offset:256 sc1
  buffer_load_dwordx4 a[8:11], v164, s[8:11], s22 offen offset:2048 sc1
  buffer_load_dwordx4 a[12:15], v164, s[8:11], s22 offen offset:2304 sc1
  s_addk_i32 s22, 4096
  buffer_load_dwordx4 a[16:19], v164, s[8:11], s22 offen offset:0 sc1
  buffer_load_dwordx4 a[20:23], v164, s[8:11], s22 offen offset:256 sc1
  buffer_load_dwordx4 a[24:27], v164, s[8:11], s22 offen offset:2048 sc1
  buffer_load_dwordx4 a[28:31], v164, s[8:11], s22 offen offset:2304 sc1
  s_addk_i32 s22, 4096
  buffer_load_dwordx4 a[32:35], v164, s[8:11], s22 offen offset:0 sc1
  buffer_load_dwordx4 a[36:39], v164, s[8:11], s22 offen offset:256 sc1
  buffer_load_dwordx4 a[40:43], v164, s[8:11], s22 offen offset:2048 sc1
  buffer_load_dwordx4 a[44:47], v164, s[8:11], s22 offen offset:2304 sc1
  s_addk_i32 s22, 4096
  buffer_load_dwordx4 a[48:51], v164, s[8:11], s22 offen offset:0 sc1
  buffer_load_dwordx4 a[52:55], v164, s[8:11], s22 offen offset:256 sc1
  buffer_load_dwordx4 a[56:59], v164, s[8:11], s22 offen offset:2048 sc1
  buffer_load_dwordx4 a[60:63], v164, s[8:11], s22 offen offset:2304 sc1
  ds_read_b128 v[80:83], v165 offset:0
  ds_read_b128 v[84:87], v165 offset:256
  ds_read_b128 v[88:91], v165 offset:1024
  ds_read_b128 v[92:95], v165 offset:1280
  ds_read_b128 v[96:99], v165 offset:4096
  ds_read_b128 v[100:103], v165 offset:4352
  ds_read_b128 v[104:107], v165 offset:5120
  s_waitcnt vmcnt(15) lgkmcnt(6)
  v_mfma_f32_16x16x32_bf16 v[16:19], a[0:3], v[80:83], 0
  s_waitcnt vmcnt(14)
  v_mfma_f32_16x16x32_bf16 v[20:23], a[4:7], v[80:83], 0
  ds_read_b128 v[108:111], v165 offset:5376
  s_waitcnt lgkmcnt(6)
  v_mfma_f32_16x16x32_bf16 v[24:27], a[0:3], v[84:87], 0
  v_mfma_f32_16x16x32_bf16 v[28:31], a[4:7], v[84:87], 0
  ds_read_b128 v[80:83], v165 offset:8192
  s_waitcnt lgkmcnt(6)
  v_mfma_f32_16x16x32_bf16 v[32:35], a[0:3], v[88:91], 0
  v_mfma_f32_16x16x32_bf16 v[36:39], a[4:7], v[88:91], 0
  ds_read_b128 v[84:87], v165 offset:8448
  s_waitcnt lgkmcnt(6)
  v_mfma_f32_16x16x32_bf16 v[40:43], a[0:3], v[92:95], 0
  v_mfma_f32_16x16x32_bf16 v[44:47], a[4:7], v[92:95], 0
  ds_read_b128 v[88:91], v165 offset:9216
  s_waitcnt vmcnt(13) lgkmcnt(6)
  v_mfma_f32_16x16x32_bf16 v[16:19], a[8:11], v[96:99], v[16:19]
  s_addk_i32 s22, 4096
  buffer_load_dwordx4 a[0:3], v164, s[8:11], s22 offen offset:0 sc1
  s_waitcnt vmcnt(13)
  v_mfma_f32_16x16x32_bf16 v[20:23], a[12:15], v[96:99], v[20:23]
  ds_read_b128 v[92:95], v165 offset:9472
  s_waitcnt lgkmcnt(6)
  v_mfma_f32_16x16x32_bf16 v[24:27], a[8:11], v[100:103], v[24:27]
  v_mfma_f32_16x16x32_bf16 v[28:31], a[12:15], v[100:103], v[28:31]
  ds_read_b128 v[96:99], v165 offset:12288
  s_waitcnt lgkmcnt(6)
  v_mfma_f32_16x16x32_bf16 v[32:35], a[8:11], v[104:107], v[32:35]
  buffer_load_dwordx4 a[4:7], v164, s[8:11], s22 offen offset:256 sc1
  v_mfma_f32_16x16x32_bf16 v[36:39], a[12:15], v[104:107], v[36:39]
  ds_read_b128 v[100:103], v165 offset:12544
  s_waitcnt lgkmcnt(6)
  v_mfma_f32_16x16x32_bf16 v[40:43], a[8:11], v[108:111], v[40:43]
  v_mfma_f32_16x16x32_bf16 v[44:47], a[12:15], v[108:111], v[44:47]
  ds_read_b128 v[104:107], v165 offset:13312
  s_waitcnt vmcnt(13) lgkmcnt(6)
  v_mfma_f32_16x16x32_bf16 v[16:19], a[16:19], v[80:83], v[16:19]
  buffer_load_dwordx4 a[8:11], v164, s[8:11], s22 offen offset:2048 sc1
  s_waitcnt vmcnt(13)
  v_mfma_f32_16x16x32_bf16 v[20:23], a[20:23], v[80:83], v[20:23]
  ds_read_b128 v[108:111], v165 offset:13568
  s_waitcnt lgkmcnt(6)
  v_mfma_f32_16x16x32_bf16 v[24:27], a[16:19], v[84:87], v[24:27]
  v_mfma_f32_16x16x32_bf16 v[28:31], a[20:23], v[84:87], v[28:31]
  ds_read_b128 v[80:83], v165 offset:16384
  s_waitcnt lgkmcnt(6)
  v_mfma_f32_16x16x32_bf16 v[32:35], a[16:19], v[88:91], v[32:35]
  buffer_load_dwordx4 a[12:15], v164, s[8:11], s22 offen offset:2304 sc1
  v_mfma_f32_16x16x32_bf16 v[36:39], a[20:23], v[88:91], v[36:39]
  ds_read_b128 v[84:87], v165 offset:16640
  s_waitcnt lgkmcnt(6)
  v_mfma_f32_16x16x32_bf16 v[40:43], a[16:19], v[92:95], v[40:43]
  v_mfma_f32_16x16x32_bf16 v[44:47], a[20:23], v[92:95], v[44:47]
  ds_read_b128 v[88:91], v165 offset:17408
  s_waitcnt vmcnt(13) lgkmcnt(6)
  v_mfma_f32_16x16x32_bf16 v[16:19], a[24:27], v[96:99], v[16:19]
  s_addk_i32 s22, 4096
  buffer_load_dwordx4 a[16:19], v164, s[8:11], s22 offen offset:0 sc1
  s_waitcnt vmcnt(13)
  v_mfma_f32_16x16x32_bf16 v[20:23], a[28:31], v[96:99], v[20:23]
  ds_read_b128 v[92:95], v165 offset:17664
  s_waitcnt lgkmcnt(6)
  v_mfma_f32_16x16x32_bf16 v[24:27], a[24:27], v[100:103], v[24:27]
  v_mfma_f32_16x16x32_bf16 v[28:31], a[28:31], v[100:103], v[28:31]
  ds_read_b128 v[96:99], v165 offset:20480
  s_waitcnt lgkmcnt(6)
  v_mfma_f32_16x16x32_bf16 v[32:35], a[24:27], v[104:107], v[32:35]
  buffer_load_dwordx4 a[20:23], v164, s[8:11], s22 offen offset:256 sc1
  v_mfma_f32_16x16x32_bf16 v[36:39], a[28:31], v[104:107], v[36:39]
  ds_read_b128 v[100:103], v165 offset:20736
  s_waitcnt lgkmcnt(6)
  v_mfma_f32_16x16x32_bf16 v[40:43], a[24:27], v[108:111], v[40:43]
  v_mfma_f32_16x16x32_bf16 v[44:47], a[28:31], v[108:111], v[44:47]
  ds_read_b128 v[104:107], v165 offset:21504
  s_waitcnt vmcnt(13) lgkmcnt(6)
  v_mfma_f32_16x16x32_bf16 v[16:19], a[32:35], v[80:83], v[16:19]
  buffer_load_dwordx4 a[24:27], v164, s[8:11], s22 offen offset:2048 sc1
  s_waitcnt vmcnt(13)
  v_mfma_f32_16x16x32_bf16 v[20:23], a[36:39], v[80:83], v[20:23]
  ds_read_b128 v[108:111], v165 offset:21760
  s_waitcnt lgkmcnt(6)
  v_mfma_f32_16x16x32_bf16 v[24:27], a[32:35], v[84:87], v[24:27]
  v_mfma_f32_16x16x32_bf16 v[28:31], a[36:39], v[84:87], v[28:31]
  ds_read_b128 v[80:83], v165 offset:24576
  s_waitcnt lgkmcnt(6)
  v_mfma_f32_16x16x32_bf16 v[32:35], a[32:35], v[88:91], v[32:35]
  buffer_load_dwordx4 a[28:31], v164, s[8:11], s22 offen offset:2304 sc1
  v_mfma_f32_16x16x32_bf16 v[36:39], a[36:39], v[88:91], v[36:39]
  ds_read_b128 v[84:87], v165 offset:24832
  s_waitcnt lgkmcnt(6)
  v_mfma_f32_16x16x32_bf16 v[40:43], a[32:35], v[92:95], v[40:43]
  v_mfma_f32_16x16x32_bf16 v[44:47], a[36:39], v[92:95], v[44:47]
  ds_read_b128 v[88:91], v165 offset:25600
  s_waitcnt vmcnt(13) lgkmcnt(6)
  v_mfma_f32_16x16x32_bf16 v[16:19], a[40:43], v[96:99], v[16:19]
  s_addk_i32 s22, 4096
  buffer_load_dwordx4 a[32:35], v164, s[8:11], s22 offen offset:0 sc1
  s_waitcnt vmcnt(13)
  v_mfma_f32_16x16x32_bf16 v[20:23], a[44:47], v[96:99], v[20:23]
  ds_read_b128 v[92:95], v165 offset:25856
  s_waitcnt lgkmcnt(6)
  v_mfma_f32_16x16x32_bf16 v[24:27], a[40:43], v[100:103], v[24:27]
  v_bfe_u32 v10, v0, 2, 5
  v_mfma_f32_16x16x32_bf16 v[28:31], a[44:47], v[100:103], v[28:31]
  ds_read_b128 v[96:99], v165 offset:28672
  s_waitcnt lgkmcnt(6)
  v_mfma_f32_16x16x32_bf16 v[32:35], a[40:43], v[104:107], v[32:35]
  buffer_load_dwordx4 a[36:39], v164, s[8:11], s22 offen offset:256 sc1
  v_mfma_f32_16x16x32_bf16 v[36:39], a[44:47], v[104:107], v[36:39]
  ds_read_b128 v[100:103], v165 offset:28928
  s_waitcnt lgkmcnt(6)
  v_mfma_f32_16x16x32_bf16 v[40:43], a[40:43], v[108:111], v[40:43]
  v_mfma_f32_16x16x32_bf16 v[44:47], a[44:47], v[108:111], v[44:47]
  ds_read_b128 v[104:107], v165 offset:29696
  v_lshrrev_b32 v12, 1, v0
  s_waitcnt vmcnt(13) lgkmcnt(6)
  v_mfma_f32_16x16x32_bf16 v[16:19], a[48:51], v[80:83], v[16:19]
  buffer_load_dwordx4 a[40:43], v164, s[8:11], s22 offen offset:2048 sc1
  s_waitcnt vmcnt(13)
  v_mfma_f32_16x16x32_bf16 v[20:23], a[52:55], v[80:83], v[20:23]
  ds_read_b128 v[108:111], v165 offset:29952
  s_waitcnt lgkmcnt(6)
  v_mfma_f32_16x16x32_bf16 v[24:27], a[48:51], v[84:87], v[24:27]
  v_mfma_f32_16x16x32_bf16 v[28:31], a[52:55], v[84:87], v[28:31]
  ds_read_b128 v[80:83], v165 offset:32768
  s_waitcnt lgkmcnt(6)
  v_mfma_f32_16x16x32_bf16 v[32:35], a[48:51], v[88:91], v[32:35]
  buffer_load_dwordx4 a[44:47], v164, s[8:11], s22 offen offset:2304 sc1
  v_mfma_f32_16x16x32_bf16 v[36:39], a[52:55], v[88:91], v[36:39]
  ds_read_b128 v[84:87], v165 offset:33024
  v_cmp_gt_u32 s[34:35], 19, v10
  s_waitcnt lgkmcnt(6)
  v_mfma_f32_16x16x32_bf16 v[40:43], a[48:51], v[92:95], v[40:43]
  v_mfma_f32_16x16x32_bf16 v[44:47], a[52:55], v[92:95], v[44:47]
  ds_read_b128 v[88:91], v165 offset:33792
  s_waitcnt vmcnt(13) lgkmcnt(6)
  v_mfma_f32_16x16x32_bf16 v[16:19], a[56:59], v[96:99], v[16:19]
  s_addk_i32 s22, 4096
  buffer_load_dwordx4 a[48:51], v164, s[8:11], s22 offen offset:0 sc1
  s_waitcnt vmcnt(13)
  v_mfma_f32_16x16x32_bf16 v[20:23], a[60:63], v[96:99], v[20:23]
  ds_read_b128 v[92:95], v165 offset:34048
  s_waitcnt lgkmcnt(6)
  v_mfma_f32_16x16x32_bf16 v[24:27], a[56:59], v[100:103], v[24:27]
  v_cmp_eq_u32 s[36:37], 22, v10
  v_mfma_f32_16x16x32_bf16 v[28:31], a[60:63], v[100:103], v[28:31]
  ds_read_b128 v[96:99], v165 offset:36864
  s_waitcnt lgkmcnt(6)
  v_mfma_f32_16x16x32_bf16 v[32:35], a[56:59], v[104:107], v[32:35]
  buffer_load_dwordx4 a[52:55], v164, s[8:11], s22 offen offset:256 sc1
  v_mfma_f32_16x16x32_bf16 v[36:39], a[60:63], v[104:107], v[36:39]
  ds_read_b128 v[100:103], v165 offset:37120
  s_waitcnt lgkmcnt(6)
  v_mfma_f32_16x16x32_bf16 v[40:43], a[56:59], v[108:111], v[40:43]
  v_mfma_f32_16x16x32_bf16 v[44:47], a[60:63], v[108:111], v[44:47]
  ds_read_b128 v[104:107], v165 offset:37888
  s_or_b64 s[34:35], s[34:35], s[36:37]
  s_waitcnt vmcnt(13) lgkmcnt(6)
  v_mfma_f32_16x16x32_bf16 v[16:19], a[0:3], v[80:83], v[16:19]
  buffer_load_dwordx4 a[56:59], v164, s[8:11], s22 offen offset:2048 sc1
  s_waitcnt vmcnt(13)
  v_mfma_f32_16x16x32_bf16 v[20:23], a[4:7], v[80:83], v[20:23]
  ds_read_b128 v[108:111], v165 offset:38144
  s_waitcnt lgkmcnt(6)
  v_mfma_f32_16x16x32_bf16 v[24:27], a[0:3], v[84:87], v[24:27]
  v_mfma_f32_16x16x32_bf16 v[28:31], a[4:7], v[84:87], v[28:31]
  ds_read_b128 v[80:83], v165 offset:40960
  s_waitcnt lgkmcnt(6)
  v_mfma_f32_16x16x32_bf16 v[32:35], a[0:3], v[88:91], v[32:35]
  buffer_load_dwordx4 a[60:63], v164, s[8:11], s22 offen offset:2304 sc1
  v_mfma_f32_16x16x32_bf16 v[36:39], a[4:7], v[88:91], v[36:39]
  ds_read_b128 v[84:87], v165 offset:41216
  v_cmp_gt_u32 s[38:39], 19, v12
  s_waitcnt lgkmcnt(6)
  v_mfma_f32_16x16x32_bf16 v[40:43], a[0:3], v[92:95], v[40:43]
  v_mfma_f32_16x16x32_bf16 v[44:47], a[4:7], v[92:95], v[44:47]
  ds_read_b128 v[88:91], v165 offset:41984
  s_waitcnt vmcnt(13) lgkmcnt(6)
  v_mfma_f32_16x16x32_bf16 v[16:19], a[8:11], v[96:99], v[16:19]
  s_addk_i32 s22, 4096
  buffer_load_dwordx4 a[0:3], v164, s[8:11], s22 offen offset:0 sc1
  s_waitcnt vmcnt(13)
  v_mfma_f32_16x16x32_bf16 v[20:23], a[12:15], v[96:99], v[20:23]
  ds_read_b128 v[92:95], v165 offset:42240
  s_waitcnt lgkmcnt(6)
  v_mfma_f32_16x16x32_bf16 v[24:27], a[8:11], v[100:103], v[24:27]
  v_cmp_eq_u32 s[36:37], 22, v12
  v_mfma_f32_16x16x32_bf16 v[28:31], a[12:15], v[100:103], v[28:31]
  ds_read_b128 v[96:99], v165 offset:45056
  s_waitcnt lgkmcnt(6)
  v_mfma_f32_16x16x32_bf16 v[32:35], a[8:11], v[104:107], v[32:35]
  buffer_load_dwordx4 a[4:7], v164, s[8:11], s22 offen offset:256 sc1
  v_mfma_f32_16x16x32_bf16 v[36:39], a[12:15], v[104:107], v[36:39]
  ds_read_b128 v[100:103], v165 offset:45312
  s_waitcnt lgkmcnt(6)
  v_mfma_f32_16x16x32_bf16 v[40:43], a[8:11], v[108:111], v[40:43]
  v_mfma_f32_16x16x32_bf16 v[44:47], a[12:15], v[108:111], v[44:47]
  ds_read_b128 v[104:107], v165 offset:46080
  s_or_b64 s[38:39], s[38:39], s[36:37]
  s_waitcnt vmcnt(13) lgkmcnt(6)
  v_mfma_f32_16x16x32_bf16 v[16:19], a[16:19], v[80:83], v[16:19]
  buffer_load_dwordx4 a[8:11], v164, s[8:11], s22 offen offset:2048 sc1
  s_waitcnt vmcnt(13)
  v_mfma_f32_16x16x32_bf16 v[20:23], a[20:23], v[80:83], v[20:23]
  ds_read_b128 v[108:111], v165 offset:46336
  s_waitcnt lgkmcnt(6)
  v_mfma_f32_16x16x32_bf16 v[24:27], a[16:19], v[84:87], v[24:27]
  v_mfma_f32_16x16x32_bf16 v[28:31], a[20:23], v[84:87], v[28:31]
  ds_read_b128 v[80:83], v165 offset:49152
  s_waitcnt lgkmcnt(6)
  v_mfma_f32_16x16x32_bf16 v[32:35], a[16:19], v[88:91], v[32:35]
  buffer_load_dwordx4 a[12:15], v164, s[8:11], s22 offen offset:2304 sc1
  v_mfma_f32_16x16x32_bf16 v[36:39], a[20:23], v[88:91], v[36:39]
  ds_read_b128 v[84:87], v165 offset:49408
  s_mul_i32 s28, s20, 2560
  s_waitcnt lgkmcnt(6)
  v_mfma_f32_16x16x32_bf16 v[40:43], a[16:19], v[92:95], v[40:43]
  v_mfma_f32_16x16x32_bf16 v[44:47], a[20:23], v[92:95], v[44:47]
  ds_read_b128 v[88:91], v165 offset:50176
  s_waitcnt vmcnt(13) lgkmcnt(6)
  v_mfma_f32_16x16x32_bf16 v[16:19], a[24:27], v[96:99], v[16:19]
  s_addk_i32 s22, 4096
  buffer_load_dwordx4 a[16:19], v164, s[8:11], s22 offen offset:0 sc1
  s_waitcnt vmcnt(13)
  v_mfma_f32_16x16x32_bf16 v[20:23], a[28:31], v[96:99], v[20:23]
  ds_read_b128 v[92:95], v165 offset:50432
  s_waitcnt lgkmcnt(6)
  v_mfma_f32_16x16x32_bf16 v[24:27], a[24:27], v[100:103], v[24:27]
  s_add_u32 s28, s28, 43253760
  v_mfma_f32_16x16x32_bf16 v[28:31], a[28:31], v[100:103], v[28:31]
  ds_read_b128 v[96:99], v165 offset:53248
  s_waitcnt lgkmcnt(6)
  v_mfma_f32_16x16x32_bf16 v[32:35], a[24:27], v[104:107], v[32:35]
  buffer_load_dwordx4 a[20:23], v164, s[8:11], s22 offen offset:256 sc1
  v_mfma_f32_16x16x32_bf16 v[36:39], a[28:31], v[104:107], v[36:39]
  ds_read_b128 v[100:103], v165 offset:53504
  s_waitcnt lgkmcnt(6)
  v_mfma_f32_16x16x32_bf16 v[40:43], a[24:27], v[108:111], v[40:43]
  v_mfma_f32_16x16x32_bf16 v[44:47], a[28:31], v[108:111], v[44:47]
  ds_read_b128 v[104:107], v165 offset:54272
  s_nop 0
  s_waitcnt vmcnt(13) lgkmcnt(6)
  v_mfma_f32_16x16x32_bf16 v[16:19], a[32:35], v[80:83], v[16:19]
  buffer_load_dwordx4 a[24:27], v164, s[8:11], s22 offen offset:2048 sc1
  s_waitcnt vmcnt(13)
  v_mfma_f32_16x16x32_bf16 v[20:23], a[36:39], v[80:83], v[20:23]
  ds_read_b128 v[108:111], v165 offset:54528
  s_waitcnt lgkmcnt(6)
  v_mfma_f32_16x16x32_bf16 v[24:27], a[32:35], v[84:87], v[24:27]
  v_mfma_f32_16x16x32_bf16 v[28:31], a[36:39], v[84:87], v[28:31]
  ds_read_b128 v[80:83], v165 offset:57344
  s_waitcnt lgkmcnt(6)
  v_mfma_f32_16x16x32_bf16 v[32:35], a[32:35], v[88:91], v[32:35]
  buffer_load_dwordx4 a[28:31], v164, s[8:11], s22 offen offset:2304 sc1
  v_mfma_f32_16x16x32_bf16 v[36:39], a[36:39], v[88:91], v[36:39]
  ds_read_b128 v[84:87], v165 offset:57600
  s_lshl_b32 s54, s20, 7
  s_waitcnt lgkmcnt(6)
  v_mfma_f32_16x16x32_bf16 v[40:43], a[32:35], v[92:95], v[40:43]
  v_mfma_f32_16x16x32_bf16 v[44:47], a[36:39], v[92:95], v[44:47]
  ds_read_b128 v[88:91], v165 offset:58368
  s_waitcnt vmcnt(13) lgkmcnt(6)
  v_mfma_f32_16x16x32_bf16 v[16:19], a[40:43], v[96:99], v[16:19]
  s_addk_i32 s22, 4096
  buffer_load_dwordx4 a[32:35], v164, s[8:11], s22 offen offset:0 sc1
  s_waitcnt vmcnt(13)
  v_mfma_f32_16x16x32_bf16 v[20:23], a[44:47], v[96:99], v[20:23]
  ds_read_b128 v[92:95], v165 offset:58624
  s_waitcnt lgkmcnt(6)
  v_mfma_f32_16x16x32_bf16 v[24:27], a[40:43], v[100:103], v[24:27]
  s_add_u32 s54, s54, 43401216
  v_mfma_f32_16x16x32_bf16 v[28:31], a[44:47], v[100:103], v[28:31]
  ds_read_b128 v[96:99], v165 offset:61440
  s_waitcnt lgkmcnt(6)
  v_mfma_f32_16x16x32_bf16 v[32:35], a[40:43], v[104:107], v[32:35]
  buffer_load_dwordx4 a[36:39], v164, s[8:11], s22 offen offset:256 sc1
  v_mfma_f32_16x16x32_bf16 v[36:39], a[44:47], v[104:107], v[36:39]
  ds_read_b128 v[100:103], v165 offset:61696
  s_waitcnt lgkmcnt(6)
  v_mfma_f32_16x16x32_bf16 v[40:43], a[40:43], v[108:111], v[40:43]
  v_mfma_f32_16x16x32_bf16 v[44:47], a[44:47], v[108:111], v[44:47]
  ds_read_b128 v[104:107], v165 offset:62464
  v_lshlrev_b32 v10, 12, v2
  s_waitcnt vmcnt(13) lgkmcnt(6)
  v_mfma_f32_16x16x32_bf16 v[16:19], a[48:51], v[80:83], v[16:19]
  buffer_load_dwordx4 a[40:43], v164, s[8:11], s22 offen offset:2048 sc1
  s_waitcnt vmcnt(13)
  v_mfma_f32_16x16x32_bf16 v[20:23], a[52:55], v[80:83], v[20:23]
  ds_read_b128 v[108:111], v165 offset:62720
  s_waitcnt lgkmcnt(6)
  v_mfma_f32_16x16x32_bf16 v[24:27], a[48:51], v[84:87], v[24:27]
  v_mfma_f32_16x16x32_bf16 v[28:31], a[52:55], v[84:87], v[28:31]
  ds_read_b128 v[80:83], v166 offset:0
  s_waitcnt lgkmcnt(6)
  v_mfma_f32_16x16x32_bf16 v[32:35], a[48:51], v[88:91], v[32:35]
  buffer_load_dwordx4 a[44:47], v164, s[8:11], s22 offen offset:2304 sc1
  v_mfma_f32_16x16x32_bf16 v[36:39], a[52:55], v[88:91], v[36:39]
  ds_read_b128 v[84:87], v166 offset:256
  v_mov_b32 v11, 1
  s_waitcnt lgkmcnt(6)
  v_mfma_f32_16x16x32_bf16 v[40:43], a[48:51], v[92:95], v[40:43]
  v_mfma_f32_16x16x32_bf16 v[44:47], a[52:55], v[92:95], v[44:47]
  ds_read_b128 v[88:91], v166 offset:1024
  s_waitcnt vmcnt(13) lgkmcnt(6)
  v_mfma_f32_16x16x32_bf16 v[16:19], a[56:59], v[96:99], v[16:19]
  s_addk_i32 s22, 4096
  buffer_load_dwordx4 a[48:51], v164, s[8:11], s22 offen offset:0 sc1
  s_waitcnt vmcnt(13)
  v_mfma_f32_16x16x32_bf16 v[20:23], a[60:63], v[96:99], v[20:23]
  ds_read_b128 v[92:95], v166 offset:1280
  s_waitcnt lgkmcnt(6)
  v_mfma_f32_16x16x32_bf16 v[24:27], a[56:59], v[100:103], v[24:27]
  v_mfma_f32_16x16x32_bf16 v[28:31], a[60:63], v[100:103], v[28:31]
  ds_read_b128 v[96:99], v166 offset:4096
  s_waitcnt lgkmcnt(6)
  v_mfma_f32_16x16x32_bf16 v[32:35], a[56:59], v[104:107], v[32:35]
  buffer_load_dwordx4 a[52:55], v164, s[8:11], s22 offen offset:256 sc1
  v_mfma_f32_16x16x32_bf16 v[36:39], a[60:63], v[104:107], v[36:39]
  ds_read_b128 v[100:103], v166 offset:4352
  s_waitcnt lgkmcnt(6)
  v_mfma_f32_16x16x32_bf16 v[40:43], a[56:59], v[108:111], v[40:43]
  v_mfma_f32_16x16x32_bf16 v[44:47], a[60:63], v[108:111], v[44:47]
  ds_read_b128 v[104:107], v166 offset:5120
  s_waitcnt vmcnt(13) lgkmcnt(6)
  v_mfma_f32_16x16x32_bf16 v[16:19], a[0:3], v[80:83], v[16:19]
  buffer_load_dwordx4 a[56:59], v164, s[8:11], s22 offen offset:2048 sc1
  s_waitcnt vmcnt(13)
  v_mfma_f32_16x16x32_bf16 v[20:23], a[4:7], v[80:83], v[20:23]
  ds_read_b128 v[108:111], v166 offset:5376
  s_waitcnt lgkmcnt(6)
  v_mfma_f32_16x16x32_bf16 v[24:27], a[0:3], v[84:87], v[24:27]
  v_mfma_f32_16x16x32_bf16 v[28:31], a[4:7], v[84:87], v[28:31]
  ds_read_b128 v[80:83], v165 offset:0
  s_waitcnt lgkmcnt(6)
  v_mfma_f32_16x16x32_bf16 v[32:35], a[0:3], v[88:91], v[32:35]
  buffer_load_dwordx4 a[60:63], v164, s[8:11], s22 offen offset:2304 sc1
  v_mfma_f32_16x16x32_bf16 v[36:39], a[4:7], v[88:91], v[36:39]
  ds_read_b128 v[84:87], v165 offset:256
  s_waitcnt lgkmcnt(6)
  v_mfma_f32_16x16x32_bf16 v[40:43], a[0:3], v[92:95], v[40:43]
  v_mfma_f32_16x16x32_bf16 v[44:47], a[4:7], v[92:95], v[44:47]
  ds_read_b128 v[88:91], v165 offset:1024
  s_waitcnt vmcnt(13) lgkmcnt(6)
  v_mfma_f32_16x16x32_bf16 v[16:19], a[8:11], v[96:99], v[16:19]
  s_addk_i32 s22, 4096
  buffer_load_dwordx4 a[0:3], v164, s[8:11], s22 offen offset:0 sc1
  s_waitcnt vmcnt(13)
  v_mfma_f32_16x16x32_bf16 v[20:23], a[12:15], v[96:99], v[20:23]
  ds_read_b128 v[92:95], v165 offset:1280
  s_waitcnt lgkmcnt(6)
  v_mfma_f32_16x16x32_bf16 v[24:27], a[8:11], v[100:103], v[24:27]
  v_mfma_f32_16x16x32_bf16 v[28:31], a[12:15], v[100:103], v[28:31]
  ds_read_b128 v[96:99], v165 offset:4096
  s_waitcnt lgkmcnt(6)
  v_mfma_f32_16x16x32_bf16 v[32:35], a[8:11], v[104:107], v[32:35]
  buffer_load_dwordx4 a[4:7], v164, s[8:11], s22 offen offset:256 sc1
  v_mfma_f32_16x16x32_bf16 v[36:39], a[12:15], v[104:107], v[36:39]
  ds_read_b128 v[100:103], v165 offset:4352
  s_waitcnt lgkmcnt(6)
  v_mfma_f32_16x16x32_bf16 v[40:43], a[8:11], v[108:111], v[40:43]
  v_mfma_f32_16x16x32_bf16 v[44:47], a[12:15], v[108:111], v[44:47]
  ds_read_b128 v[104:107], v165 offset:5120
  s_waitcnt vmcnt(13) lgkmcnt(6)
  v_mfma_f32_16x16x32_bf16 v[48:51], a[16:19], v[80:83], 0
  buffer_load_dwordx4 a[8:11], v164, s[8:11], s22 offen offset:2048 sc1
  s_waitcnt vmcnt(13)
  v_mfma_f32_16x16x32_bf16 v[52:55], a[20:23], v[80:83], 0
  ds_read_b128 v[108:111], v165 offset:5376
  s_waitcnt lgkmcnt(6)
  v_mfma_f32_16x16x32_bf16 v[56:59], a[16:19], v[84:87], 0
  v_mfma_f32_16x16x32_bf16 v[60:63], a[20:23], v[84:87], 0
  ds_read_b128 v[80:83], v165 offset:8192
  s_waitcnt lgkmcnt(6)
  v_mfma_f32_16x16x32_bf16 v[64:67], a[16:19], v[88:91], 0
  buffer_load_dwordx4 a[12:15], v164, s[8:11], s22 offen offset:2304 sc1
  v_mul_f32 v128, 0x3fb8aa3b, v16
  v_mul_f32 v129, 0x3fb8aa3b, v17
  v_mfma_f32_16x16x32_bf16 v[68:71], a[20:23], v[88:91], 0
  ds_read_b128 v[84:87], v165 offset:8448
  v_mul_f32 v130, 0x3fb8aa3b, v18
  s_waitcnt lgkmcnt(6)
  v_mfma_f32_16x16x32_bf16 v[72:75], a[16:19], v[92:95], 0
  v_mul_f32 v131, 0x3fb8aa3b, v19
  v_exp_f32 v128, v128 clamp
  v_mfma_f32_16x16x32_bf16 v[76:79], a[20:23], v[92:95], 0
  ds_read_b128 v[88:91], v165 offset:9216
  s_waitcnt vmcnt(13) lgkmcnt(6)
  v_mfma_f32_16x16x32_bf16 v[48:51], a[24:27], v[96:99], v[48:51]
  s_addk_i32 s22, 4096
  buffer_load_dwordx4 a[16:19], v164, s[8:11], s22 offen offset:0 sc1
  v_exp_f32 v129, v129 clamp
  s_waitcnt vmcnt(13)
  v_mfma_f32_16x16x32_bf16 v[52:55], a[28:31], v[96:99], v[52:55]
  ds_read_b128 v[92:95], v165 offset:9472
  v_exp_f32 v130, v130 clamp
  s_waitcnt lgkmcnt(6)
  v_mfma_f32_16x16x32_bf16 v[56:59], a[24:27], v[100:103], v[56:59]
  v_exp_f32 v131, v131 clamp
  v_mfma_f32_16x16x32_bf16 v[60:63], a[28:31], v[100:103], v[60:63]
  ds_read_b128 v[96:99], v165 offset:12288
  v_max_f32 v16, 0x358637bd, v16
  v_max_f32 v17, 0x358637bd, v17
  s_waitcnt lgkmcnt(6)
  v_mfma_f32_16x16x32_bf16 v[64:67], a[24:27], v[104:107], v[64:67]
  buffer_load_dwordx4 a[20:23], v164, s[8:11], s22 offen offset:256 sc1
  v_max_f32 v18, 0x358637bd, v18
  v_mfma_f32_16x16x32_bf16 v[68:71], a[28:31], v[104:107], v[68:71]
  ds_read_b128 v[100:103], v165 offset:12544
  v_max_f32 v19, 0x358637bd, v19
  v_add_f32 v16, v16, v128
  s_waitcnt lgkmcnt(6)
  v_mfma_f32_16x16x32_bf16 v[72:75], a[24:27], v[108:111], v[72:75]
  v_add_f32 v17, v17, v129
  v_add_f32 v18, v18, v130
  v_mfma_f32_16x16x32_bf16 v[76:79], a[28:31], v[108:111], v[76:79]
  ds_read_b128 v[104:107], v165 offset:13312
  v_add_f32 v19, v19, v131
  s_waitcnt vmcnt(13) lgkmcnt(6)
  v_mfma_f32_16x16x32_bf16 v[48:51], a[32:35], v[80:83], v[48:51]
  buffer_load_dwordx4 a[24:27], v164, s[8:11], s22 offen offset:2048 sc1
  v_mul_f32 v128, 0x3fb8aa3b, v20
  v_mul_f32 v129, 0x3fb8aa3b, v21
  s_waitcnt vmcnt(13)
  v_mfma_f32_16x16x32_bf16 v[52:55], a[36:39], v[80:83], v[52:55]
  ds_read_b128 v[108:111], v165 offset:13568
  v_mul_f32 v130, 0x3fb8aa3b, v22
  v_mul_f32 v131, 0x3fb8aa3b, v23
  s_waitcnt lgkmcnt(6)
  v_mfma_f32_16x16x32_bf16 v[56:59], a[32:35], v[84:87], v[56:59]
  v_exp_f32 v128, v128 clamp
  v_mfma_f32_16x16x32_bf16 v[60:63], a[36:39], v[84:87], v[60:63]
  ds_read_b128 v[80:83], v165 offset:16384
  v_exp_f32 v129, v129 clamp
  s_waitcnt lgkmcnt(6)
  v_mfma_f32_16x16x32_bf16 v[64:67], a[32:35], v[88:91], v[64:67]
  buffer_load_dwordx4 a[28:31], v164, s[8:11], s22 offen offset:2304 sc1
  v_mfma_f32_16x16x32_bf16 v[68:71], a[36:39], v[88:91], v[68:71]
  ds_read_b128 v[84:87], v165 offset:16640
  v_exp_f32 v130, v130 clamp
  s_waitcnt lgkmcnt(6)
  v_mfma_f32_16x16x32_bf16 v[72:75], a[32:35], v[92:95], v[72:75]
  v_exp_f32 v131, v131 clamp
  v_mfma_f32_16x16x32_bf16 v[76:79], a[36:39], v[92:95], v[76:79]
  ds_read_b128 v[88:91], v165 offset:17408
  v_max_f32 v20, 0x358637bd, v20
  v_max_f32 v21, 0x358637bd, v21
  s_waitcnt vmcnt(13) lgkmcnt(6)
  v_mfma_f32_16x16x32_bf16 v[48:51], a[40:43], v[96:99], v[48:51]
  s_addk_i32 s22, 4096
  buffer_load_dwordx4 a[32:35], v164, s[8:11], s22 offen offset:0 sc1
  v_max_f32 v22, 0x358637bd, v22
  v_max_f32 v23, 0x358637bd, v23
  s_waitcnt vmcnt(13)
  v_mfma_f32_16x16x32_bf16 v[52:55], a[44:47], v[96:99], v[52:55]
  ds_read_b128 v[92:95], v165 offset:17664
  v_add_f32 v20, v20, v128
  s_waitcnt lgkmcnt(6)
  v_mfma_f32_16x16x32_bf16 v[56:59], a[40:43], v[100:103], v[56:59]
  v_add_f32 v21, v21, v129
  v_add_f32 v22, v22, v130
  v_mfma_f32_16x16x32_bf16 v[60:63], a[44:47], v[100:103], v[60:63]
  ds_read_b128 v[96:99], v165 offset:20480
  v_add_f32 v23, v23, v131
  v_cvt_pk_bf16_f32 v112, v16, v17
  s_waitcnt lgkmcnt(6)
  v_mfma_f32_16x16x32_bf16 v[64:67], a[40:43], v[104:107], v[64:67]
  buffer_load_dwordx4 a[36:39], v164, s[8:11], s22 offen offset:256 sc1
  v_cvt_pk_bf16_f32 v113, v18, v19
  v_mfma_f32_16x16x32_bf16 v[68:71], a[44:47], v[104:107], v[68:71]
  ds_read_b128 v[100:103], v165 offset:20736
  v_cvt_pk_bf16_f32 v114, v20, v21
  v_cvt_pk_bf16_f32 v115, v22, v23
  s_waitcnt lgkmcnt(6)
  v_mfma_f32_16x16x32_bf16 v[72:75], a[40:43], v[108:111], v[72:75]
  v_cvt_pk_bf16_f32 v120, v32, v33
  v_cvt_pk_bf16_f32 v121, v34, v35
  v_mfma_f32_16x16x32_bf16 v[76:79], a[44:47], v[108:111], v[76:79]
  ds_read_b128 v[104:107], v165 offset:21504
  v_cvt_pk_bf16_f32 v122, v36, v37
  s_waitcnt vmcnt(13) lgkmcnt(6)
  v_mfma_f32_16x16x32_bf16 v[48:51], a[48:51], v[80:83], v[48:51]
  buffer_load_dwordx4 a[40:43], v164, s[8:11], s22 offen offset:2048 sc1
  v_cvt_pk_bf16_f32 v123, v38, v39
  v_cvt_pk_bf16_f32 v124, v40, v41
  s_waitcnt vmcnt(13)
  v_mfma_f32_16x16x32_bf16 v[52:55], a[52:55], v[80:83], v[52:55]
  ds_read_b128 v[108:111], v165 offset:21760
  v_cvt_pk_bf16_f32 v125, v42, v43
  v_cvt_pk_bf16_f32 v126, v44, v45
  s_waitcnt lgkmcnt(6)
  v_mfma_f32_16x16x32_bf16 v[56:59], a[48:51], v[84:87], v[56:59]
  v_cvt_pk_bf16_f32 v127, v46, v47
  v_mfma_f32_16x16x32_bf16 v[60:63], a[52:55], v[84:87], v[60:63]
  ds_read_b128 v[80:83], v165 offset:24576
  v_cndmask_b32 v124, v124, v8, s[30:31]
  v_cndmask_b32 v125, v125, v8, s[30:31]
  s_waitcnt lgkmcnt(6)
  v_mfma_f32_16x16x32_bf16 v[64:67], a[48:51], v[88:91], v[64:67]
  buffer_load_dwordx4 a[44:47], v164, s[8:11], s22 offen offset:2304 sc1
  v_cndmask_b32 v126, v126, v8, s[30:31]
  v_cndmask_b32 v127, v127, v8, s[30:31]
  v_mfma_f32_16x16x32_bf16 v[68:71], a[52:55], v[88:91], v[68:71]
  ds_read_b128 v[84:87], v165 offset:24832
  v_mfma_f32_16x16x32_bf16 v[136:139], v[112:115], v[120:123], 0
  s_waitcnt lgkmcnt(6)
  v_mfma_f32_16x16x32_bf16 v[72:75], a[48:51], v[92:95], v[72:75]
  v_mfma_f32_16x16x32_bf16 v[140:143], v[112:115], v[124:127], 0
  v_mul_f32 v128, 0x3fb8aa3b, v24
  v_mfma_f32_16x16x32_bf16 v[76:79], a[52:55], v[92:95], v[76:79]
  ds_read_b128 v[88:91], v165 offset:25600
  v_mul_f32 v129, 0x3fb8aa3b, v25
  v_mul_f32 v130, 0x3fb8aa3b, v26
  s_waitcnt vmcnt(13) lgkmcnt(6)
  v_mfma_f32_16x16x32_bf16 v[48:51], a[56:59], v[96:99], v[48:51]
  s_addk_i32 s22, 4096
  buffer_load_dwordx4 a[48:51], v164, s[8:11], s22 offen offset:0 sc1
  v_mul_f32 v131, 0x3fb8aa3b, v27
  s_waitcnt vmcnt(13)
  v_mfma_f32_16x16x32_bf16 v[52:55], a[60:63], v[96:99], v[52:55]
  ds_read_b128 v[92:95], v165 offset:25856
  v_exp_f32 v128, v128 clamp
  s_waitcnt lgkmcnt(6)
  v_mfma_f32_16x16x32_bf16 v[56:59], a[56:59], v[100:103], v[56:59]
  v_exp_f32 v129, v129 clamp
  v_mfma_f32_16x16x32_bf16 v[60:63], a[60:63], v[100:103], v[60:63]
  ds_read_b128 v[96:99], v165 offset:28672
  v_exp_f32 v130, v130 clamp
  s_waitcnt lgkmcnt(6)
  v_mfma_f32_16x16x32_bf16 v[64:67], a[56:59], v[104:107], v[64:67]
  buffer_load_dwordx4 a[52:55], v164, s[8:11], s22 offen offset:256 sc1
  v_exp_f32 v131, v131 clamp
  v_mfma_f32_16x16x32_bf16 v[68:71], a[60:63], v[104:107], v[68:71]
  ds_read_b128 v[100:103], v165 offset:28928
  v_max_f32 v24, 0x358637bd, v24
  s_waitcnt lgkmcnt(6)
  v_mfma_f32_16x16x32_bf16 v[72:75], a[56:59], v[108:111], v[72:75]
  v_max_f32 v25, 0x358637bd, v25
  v_max_f32 v26, 0x358637bd, v26
  v_mfma_f32_16x16x32_bf16 v[76:79], a[60:63], v[108:111], v[76:79]
  ds_read_b128 v[104:107], v165 offset:29696
  v_max_f32 v27, 0x358637bd, v27
  s_waitcnt vmcnt(13) lgkmcnt(6)
  v_mfma_f32_16x16x32_bf16 v[48:51], a[0:3], v[80:83], v[48:51]
  buffer_load_dwordx4 a[56:59], v164, s[8:11], s22 offen offset:2048 sc1
  v_add_f32 v24, v24, v128
  v_add_f32 v25, v25, v129
  s_waitcnt vmcnt(13)
  v_mfma_f32_16x16x32_bf16 v[52:55], a[4:7], v[80:83], v[52:55]
  ds_read_b128 v[108:111], v165 offset:29952
  v_add_f32 v26, v26, v130
  v_add_f32 v27, v27, v131
  s_waitcnt lgkmcnt(6)
  v_mfma_f32_16x16x32_bf16 v[56:59], a[0:3], v[84:87], v[56:59]
  v_mul_f32 v128, 0x3fb8aa3b, v28
  v_mfma_f32_16x16x32_bf16 v[60:63], a[4:7], v[84:87], v[60:63]
  ds_read_b128 v[80:83], v165 offset:32768
  v_mul_f32 v129, 0x3fb8aa3b, v29
  v_mul_f32 v130, 0x3fb8aa3b, v30
  s_waitcnt lgkmcnt(6)
  v_mfma_f32_16x16x32_bf16 v[64:67], a[0:3], v[88:91], v[64:67]
  buffer_load_dwordx4 a[60:63], v164, s[8:11], s22 offen offset:2304 sc1
  v_mul_f32 v131, 0x3fb8aa3b, v31
  v_mfma_f32_16x16x32_bf16 v[68:71], a[4:7], v[88:91], v[68:71]
  ds_read_b128 v[84:87], v165 offset:33024
  v_exp_f32 v128, v128 clamp
  s_waitcnt lgkmcnt(6)
  v_mfma_f32_16x16x32_bf16 v[72:75], a[0:3], v[92:95], v[72:75]
  v_exp_f32 v129, v129 clamp
  v_mfma_f32_16x16x32_bf16 v[76:79], a[4:7], v[92:95], v[76:79]
  ds_read_b128 v[88:91], v165 offset:33792
  v_exp_f32 v130, v130 clamp
  s_waitcnt vmcnt(13) lgkmcnt(6)
  v_mfma_f32_16x16x32_bf16 v[48:51], a[8:11], v[96:99], v[48:51]
  s_addk_i32 s22, 4096
  buffer_load_dwordx4 a[0:3], v164, s[8:11], s22 offen offset:0 sc1
  v_exp_f32 v131, v131 clamp
  s_waitcnt vmcnt(13)
  v_mfma_f32_16x16x32_bf16 v[52:55], a[12:15], v[96:99], v[52:55]
  ds_read_b128 v[92:95], v165 offset:34048
  v_max_f32 v28, 0x358637bd, v28
  s_waitcnt lgkmcnt(6)
  v_mfma_f32_16x16x32_bf16 v[56:59], a[8:11], v[100:103], v[56:59]
  v_max_f32 v29, 0x358637bd, v29
  v_max_f32 v30, 0x358637bd, v30
  v_mfma_f32_16x16x32_bf16 v[60:63], a[12:15], v[100:103], v[60:63]
  ds_read_b128 v[96:99], v165 offset:36864
  v_max_f32 v31, 0x358637bd, v31
  v_add_f32 v28, v28, v128
  s_waitcnt lgkmcnt(6)
  v_mfma_f32_16x16x32_bf16 v[64:67], a[8:11], v[104:107], v[64:67]
  buffer_load_dwordx4 a[4:7], v164, s[8:11], s22 offen offset:256 sc1
  v_add_f32 v29, v29, v129
  v_mfma_f32_16x16x32_bf16 v[68:71], a[12:15], v[104:107], v[68:71]
  ds_read_b128 v[100:103], v165 offset:37120
  v_add_f32 v30, v30, v130
  v_add_f32 v31, v31, v131
  s_waitcnt lgkmcnt(6)
  v_mfma_f32_16x16x32_bf16 v[72:75], a[8:11], v[108:111], v[72:75]
  v_cvt_pk_bf16_f32 v116, v24, v25
  v_cvt_pk_bf16_f32 v117, v26, v27
  v_mfma_f32_16x16x32_bf16 v[76:79], a[12:15], v[108:111], v[76:79]
  ds_read_b128 v[104:107], v165 offset:37888
  v_cvt_pk_bf16_f32 v118, v28, v29
  s_waitcnt vmcnt(13) lgkmcnt(6)
  v_mfma_f32_16x16x32_bf16 v[48:51], a[16:19], v[80:83], v[48:51]
  buffer_load_dwordx4 a[8:11], v164, s[8:11], s22 offen offset:2048 sc1
  v_cvt_pk_bf16_f32 v119, v30, v31
  s_nop 1
  v_mfma_f32_16x16x32_bf16 v[144:147], v[116:119], v[120:123], 0
  s_waitcnt vmcnt(13)
  v_mfma_f32_16x16x32_bf16 v[52:55], a[20:23], v[80:83], v[52:55]
  ds_read_b128 v[108:111], v165 offset:38144
  v_mfma_f32_16x16x32_bf16 v[148:151], v[116:119], v[124:127], 0
  s_waitcnt lgkmcnt(6)
  v_mfma_f32_16x16x32_bf16 v[56:59], a[16:19], v[84:87], v[56:59]
  v_mfma_f32_16x16x32_bf16 v[60:63], a[20:23], v[84:87], v[60:63]
  ds_read_b128 v[80:83], v165 offset:40960
  s_mov_b32 exec_lo, 0xff00ff00
  s_mov_b32 exec_hi, 0xff00ff00
  ds_write2_b64 v5, v[124:125], v[126:127] offset0:64 offset1:66
  s_mov_b32 exec_lo, 0xfff0fff0
  s_mov_b32 exec_hi, 0xfff0fff0
  ds_write2_b64 v5, v[116:117], v[118:119] offset1:2
  s_mov_b64 exec, -1
  s_waitcnt lgkmcnt(8)
  v_mfma_f32_16x16x32_bf16 v[64:67], a[16:19], v[88:91], v[64:67]
  buffer_load_dwordx4 a[12:15], v164, s[8:11], s22 offen offset:2304 sc1
  v_mfma_f32_16x16x32_bf16 v[68:71], a[20:23], v[88:91], v[68:71]
  ds_read_b128 v[84:87], v165 offset:41216
  ds_read_b64_tr_b16 v[152:153], v6
  s_waitcnt lgkmcnt(9)
  v_mfma_f32_16x16x32_bf16 v[72:75], a[16:19], v[92:95], v[72:75]
  ds_read_b64_tr_b16 v[154:155], v6 offset:768
  v_mfma_f32_16x16x32_bf16 v[76:79], a[20:23], v[92:95], v[76:79]
  ds_read_b128 v[88:91], v165 offset:41984
  ds_read_b64_tr_b16 v[156:157], v6 offset:512
  s_waitcnt lgkmcnt(2)
  v_lshlrev_b32 v132, 16, v154
  s_waitcnt vmcnt(13)
  v_mfma_f32_16x16x32_bf16 v[48:51], a[24:27], v[96:99], v[48:51]
  s_addk_i32 s22, 4096
  buffer_load_dwordx4 a[16:19], v164, s[8:11], s22 offen offset:0 sc1
  v_and_b32 v133, 0xffff0000, v154
  v_lshlrev_b32 v134, 16, v155
  s_waitcnt vmcnt(13)
  v_mfma_f32_16x16x32_bf16 v[52:55], a[28:31], v[96:99], v[52:55]
  ds_read_b128 v[92:95], v165 offset:42240
  v_and_b32 v135, 0xffff0000, v155
  v_mfma_f32_16x16x32_bf16 v[56:59], a[24:27], v[100:103], v[56:59]
  v_mul_f32 v128, 0x3fb8aa3b, v132
  v_mul_f32 v129, 0x3fb8aa3b, v133
  v_mfma_f32_16x16x32_bf16 v[60:63], a[28:31], v[100:103], v[60:63]
  ds_read_b128 v[96:99], v165 offset:45056
  v_mul_f32 v130, 0x3fb8aa3b, v134
  v_mul_f32 v131, 0x3fb8aa3b, v135
  v_mfma_f32_16x16x32_bf16 v[64:67], a[24:27], v[104:107], v[64:67]
  buffer_load_dwordx4 a[20:23], v164, s[8:11], s22 offen offset:256 sc1
  v_exp_f32 v128, v128 clamp
  v_mfma_f32_16x16x32_bf16 v[68:71], a[28:31], v[104:107], v[68:71]
  ds_read_b128 v[100:103], v165 offset:45312
  v_exp_f32 v129, v129 clamp
  v_mfma_f32_16x16x32_bf16 v[72:75], a[24:27], v[108:111], v[72:75]
  v_mfma_f32_16x16x32_bf16 v[76:79], a[28:31], v[108:111], v[76:79]
  ds_read_b128 v[104:107], v165 offset:46080
  v_exp_f32 v130, v130 clamp
  s_waitcnt vmcnt(13)
  v_mfma_f32_16x16x32_bf16 v[48:51], a[32:35], v[80:83], v[48:51]
  buffer_load_dwordx4 a[24:27], v164, s[8:11], s22 offen offset:2048 sc1
  v_exp_f32 v131, v131 clamp
  s_waitcnt vmcnt(13)
  v_mfma_f32_16x16x32_bf16 v[52:55], a[36:39], v[80:83], v[52:55]
  ds_read_b128 v[108:111], v165 offset:46336
  v_max_f32 v132, 0x358637bd, v132
  v_max_f32 v133, 0x358637bd, v133
  v_mfma_f32_16x16x32_bf16 v[56:59], a[32:35], v[84:87], v[56:59]
  v_max_f32 v134, 0x358637bd, v134
  v_max_f32 v135, 0x358637bd, v135
  v_mfma_f32_16x16x32_bf16 v[60:63], a[36:39], v[84:87], v[60:63]
  ds_read_b128 v[80:83], v165 offset:49152
  v_add_f32 v132, v132, v128
  s_waitcnt lgkmcnt(7)
  v_mfma_f32_16x16x32_bf16 v[64:67], a[32:35], v[88:91], v[64:67]
  buffer_load_dwordx4 a[28:31], v164, s[8:11], s22 offen offset:2304 sc1
  v_add_f32 v133, v133, v129
  v_add_f32 v134, v134, v130
  v_mfma_f32_16x16x32_bf16 v[68:71], a[36:39], v[88:91], v[68:71]
  ds_read_b128 v[84:87], v165 offset:49408
  v_add_f32 v135, v135, v131
  v_cvt_pk_bf16_f32 v154, v132, v133
  s_waitcnt lgkmcnt(6)
  v_mfma_f32_16x16x32_bf16 v[72:75], a[32:35], v[92:95], v[72:75]
  v_cvt_pk_bf16_f32 v155, v134, v135
  v_mfma_f32_16x16x32_bf16 v[76:79], a[36:39], v[92:95], v[76:79]
  ds_read_b128 v[88:91], v165 offset:50176
  buffer_store_dwordx4 v[152:155], v3, s[8:11], s26 offen sc1
  buffer_store_dword v156, v7, s[8:11], s27 offen sc1
  s_waitcnt vmcnt(15) lgkmcnt(6)
  v_mfma_f32_16x16x32_bf16 v[48:51], a[40:43], v[96:99], v[48:51]
  s_barrier
  s_waitcnt vmcnt(14)
  v_mfma_f32_16x16x32_bf16 v[52:55], a[44:47], v[96:99], v[52:55]
  ds_read_b128 v[92:95], v165 offset:50432
  s_waitcnt lgkmcnt(6)
  v_mfma_f32_16x16x32_bf16 v[56:59], a[40:43], v[100:103], v[56:59]
  v_mfma_f32_16x16x32_bf16 v[60:63], a[44:47], v[100:103], v[60:63]
  ds_read_b128 v[96:99], v165 offset:53248
  s_waitcnt lgkmcnt(6)
  v_mfma_f32_16x16x32_bf16 v[64:67], a[40:43], v[104:107], v[64:67]
  v_mfma_f32_16x16x32_bf16 v[68:71], a[44:47], v[104:107], v[68:71]
  ds_read_b128 v[100:103], v165 offset:53504
  s_waitcnt lgkmcnt(6)
  v_mfma_f32_16x16x32_bf16 v[72:75], a[40:43], v[108:111], v[72:75]
  v_mfma_f32_16x16x32_bf16 v[76:79], a[44:47], v[108:111], v[76:79]
  ds_read_b128 v[104:107], v165 offset:54272
  s_waitcnt vmcnt(13) lgkmcnt(6)
  v_mfma_f32_16x16x32_bf16 v[48:51], a[48:51], v[80:83], v[48:51]
  s_waitcnt vmcnt(12)
  v_mfma_f32_16x16x32_bf16 v[52:55], a[52:55], v[80:83], v[52:55]
  ds_read_b128 v[108:111], v165 offset:54528
  s_waitcnt lgkmcnt(6)
  v_mfma_f32_16x16x32_bf16 v[56:59], a[48:51], v[84:87], v[56:59]
  v_mfma_f32_16x16x32_bf16 v[60:63], a[52:55], v[84:87], v[60:63]
  ds_read_b128 v[80:83], v165 offset:57344
  s_waitcnt lgkmcnt(6)
  v_mfma_f32_16x16x32_bf16 v[64:67], a[48:51], v[88:91], v[64:67]
  s_and_b32 s64, s2, 3
  s_lshl_b32 s64, s64, 1
  s_bfe_u32 s65, s2, 0x10003
  s_add_u32 s64, s64, s65
  s_lshl_b32 s64, s64, 2
  s_add_u32 s64, s64, s16
  s_mul_i32 s64, s64, 336896
  s_lshr_b32 s65, s2, 4
  s_mul_i32 s65, s65, 3072
  s_add_u32 s64, s64, s65
  s_add_u32 s64, s64, 140509184
  buffer_load_dwordx4 v[168:171], v3, s[8:11], s64 offen offset:0 sc1
  buffer_load_dwordx4 v[172:175], v3, s[8:11], s64 offen offset:1024 sc1
  buffer_load_dwordx4 v[176:179], v3, s[8:11], s64 offen offset:2048 sc1
  v_mfma_f32_16x16x32_bf16 v[68:71], a[52:55], v[88:91], v[68:71]
  ds_read_b128 v[84:87], v165 offset:57600
  s_waitcnt lgkmcnt(6)
  v_mfma_f32_16x16x32_bf16 v[72:75], a[48:51], v[92:95], v[72:75]
  v_mfma_f32_16x16x32_bf16 v[76:79], a[52:55], v[92:95], v[76:79]
  ds_read_b128 v[88:91], v165 offset:58368
  s_waitcnt vmcnt(14) lgkmcnt(6)
  v_mfma_f32_16x16x32_bf16 v[48:51], a[56:59], v[96:99], v[48:51]
  s_waitcnt vmcnt(13)
  v_mfma_f32_16x16x32_bf16 v[52:55], a[60:63], v[96:99], v[52:55]
  ds_read_b128 v[92:95], v165 offset:58624
  s_waitcnt lgkmcnt(6)
  v_mfma_f32_16x16x32_bf16 v[56:59], a[56:59], v[100:103], v[56:59]
  v_mfma_f32_16x16x32_bf16 v[60:63], a[60:63], v[100:103], v[60:63]
  ds_read_b128 v[96:99], v165 offset:61440
  s_waitcnt lgkmcnt(6)
  v_mfma_f32_16x16x32_bf16 v[64:67], a[56:59], v[104:107], v[64:67]
  v_mfma_f32_16x16x32_bf16 v[68:71], a[60:63], v[104:107], v[68:71]
  ds_read_b128 v[100:103], v165 offset:61696
  s_waitcnt lgkmcnt(6)
  v_mfma_f32_16x16x32_bf16 v[72:75], a[56:59], v[108:111], v[72:75]
  v_mfma_f32_16x16x32_bf16 v[76:79], a[60:63], v[108:111], v[76:79]
  ds_read_b128 v[104:107], v165 offset:62464
  s_waitcnt vmcnt(12) lgkmcnt(6)
  v_mfma_f32_16x16x32_bf16 v[48:51], a[0:3], v[80:83], v[48:51]
  s_waitcnt vmcnt(11)
  v_mfma_f32_16x16x32_bf16 v[52:55], a[4:7], v[80:83], v[52:55]
  ds_read_b128 v[108:111], v165 offset:62720
  s_waitcnt lgkmcnt(6)
  v_mfma_f32_16x16x32_bf16 v[56:59], a[0:3], v[84:87], v[56:59]
  v_mfma_f32_16x16x32_bf16 v[60:63], a[4:7], v[84:87], v[60:63]
  ds_read_b128 v[80:83], v166 offset:0
  s_waitcnt lgkmcnt(6)
  v_mfma_f32_16x16x32_bf16 v[64:67], a[0:3], v[88:91], v[64:67]
  v_mfma_f32_16x16x32_bf16 v[68:71], a[4:7], v[88:91], v[68:71]
  ds_read_b128 v[84:87], v166 offset:256
  s_waitcnt lgkmcnt(6)
  v_mfma_f32_16x16x32_bf16 v[72:75], a[0:3], v[92:95], v[72:75]
  v_mfma_f32_16x16x32_bf16 v[76:79], a[4:7], v[92:95], v[76:79]
  ds_read_b128 v[88:91], v166 offset:1024
  s_waitcnt vmcnt(10) lgkmcnt(6)
  v_mfma_f32_16x16x32_bf16 v[48:51], a[8:11], v[96:99], v[48:51]
  s_waitcnt vmcnt(9)
  v_mfma_f32_16x16x32_bf16 v[52:55], a[12:15], v[96:99], v[52:55]
  ds_read_b128 v[92:95], v166 offset:1280
  s_waitcnt lgkmcnt(6)
  v_mfma_f32_16x16x32_bf16 v[56:59], a[8:11], v[100:103], v[56:59]
  v_mfma_f32_16x16x32_bf16 v[60:63], a[12:15], v[100:103], v[60:63]
  ds_read_b128 v[96:99], v166 offset:4096
  s_waitcnt lgkmcnt(6)
  v_mfma_f32_16x16x32_bf16 v[64:67], a[8:11], v[104:107], v[64:67]
  v_mfma_f32_16x16x32_bf16 v[68:71], a[12:15], v[104:107], v[68:71]
  ds_read_b128 v[100:103], v166 offset:4352
  s_waitcnt lgkmcnt(6)
  v_mfma_f32_16x16x32_bf16 v[72:75], a[8:11], v[108:111], v[72:75]
  v_mfma_f32_16x16x32_bf16 v[76:79], a[12:15], v[108:111], v[76:79]
  ds_read_b128 v[104:107], v166 offset:5120
  s_waitcnt vmcnt(8) lgkmcnt(6)
  v_mfma_f32_16x16x32_bf16 v[48:51], a[16:19], v[80:83], v[48:51]
  s_waitcnt vmcnt(7)
  v_mfma_f32_16x16x32_bf16 v[52:55], a[20:23], v[80:83], v[52:55]
  ds_read_b128 v[108:111], v166 offset:5376
  s_waitcnt lgkmcnt(6)
  v_mfma_f32_16x16x32_bf16 v[56:59], a[16:19], v[84:87], v[56:59]
  v_mfma_f32_16x16x32_bf16 v[60:63], a[20:23], v[84:87], v[60:63]
  s_waitcnt lgkmcnt(5)
  v_mfma_f32_16x16x32_bf16 v[64:67], a[16:19], v[88:91], v[64:67]
  v_mfma_f32_16x16x32_bf16 v[68:71], a[20:23], v[88:91], v[68:71]
  s_waitcnt lgkmcnt(4)
  v_mfma_f32_16x16x32_bf16 v[72:75], a[16:19], v[92:95], v[72:75]
  v_mfma_f32_16x16x32_bf16 v[76:79], a[20:23], v[92:95], v[76:79]
  s_waitcnt vmcnt(6) lgkmcnt(3)
  v_mfma_f32_16x16x32_bf16 v[48:51], a[24:27], v[96:99], v[48:51]
  s_waitcnt vmcnt(5)
  v_mfma_f32_16x16x32_bf16 v[52:55], a[28:31], v[96:99], v[52:55]
  s_waitcnt lgkmcnt(2)
  v_mfma_f32_16x16x32_bf16 v[56:59], a[24:27], v[100:103], v[56:59]
  v_mfma_f32_16x16x32_bf16 v[60:63], a[28:31], v[100:103], v[60:63]
  s_waitcnt lgkmcnt(1)
  v_mfma_f32_16x16x32_bf16 v[64:67], a[24:27], v[104:107], v[64:67]
  v_mfma_f32_16x16x32_bf16 v[68:71], a[28:31], v[104:107], v[68:71]
  s_waitcnt lgkmcnt(0)
  v_mfma_f32_16x16x32_bf16 v[72:75], a[24:27], v[108:111], v[72:75]
  v_mfma_f32_16x16x32_bf16 v[76:79], a[28:31], v[108:111], v[76:79]
  v_mul_f32 v128, 0x3fb8aa3b, v48
  v_mul_f32 v129, 0x3fb8aa3b, v49
  v_mul_f32 v130, 0x3fb8aa3b, v50
  v_mul_f32 v131, 0x3fb8aa3b, v51
  v_exp_f32 v128, v128 clamp
  v_exp_f32 v129, v129 clamp
  s_addk_i32 s50, 4096
  buffer_load_dwordx4 a[64:67], v3, s[8:11], s50 offen offset:0 sc1
  v_exp_f32 v130, v130 clamp
  v_exp_f32 v131, v131 clamp
  v_max_f32 v48, 0x358637bd, v48
  v_max_f32 v49, 0x358637bd, v49
  v_max_f32 v50, 0x358637bd, v50
  v_max_f32 v51, 0x358637bd, v51
  v_add_f32 v48, v48, v128
  v_add_f32 v49, v49, v129
  v_add_f32 v50, v50, v130
  v_add_f32 v51, v51, v131
  s_add_u32 s50, s50, 28672
  buffer_load_dwordx4 a[228:231], v3, s[8:11], s50 offen offset:0 sc1
  v_mul_f32 v128, 0x3fb8aa3b, v52
  v_mul_f32 v129, 0x3fb8aa3b, v53
  v_mul_f32 v130, 0x3fb8aa3b, v54
  v_mul_f32 v131, 0x3fb8aa3b, v55
  v_exp_f32 v128, v128 clamp
  v_exp_f32 v129, v129 clamp
  v_exp_f32 v130, v130 clamp
  buffer_load_dwordx4 a[208:211], v3, s[8:11], s50 offen offset:1024 sc1
  v_exp_f32 v131, v131 clamp
  v_max_f32 v52, 0x358637bd, v52
  v_max_f32 v53, 0x358637bd, v53
  v_max_f32 v54, 0x358637bd, v54
  v_max_f32 v55, 0x358637bd, v55
  v_add_f32 v52, v52, v128
  buffer_load_dwordx4 a[188:191], v3, s[8:11], s50 offen offset:2048 sc1
  v_add_f32 v53, v53, v129
  v_add_f32 v54, v54, v130
  v_add_f32 v55, v55, v131
  v_cvt_pk_bf16_f32 v112, v48, v49
  v_cvt_pk_bf16_f32 v113, v50, v51
  buffer_load_dwordx4 a[168:171], v3, s[8:11], s50 offen offset:3072 sc1
  v_cvt_pk_bf16_f32 v114, v52, v53
  v_cvt_pk_bf16_f32 v115, v54, v55
  v_cvt_pk_bf16_f32 v120, v64, v65
  v_cvt_pk_bf16_f32 v121, v66, v67
  v_cvt_pk_bf16_f32 v122, v68, v69
  v_cvt_pk_bf16_f32 v123, v70, v71
  v_cvt_pk_bf16_f32 v124, v72, v73
  s_addk_i32 s50, 4096
  buffer_load_dwordx4 a[148:151], v3, s[8:11], s50 offen offset:0 sc1
  v_cvt_pk_bf16_f32 v125, v74, v75
  v_cvt_pk_bf16_f32 v126, v76, v77
  v_cvt_pk_bf16_f32 v127, v78, v79
  v_cndmask_b32 v124, v124, v8, s[30:31]
  v_cndmask_b32 v125, v125, v8, s[30:31]
  v_cndmask_b32 v126, v126, v8, s[30:31]
  v_cndmask_b32 v127, v127, v8, s[30:31]
  v_mfma_f32_16x16x32_bf16 v[136:139], v[112:115], v[120:123], v[136:139]
  buffer_load_dwordx4 a[128:131], v3, s[8:11], s50 offen offset:1024 sc1
  v_mfma_f32_16x16x32_bf16 v[140:143], v[112:115], v[124:127], v[140:143]
  v_mul_f32 v128, 0x3fb8aa3b, v56
  v_mul_f32 v129, 0x3fb8aa3b, v57
  v_mul_f32 v130, 0x3fb8aa3b, v58
  v_mul_f32 v131, 0x3fb8aa3b, v59
  buffer_load_dwordx4 a[108:111], v3, s[8:11], s50 offen offset:2048 sc1
  v_exp_f32 v128, v128 clamp
  v_exp_f32 v129, v129 clamp
  v_exp_f32 v130, v130 clamp
  v_exp_f32 v131, v131 clamp
  v_max_f32 v56, 0x358637bd, v56
  buffer_load_dwordx4 a[88:91], v3, s[8:11], s50 offen offset:3072 sc1
  v_max_f32 v57, 0x358637bd, v57
  v_max_f32 v58, 0x358637bd, v58
  v_max_f32 v59, 0x358637bd, v59
  v_add_f32 v56, v56, v128
  v_add_f32 v57, v57, v129
  v_add_f32 v58, v58, v130
  v_add_f32 v59, v59, v131
  v_mul_f32 v128, 0x3fb8aa3b, v60
  s_addk_i32 s50, 4096
  buffer_load_dwordx4 a[68:71], v3, s[8:11], s50 offen offset:0 sc1
  v_mul_f32 v129, 0x3fb8aa3b, v61
  v_mul_f32 v130, 0x3fb8aa3b, v62
  v_mul_f32 v131, 0x3fb8aa3b, v63
  v_exp_f32 v128, v128 clamp
  v_exp_f32 v129, v129 clamp
  v_exp_f32 v130, v130 clamp
  v_exp_f32 v131, v131 clamp
  v_max_f32 v60, 0x358637bd, v60
  v_max_f32 v61, 0x358637bd, v61
  v_max_f32 v62, 0x358637bd, v62
  s_add_u32 s50, s50, 28672
  buffer_load_dwordx4 a[232:235], v3, s[8:11], s50 offen offset:0 sc1
  v_max_f32 v63, 0x358637bd, v63
  v_add_f32 v60, v60, v128
  v_add_f32 v61, v61, v129
  v_add_f32 v62, v62, v130
  v_add_f32 v63, v63, v131
  v_cvt_pk_bf16_f32 v116, v56, v57
  v_cvt_pk_bf16_f32 v117, v58, v59
  v_cvt_pk_bf16_f32 v118, v60, v61
  buffer_load_dwordx4 a[212:215], v3, s[8:11], s50 offen offset:1024 sc1
  v_cvt_pk_bf16_f32 v119, v62, v63
  s_nop 1
  v_mfma_f32_16x16x32_bf16 v[144:147], v[116:119], v[120:123], v[144:147]
  v_mfma_f32_16x16x32_bf16 v[148:151], v[116:119], v[124:127], v[148:151]
  s_mov_b32 exec_lo, 0xff00ff00
  s_mov_b32 exec_hi, 0xff00ff00
  ds_write2_b64 v5, v[124:125], v[126:127] offset0:64 offset1:66
  s_mov_b32 exec_lo, 0xfff0fff0
  s_mov_b32 exec_hi, 0xfff0fff0
  ds_write2_b64 v5, v[116:117], v[118:119] offset1:2
  s_mov_b64 exec, -1
  ds_read_b64_tr_b16 v[152:153], v6
  buffer_load_dwordx4 a[192:195], v3, s[8:11], s50 offen offset:2048 sc1
  ds_read_b64_tr_b16 v[154:155], v6 offset:768
  ds_read_b64_tr_b16 v[156:157], v6 offset:512
  ds_write_b128 v15, v[136:139]
  ds_write_b128 v15, v[140:143] offset:256
  s_mov_b32 exec_hi, 0
  ds_write_b64 v14, v[144:145] offset:2048
  ds_write_b64 v14, v[148:149] offset:2176
  s_mov_b64 exec, -1
  buffer_load_dwordx4 a[172:175], v3, s[8:11], s50 offen offset:3072 sc1
  s_addk_i32 s50, 4096
  buffer_load_dwordx4 a[152:155], v3, s[8:11], s50 offen offset:0 sc1
  buffer_load_dwordx4 a[132:135], v3, s[8:11], s50 offen offset:1024 sc1
  buffer_load_dwordx4 a[112:115], v3, s[8:11], s50 offen offset:2048 sc1
  buffer_load_dwordx4 a[92:95], v3, s[8:11], s50 offen offset:3072 sc1
  s_addk_i32 s50, 4096
  buffer_load_dwordx4 a[72:75], v3, s[8:11], s50 offen offset:0 sc1
  s_add_u32 s50, s50, 28672
  buffer_load_dwordx4 a[236:239], v3, s[8:11], s50 offen offset:0 sc1
  s_waitcnt lgkmcnt(0)
  s_barrier
  ds_read_b32 v16, v13 offset:0
  ds_read_b32 v17, v13 offset:2560
  ds_read_b32 v18, v13 offset:5120
  ds_read_b32 v19, v13 offset:7680
  ds_read_b32 v20, v13 offset:1024
  ds_read_b32 v21, v13 offset:3584
  ds_read_b32 v22, v13 offset:6144
  ds_read_b32 v23, v13 offset:8704
  ds_read_b32 v24, v13 offset:2048
  ds_read_b32 v25, v13 offset:4608
  ds_read_b32 v26, v13 offset:7168
  ds_read_b32 v27, v13 offset:9728
  v_lshlrev_b32 v132, 16, v154
  v_and_b32 v133, 0xffff0000, v154
  v_lshlrev_b32 v134, 16, v155
  v_and_b32 v135, 0xffff0000, v155
  v_mul_f32 v128, 0x3fb8aa3b, v132
  v_mul_f32 v129, 0x3fb8aa3b, v133
  v_mul_f32 v130, 0x3fb8aa3b, v134
  v_mul_f32 v131, 0x3fb8aa3b, v135
  v_exp_f32 v128, v128 clamp
  v_exp_f32 v129, v129 clamp
  v_exp_f32 v130, v130 clamp
  v_exp_f32 v131, v131 clamp
  v_max_f32 v132, 0x358637bd, v132
  v_max_f32 v133, 0x358637bd, v133
  v_max_f32 v134, 0x358637bd, v134
  v_max_f32 v135, 0x358637bd, v135
  v_add_f32 v132, v132, v128
  v_add_f32 v133, v133, v129
  v_add_f32 v134, v134, v130
  v_add_f32 v135, v135, v131
  v_cvt_pk_bf16_f32 v154, v132, v133
  v_cvt_pk_bf16_f32 v155, v134, v135
  s_waitcnt lgkmcnt(10)
  v_add_f32 v16, v16, v17
  s_waitcnt lgkmcnt(8)
  v_add_f32 v18, v18, v19
  v_add_f32 v16, v16, v18
  s_waitcnt lgkmcnt(6)
  v_add_f32 v20, v20, v21
  s_waitcnt lgkmcnt(4)
  v_add_f32 v22, v22, v23
  v_add_f32 v20, v20, v22
  s_waitcnt lgkmcnt(2)
  v_add_f32 v24, v24, v25
  s_waitcnt lgkmcnt(0)
  v_add_f32 v26, v26, v27
  v_add_f32 v24, v24, v26
  s_mov_b64 exec, s[34:35]
  buffer_atomic_add_f32 v16, v13, s[8:11], s28 offen
  buffer_atomic_add_f32 v20, v13, s[8:11], s28 offen offset:1024
  s_mov_b64 exec, -1
  s_add_u32 s26, s26, 32768
  s_add_u32 s27, s27, 8192
  buffer_store_dwordx4 v[152:155], v3, s[8:11], s26 offen sc1
  buffer_store_dword v156, v7, s[8:11], s27 offen sc1
  s_cmp_eq_u32 s16, 0
  s_cbranch_scc0 L_a1_end
  s_mov_b64 exec, s[38:39]
  buffer_atomic_add_f32 v24, v13, s[8:11], s28 offen offset:2048
  s_mov_b64 exec, -1
L_a1_end:
L_ab:
  s_load_dwordx4 s[96:99], s[0:1], 32
  s_load_dwordx2 s[86:87], s[0:1], 48
  s_and_b32 s17, s2, 7
  s_lshl_b32 s17, s17, 3
  s_bfe_u32 s19, s2, 0x30003
  s_add_u32 s17, s17, s19
  s_mov_b32 s18, s52
  s_waitcnt vmcnt(0)
  s_barrier
  s_cmp_eq_u32 s16, 0
  s_cbranch_scc0 L_ab_ns
  s_mov_b64 exec, 255
  buffer_atomic_add v11, v10, s[8:11], s54 offen
  s_mov_b64 exec, -1
L_ab_ns:
  buffer_load_dwordx4 a[216:219], v3, s[8:11], s50 offen offset:1024 sc1
  buffer_load_dwordx4 a[196:199], v3, s[8:11], s50 offen offset:2048 sc1
  buffer_load_dwordx4 a[176:179], v3, s[8:11], s50 offen offset:3072 sc1
  s_addk_i32 s50, 4096
  buffer_load_dwordx4 a[156:159], v3, s[8:11], s50 offen offset:0 sc1
  buffer_load_dwordx4 a[136:139], v3, s[8:11], s50 offen offset:1024 sc1
  buffer_load_dwordx4 a[116:119], v3, s[8:11], s50 offen offset:2048 sc1
  buffer_load_dwordx4 a[96:99], v3, s[8:11], s50 offen offset:3072 sc1
  s_addk_i32 s50, 4096
  buffer_load_dwordx4 a[76:79], v3, s[8:11], s50 offen offset:0 sc1
  s_mov_b32 s55, 0
  s_cmp_eq_u32 s63, 0
  s_cbranch_scc0 L_ld_e
  s_and_b32 s58, s2, 7
  s_lshr_b32 s60, s2, 3
  s_lshr_b32 s59, s60, 2
  s_and_b32 s100, s60, 3
  s_lshl_b32 s61, s16, 5
  s_sub_u32 s61, s61, 32
  s_cmp_eq_u32 s16, 3
  s_cselect_b32 s55, 16, 32
  s_cmp_lt_u32 s60, s55
  s_cselect_b32 s55, 2, 1
  s_cselect_b32 s61, s61, 0
  s_add_u32 s60, s60, s61
  s_sub_u32 s61, s2, 241
  s_cmp_lt_u32 s61, 8
  s_cselect_b32 s61, 0, 1
  s_add_u32 s61, s61, 80
  s_cmp_eq_u32 s16, 0
  s_cselect_b32 s60, s61, s60
  s_mul_i32 s61, s60, 7282
  s_lshr_b32 s61, s61, 16
  s_mul_i32 s62, s61, 9
  s_sub_u32 s62, s60, s62
  s_cmp_lt_u32 s60, 81
  s_cselect_b32 s55, s55, 0
  s_cmp_eq_u32 s55, 1
  s_cselect_b32 s59, s59, s62
  s_cselect_b32 s100, s100, s61
  s_cselect_b32 s69, 8, 1
  s_cselect_b32 s60, 72, 4
  s_cselect_b32 s61, 0, 36
  s_cselect_b32 s62, 9, 0
  s_cselect_b32 s64, 4, 0
  s_cselect_b32 s65, 0, 4
  s_cmp_eq_u32 s100, 8
  s_cselect_b32 s65, 0, s65
  s_cmp_lt_u32 s58, 4
  s_cselect_b32 s64, s64, 0
  s_cselect_b32 s65, s65, 0
  s_xor_b32 s64, s64, s59
  s_xor_b32 s65, s65, s100
  s_mul_i32 s68, s65, s60
  s_mul_i32 s61, s61, s58
  s_add_u32 s68, s68, s61
  s_mul_i32 s68, s68, 18432
  s_mul_i32 s61, s62, s58
  s_add_u32 s61, s61, s64
  s_lshl_b32 s61, s61, 7
  s_add_u32 s68, s68, s61
  s_mul_i32 s69, s69, 1152
  v_and_b32 v112, 3, v2
  v_bfe_u32 v113, v2, 2, 3
  v_lshrrev_b32 v114, 5, v2
  v_lshlrev_b32 v114, 6, v114
  v_lshl_add_u32 v114, v112, 4, v114
  v_mul_u32_u24 v248, s69, v113
  v_add_u32 v248, v248, v114
  v_lshlrev_b32 v251, 1, v2
  s_lshl_b32 s69, s69, 3
  s_sub_u32 s69, s69, 1024
  s_mul_i32 s62, s16, 18432
  s_add_u32 s62, s62, 90112
  s_mov_b32 s90, 5308416
  s_mov_b32 s91, 0x20000
  s_cmp_eq_u32 s55, 1
  s_waitcnt lgkmcnt(0)
  s_cselect_b32 s88, s96, s86
  s_cselect_b32 s89, s97, s87
  s_mov_b32 s44, s98
  s_mov_b32 s45, s99
  s_mov_b32 s46, 9216
  s_mov_b32 s47, 0x20000
  s_cmp_eq_u32 s55, 0
  s_cbranch_scc1 L_ld_e
  s_cmp_eq_u32 s16, 0
  s_cbranch_scc1 L_ld_e
  s_add_u32 m0, s62, 0
  s_nop 0
  buffer_load_dwordx4 v248, s[88:91], s68 offen offset:0 nt lds
  s_add_u32 s68, s68, s69
  buffer_load_dwordx4 v248, s[88:91], s68 offen offset:1024 nt lds
  s_add_u32 s68, s68, s69
  buffer_load_dwordx4 v248, s[88:91], s68 offen offset:2048 nt lds
  s_add_u32 s68, s68, s69
  buffer_load_dwordx4 v248, s[88:91], s68 offen offset:3072 nt lds
  s_add_u32 s68, s68, s69
  s_addk_i32 s68, 4096
  s_add_u32 m0, s62, 4096
  s_nop 0
  buffer_load_dwordx4 v248, s[88:91], s68 offen offset:0 nt lds
  s_add_u32 s68, s68, s69
  buffer_load_dwordx4 v248, s[88:91], s68 offen offset:1024 nt lds
  s_add_u32 s68, s68, s69
  buffer_load_dwordx4 v248, s[88:91], s68 offen offset:2048 nt lds
  s_add_u32 s68, s68, s69
  buffer_load_dwordx4 v248, s[88:91], s68 offen offset:3072 nt lds
  s_add_u32 s68, s68, s69
  s_addk_i32 s68, 4096
  s_cmp_eq_u32 s55, 1
  s_cbranch_scc0 L_ld_e
  buffer_load_ushort v251, v251, s[44:47], s61 offen
  s_add_u32 m0, s62, 8192
  s_nop 0
  buffer_load_dwordx4 v248, s[88:91], s68 offen offset:0 nt lds
  s_add_u32 s68, s68, s69
  buffer_load_dwordx4 v248, s[88:91], s68 offen offset:1024 nt lds
  s_add_u32 s68, s68, s69
  buffer_load_dwordx4 v248, s[88:91], s68 offen offset:2048 nt lds
  s_add_u32 s68, s68, s69
  buffer_load_dwordx4 v248, s[88:91], s68 offen offset:3072 nt lds
  s_add_u32 s68, s68, s69
  s_addk_i32 s68, 4096
  s_add_u32 m0, s62, 12288
  s_nop 0
  buffer_load_dwordx4 v248, s[88:91], s68 offen offset:0 nt lds
  s_add_u32 s68, s68, s69
  buffer_load_dwordx4 v248, s[88:91], s68 offen offset:1024 nt lds
  s_add_u32 s68, s68, s69
  buffer_load_dwordx4 v248, s[88:91], s68 offen offset:2048 nt lds
  s_add_u32 s68, s68, s69
  buffer_load_dwordx4 v248, s[88:91], s68 offen offset:3072 nt lds
  s_add_u32 s68, s68, s69
  s_addk_i32 s68, 4096
  s_add_u32 m0, s62, 16384
  s_nop 0
  buffer_load_dwordx4 v248, s[88:91], s68 offen offset:0 nt lds
  s_add_u32 s68, s68, s69
  buffer_load_dwordx4 v248, s[88:91], s68 offen offset:1024 nt lds
L_ld_e:
  s_cmp_lt_u32 s51, 2
  s_cbranch_scc0 L_b4
  s_add_u32 s50, s50, 28672
  buffer_load_dwordx4 a[240:243], v3, s[8:11], s50 offen offset:0 sc1
  buffer_load_dwordx4 a[220:223], v3, s[8:11], s50 offen offset:1024 sc1
  buffer_load_dwordx4 a[200:203], v3, s[8:11], s50 offen offset:2048 sc1
  buffer_load_dwordx4 a[180:183], v3, s[8:11], s50 offen offset:3072 sc1
  s_addk_i32 s50, 4096
  buffer_load_dwordx4 a[160:163], v3, s[8:11], s50 offen offset:0 sc1
  buffer_load_dwordx4 a[140:143], v3, s[8:11], s50 offen offset:1024 sc1
  buffer_load_dwordx4 a[120:123], v3, s[8:11], s50 offen offset:2048 sc1
  buffer_load_dwordx4 a[100:103], v3, s[8:11], s50 offen offset:3072 sc1
  s_addk_i32 s50, 4096
  buffer_load_dwordx4 a[80:83], v3, s[8:11], s50 offen offset:0 sc1
  s_lshl_b32 s19, s16, 3
  s_mul_i32 s20, s19, 2560
  s_add_u32 s20, s20, 9699328
  s_add_u32 s20, s20, s63
  s_lshl_b32 s21, s17, 5
  s_add_u32 s21, s21, s19
  s_lshl_b32 s22, s21, 8
  s_lshl_b32 s21, s21, 10
  s_add_u32 s21, s21, 7077888
  s_add_u32 s21, s21, s63
  s_add_u32 s22, s22, 9175040
  s_add_u32 s22, s22, s63
  v_lshlrev_b32 v4, 3, v2
  v_lshlrev_b32 v5, 2, v2
  v_and_b32 v6, 24, v2
  v_cmp_eq_u32 vcc, 24, v6
  v_mov_b32 v6, 0x40000000
  s_nop 0
  v_cndmask_b32 v12, v3, v6, vcc
  v_cndmask_b32 v4, v4, v6, vcc
  v_add_u32 v6, 4096, v3
  s_mul_i32 s25, s17, 36864
  s_lshl_b32 s26, s18, 11
  s_add_u32 s25, s25, s26
  s_lshl_b32 s26, s16, 9
  s_add_u32 s25, s25, s26
  s_add_u32 s25, s25, s63
  s_add_u32 s26, s25, 2359296
  s_add_u32 s27, s25, 4718592
  v_and_b32 v8, 31, v2
  v_lshlrev_b32 v8, 4, v8
  v_lshrrev_b32 v9, 5, v2
  v_lshl_add_u32 v8, v9, 3, v8
  v_add_u32 v9, 4096, v8
  v_add_u32 v10, 8192, v8
  v_and_b32 v246, 31, v2
  v_lshrrev_b32 v247, 5, v2
  v_lshlrev_b32 v8, 4, v246
  v_lshl_add_u32 v8, v247, 11, v8
  v_add_u32 v9, 4096, v8
  s_mul_i32 s31, s17, 36864
  s_lshl_b32 s32, s18, 6
  s_add_u32 s31, s31, s32
  s_lshl_b32 s32, s16, 4
  s_add_u32 s31, s31, s32
  s_cmp_eq_u32 s63, 0
  s_cselect_b32 s26, s31, s26
  s_cselect_b32 s31, 1152, 16
  s_cselect_b32 s32, 64, 2048
  v_mul_u32_u24 v246, s31, v246
  v_mul_u32_u24 v13, s32, v247
  v_lshl_add_u32 v247, v247, 3, v246
  v_add_u32 v246, v246, v13
  s_lshl_b32 s32, s32, 1
  s_add_u32 s31, s26, s32
  s_add_u32 s32, s31, s32
  v_accvgpr_write_b32 a5, 0
  v_accvgpr_write_b32 a11, 0
  v_accvgpr_write_b32 a17, 0
  v_accvgpr_write_b32 a23, 0
  v_accvgpr_write_b32 a29, 0
  v_accvgpr_write_b32 a35, 0
  v_accvgpr_write_b32 a41, 0
  v_accvgpr_write_b32 a47, 0
  s_add_u32 s28, s16, 1
  s_and_b32 s28, s28, 3
  s_mul_i32 s28, s28, 15360
  s_add_u32 s28, s28, 0
  v_add_u32 v243, s28, v3
  s_add_u32 s28, s16, 2
  s_and_b32 s28, s28, 3
  s_mul_i32 s28, s28, 15360
  s_add_u32 s28, s28, 5120
  v_add_u32 v244, s28, v3
  s_add_u32 s28, s16, 3
  s_and_b32 s28, s28, 3
  s_mul_i32 s28, s28, 15360
  s_add_u32 s28, s28, 10240
  v_add_u32 v245, s28, v3
  s_mul_i32 s28, s16, 15360
  v_add_u32 v14, s28, v3
  s_lshl_b32 s28, s17, 8
  s_add_u32 s28, s28, 9781248
  s_add_u32 s28, s28, s63
  s_and_b32 s64, s2, 3
  s_lshl_b32 s64, s64, 1
  s_bfe_u32 s65, s2, 0x10003
  s_add_u32 s64, s64, s65
  s_bfe_u32 s65, s2, 0x10002
  s_lshl_b32 s65, s65, 4
  s_lshr_b32 s66, s2, 4
  s_add_u32 s65, s65, s66
  s_lshl_b32 s64, s64, 2
  s_add_u32 s64, s64, s16
  s_mul_i32 s64, s64, 336896
  s_add_u32 s64, s64, 140172288
  s_lshl_b32 s65, s65, 9
  s_add_u32 s65, s65, 9879552
  s_add_u32 s65, s65, s63
  s_and_b32 s66, s2, 3
  s_lshl_b32 s66, s66, 14
  s_add_u32 s65, s65, s66
  v_bfe_u32 v11, v2, 4, 1
  v_lshlrev_b32 v13, 9, v11
  v_bfe_u32 v11, v2, 3, 1
  v_lshl_add_u32 v13, v11, 8, v13
  v_and_b32 v11, 7, v2
  v_lshl_add_u32 v13, v11, 4, v13
  v_add_u32 v13, 336896, v13
  s_and_b32 s66, s16, 1
  s_lshl_b32 s67, s66, 7
  v_add_u32 v1, s67, v13
  s_mul_i32 s66, s66, 4294293504
  s_add_u32 s66, s66, 336896
  v_lshrrev_b32 v11, 5, v2
  v_mul_lo_u32 v15, v11, s66
  v_add_u32 v1, v1, v15
  v_mul_u32_u24 v11, 3072, v11
  v_add_u32 v13, v13, v11
  s_lshr_b32 s67, s17, 1
  s_lshl_b32 s67, s67, 2
  s_add_u32 s67, s67, s16
  s_lshl_b32 s67, s67, 7
  s_add_u32 s67, s67, 9879552
  s_add_u32 s67, s67, s63
  buffer_load_dwordx4 a[252:255], v13, s[8:11], s64 offen offset:0 sc1
  buffer_load_dwordx4 a[248:251], v13, s[8:11], s64 offen offset:128 sc1
  buffer_load_dwordx4 a[244:247], v13, s[8:11], s64 offen offset:1024 sc1
  s_lshl_b32 s29, s16, 10
  s_bfe_u32 s30, s2, 0x30000
  s_lshl_b32 s30, s30, 12
  s_add_u32 s29, s29, s30
  s_add_u32 s29, s29, 9846784
  s_add_u32 s29, s29, s63
  v_lshlrev_b32 v7, 7, v2
  s_mov_b32 s49, 0x40000
  s_cmp_eq_u32 s16, 0
  s_cbranch_scc0 L_ab5_go
  s_mov_b32 exec_hi, 0
L_ab5_poll:
  buffer_load_dword v250, v7, s[8:11], s29 offen sc1
  s_waitcnt vmcnt(0)
  v_cmp_gt_u32 vcc, 8, v250
  s_nop 4
  s_cbranch_vccz L_ab5_ok
  s_sub_u32 s49, s49, 1
  s_cmp_eq_u32 s49, 0
  s_cbranch_scc0 L_ab5_poll
L_ab5_ok:
  s_mov_b64 exec, -1
L_ab5_go:
  s_barrier
  buffer_load_dwordx4 v[16:19], v12, s[8:11], s20 offen sc1
  buffer_load_dwordx4 v[20:23], v12, s[8:11], s20 offen offset:1024 sc1
  buffer_load_dwordx2 v[24:25], v4, s[8:11], s20 offen offset:2048 sc1
  s_addk_i32 s20, 2560
  buffer_load_dwordx4 a[0:3], v3, s[8:11], s21 offen offset:0 sc1
  buffer_load_dword a4, v5, s[8:11], s22 offen offset:0 sc1
  buffer_load_dwordx4 v[28:31], v12, s[8:11], s20 offen sc1
  buffer_load_dwordx4 v[32:35], v12, s[8:11], s20 offen offset:1024 sc1
  buffer_load_dwordx2 v[36:37], v4, s[8:11], s20 offen offset:2048 sc1
  s_addk_i32 s20, 2560
  buffer_load_dwordx4 a[6:9], v3, s[8:11], s21 offen offset:1024 sc1
  buffer_load_dword a10, v5, s[8:11], s22 offen offset:256 sc1
  buffer_load_dwordx4 v[40:43], v12, s[8:11], s20 offen sc1
  buffer_load_dwordx4 v[44:47], v12, s[8:11], s20 offen offset:1024 sc1
  buffer_load_dwordx2 v[48:49], v4, s[8:11], s20 offen offset:2048 sc1
  s_addk_i32 s20, 2560
  buffer_load_dwordx4 a[12:15], v3, s[8:11], s21 offen offset:2048 sc1
  buffer_load_dword a16, v5, s[8:11], s22 offen offset:512 sc1
  s_waitcnt vmcnt(14)
  v_cvt_pk_bf16_f32 v16, v16, v17
  v_cvt_pk_bf16_f32 v17, v18, v19
  s_waitcnt vmcnt(13)
  v_cvt_pk_bf16_f32 v18, v20, v21
  v_cvt_pk_bf16_f32 v19, v22, v23
  s_waitcnt vmcnt(12)
  v_cvt_pk_bf16_f32 v20, v24, v25
  v_mov_b32 v21, 0
  s_waitcnt vmcnt(11)
  v_mfma_f32_32x32x16_bf16 v[112:127], v[16:19], a[0:3], 0
  s_waitcnt vmcnt(10)
  v_mfma_f32_32x32x8_bf16 v[112:127], v[20:21], a[4:5], v[112:127]
  buffer_load_dwordx4 v[52:55], v12, s[8:11], s20 offen sc1
  buffer_load_dwordx4 v[56:59], v12, s[8:11], s20 offen offset:1024 sc1
  buffer_load_dwordx2 v[60:61], v4, s[8:11], s20 offen offset:2048 sc1
  s_addk_i32 s20, 2560
  buffer_load_dwordx4 a[18:21], v3, s[8:11], s21 offen offset:3072 sc1
  buffer_load_dword a22, v5, s[8:11], s22 offen offset:768 sc1
  s_waitcnt vmcnt(14)
  v_cvt_pk_bf16_f32 v28, v28, v29
  v_cvt_pk_bf16_f32 v29, v30, v31
  s_waitcnt vmcnt(13)
  v_cvt_pk_bf16_f32 v30, v32, v33
  v_cvt_pk_bf16_f32 v31, v34, v35
  s_waitcnt vmcnt(12)
  v_cvt_pk_bf16_f32 v32, v36, v37
  v_mov_b32 v33, 0
  s_waitcnt vmcnt(11)
  v_mfma_f32_32x32x16_bf16 v[128:143], v[28:31], a[6:9], 0
  s_waitcnt vmcnt(10)
  v_mfma_f32_32x32x8_bf16 v[128:143], v[32:33], a[10:11], v[128:143]
  buffer_load_dwordx4 v[64:67], v12, s[8:11], s20 offen sc1
  v_add_f32 v11, 0x358637bd, v122
  v_rcp_f32 v11, v11
  s_nop 0
  v_mul_f32 v112, v112, v11
  buffer_load_dwordx4 v[68:71], v12, s[8:11], s20 offen offset:1024 sc1
  v_mul_f32 v113, v113, v11
  v_mul_f32 v114, v114, v11
  v_mul_f32 v115, v115, v11
  buffer_load_dwordx2 v[72:73], v4, s[8:11], s20 offen offset:2048 sc1
  s_addk_i32 s20, 2560
  v_mul_f32 v116, v116, v11
  v_mul_f32 v117, v117, v11
  v_mul_f32 v118, v118, v11
  buffer_load_dwordx4 a[24:27], v6, s[8:11], s21 offen offset:0 sc1
  v_mul_f32 v119, v119, v11
  v_mul_f32 v120, v120, v11
  v_mul_f32 v121, v121, v11
  buffer_load_dword a28, v5, s[8:11], s22 offen offset:1024 sc1
  v_cvt_pk_bf16_f32 v24, v112, v113
  v_cvt_pk_bf16_f32 v25, v114, v115
  v_cvt_pk_bf16_f32 v26, v116, v117
  v_cvt_pk_bf16_f32 v27, v118, v119
  v_cvt_pk_bf16_f32 v144, v120, v121
  s_waitcnt vmcnt(14)
  v_cvt_pk_bf16_f32 v40, v40, v41
  v_cvt_pk_bf16_f32 v41, v42, v43
  s_waitcnt vmcnt(13)
  v_cvt_pk_bf16_f32 v42, v44, v45
  v_cvt_pk_bf16_f32 v43, v46, v47
  s_waitcnt vmcnt(12)
  v_cvt_pk_bf16_f32 v44, v48, v49
  v_mov_b32 v45, 0
  s_waitcnt vmcnt(11)
  v_mfma_f32_32x32x16_bf16 v[112:127], v[40:43], a[12:15], 0
  s_waitcnt vmcnt(10)
  v_mfma_f32_32x32x8_bf16 v[112:127], v[44:45], a[16:17], v[112:127]
  v_mfma_f32_32x32x16_bf16 v[152:167], a[224:227], v[24:27], 0
  buffer_load_dwordx4 v[76:79], v12, s[8:11], s20 offen sc1
  v_add_f32 v11, 0x358637bd, v138
  v_rcp_f32 v11, v11
  s_nop 0
  v_mul_f32 v128, v128, v11
  v_mfma_f32_32x32x16_bf16 v[168:183], a[228:231], v[24:27], 0
  buffer_load_dwordx4 v[80:83], v12, s[8:11], s20 offen offset:1024 sc1
  v_mul_f32 v129, v129, v11
  v_mul_f32 v130, v130, v11
  v_mul_f32 v131, v131, v11
  v_mfma_f32_32x32x16_bf16 v[184:199], a[232:235], v[24:27], 0
  buffer_load_dwordx2 v[84:85], v4, s[8:11], s20 offen offset:2048 sc1
  s_addk_i32 s20, 2560
  v_mul_f32 v132, v132, v11
  v_mul_f32 v133, v133, v11
  v_mul_f32 v134, v134, v11
  v_mfma_f32_32x32x16_bf16 v[200:215], a[236:239], v[24:27], 0
  buffer_load_dwordx4 a[30:33], v6, s[8:11], s21 offen offset:1024 sc1
  v_mul_f32 v135, v135, v11
  v_mul_f32 v136, v136, v11
  v_mul_f32 v137, v137, v11
  buffer_load_dword a34, v5, s[8:11], s22 offen offset:1280 sc1
  v_mfma_f32_32x32x16_bf16 v[216:231], a[240:243], v[24:27], 0
  v_cvt_pk_bf16_f32 v36, v128, v129
  v_cvt_pk_bf16_f32 v37, v130, v131
  v_cvt_pk_bf16_f32 v38, v132, v133
  v_cvt_pk_bf16_f32 v39, v134, v135
  v_cvt_pk_bf16_f32 v148, v136, v137
  s_waitcnt vmcnt(14)
  v_cvt_pk_bf16_f32 v52, v52, v53
  v_cvt_pk_bf16_f32 v53, v54, v55
  s_waitcnt vmcnt(13)
  v_cvt_pk_bf16_f32 v54, v56, v57
  v_cvt_pk_bf16_f32 v55, v58, v59
  s_waitcnt vmcnt(12)
  v_cvt_pk_bf16_f32 v56, v60, v61
  v_mov_b32 v57, 0
  s_waitcnt vmcnt(11)
  v_mfma_f32_32x32x16_bf16 v[128:143], v[52:55], a[18:21], 0
  s_waitcnt vmcnt(10)
  v_mfma_f32_32x32x8_bf16 v[128:143], v[56:57], a[22:23], v[128:143]
  v_mfma_f32_32x32x16_bf16 v[152:167], a[204:207], v[36:39], v[152:167]
  buffer_load_dwordx4 v[88:91], v12, s[8:11], s20 offen sc1
  v_add_f32 v11, 0x358637bd, v122
  v_rcp_f32 v11, v11
  s_nop 0
  v_mul_f32 v112, v112, v11
  v_mfma_f32_32x32x16_bf16 v[168:183], a[208:211], v[36:39], v[168:183]
  buffer_load_dwordx4 v[92:95], v12, s[8:11], s20 offen offset:1024 sc1
  v_mul_f32 v113, v113, v11
  v_mul_f32 v114, v114, v11
  v_mul_f32 v115, v115, v11
  v_mfma_f32_32x32x16_bf16 v[184:199], a[212:215], v[36:39], v[184:199]
  buffer_load_dwordx2 v[96:97], v4, s[8:11], s20 offen offset:2048 sc1
  s_addk_i32 s20, 2560
  v_mul_f32 v116, v116, v11
  v_mul_f32 v117, v117, v11
  v_mul_f32 v118, v118, v11
  v_mfma_f32_32x32x16_bf16 v[200:215], a[216:219], v[36:39], v[200:215]
  buffer_load_dwordx4 a[36:39], v6, s[8:11], s21 offen offset:2048 sc1
  v_mul_f32 v119, v119, v11
  v_mul_f32 v120, v120, v11
  v_mul_f32 v121, v121, v11
  buffer_load_dword a40, v5, s[8:11], s22 offen offset:1536 sc1
  v_mfma_f32_32x32x16_bf16 v[216:231], a[220:223], v[36:39], v[216:231]
  v_cvt_pk_bf16_f32 v48, v112, v113
  v_cvt_pk_bf16_f32 v49, v114, v115
  v_cvt_pk_bf16_f32 v50, v116, v117
  v_cvt_pk_bf16_f32 v51, v118, v119
  v_cvt_pk_bf16_f32 v145, v120, v121
  s_waitcnt vmcnt(14)
  v_cvt_pk_bf16_f32 v64, v64, v65
  v_cvt_pk_bf16_f32 v65, v66, v67
  s_waitcnt vmcnt(13)
  v_cvt_pk_bf16_f32 v66, v68, v69
  v_cvt_pk_bf16_f32 v67, v70, v71
  s_waitcnt vmcnt(12)
  v_cvt_pk_bf16_f32 v68, v72, v73
  v_mov_b32 v69, 0
  s_waitcnt vmcnt(11)
  v_mfma_f32_32x32x16_bf16 v[112:127], v[64:67], a[24:27], 0
  s_waitcnt vmcnt(10)
  v_mfma_f32_32x32x8_bf16 v[112:127], v[68:69], a[28:29], v[112:127]
  v_mfma_f32_32x32x16_bf16 v[152:167], a[184:187], v[48:51], v[152:167]
  buffer_load_dwordx4 v[100:103], v12, s[8:11], s20 offen sc1
  v_add_f32 v11, 0x358637bd, v138
  v_rcp_f32 v11, v11
  buffer_load_dwordx4 v[104:107], v12, s[8:11], s20 offen offset:1024 sc1
  v_mfma_f32_32x32x16_bf16 v[168:183], a[188:191], v[48:51], v[168:183]
  v_mul_f32 v128, v128, v11
  v_mul_f32 v129, v129, v11
  buffer_load_dwordx2 v[108:109], v4, s[8:11], s20 offen offset:2048 sc1
  v_mul_f32 v130, v130, v11
  v_mul_f32 v131, v131, v11
  v_mfma_f32_32x32x16_bf16 v[184:199], a[192:195], v[48:51], v[184:199]
  buffer_load_dwordx4 a[42:45], v6, s[8:11], s21 offen offset:3072 sc1
  v_mul_f32 v132, v132, v11
  v_mul_f32 v133, v133, v11
  buffer_load_dword a46, v5, s[8:11], s22 offen offset:1792 sc1
  v_mul_f32 v134, v134, v11
  v_mfma_f32_32x32x16_bf16 v[200:215], a[196:199], v[48:51], v[200:215]
  v_mul_f32 v135, v135, v11
  buffer_load_dwordx4 a[240:243], v13, s[8:11], s64 offen offset:1152 sc1
  v_mul_f32 v136, v136, v11
  v_mul_f32 v137, v137, v11
  buffer_load_dwordx4 a[236:239], v1, s[8:11], s64 offen offset:2048 sc1
  v_mfma_f32_32x32x16_bf16 v[216:231], a[200:203], v[48:51], v[216:231]
  v_cvt_pk_bf16_f32 v60, v128, v129
  v_cvt_pk_bf16_f32 v61, v130, v131
  v_cvt_pk_bf16_f32 v62, v132, v133
  v_cvt_pk_bf16_f32 v63, v134, v135
  v_cvt_pk_bf16_f32 v149, v136, v137
  s_waitcnt vmcnt(16)
  v_cvt_pk_bf16_f32 v76, v76, v77
  v_cvt_pk_bf16_f32 v77, v78, v79
  s_waitcnt vmcnt(15)
  v_cvt_pk_bf16_f32 v78, v80, v81
  v_cvt_pk_bf16_f32 v79, v82, v83
  s_waitcnt vmcnt(14)
  v_cvt_pk_bf16_f32 v80, v84, v85
  v_mov_b32 v81, 0
  s_waitcnt vmcnt(13)
  v_mfma_f32_32x32x16_bf16 v[128:143], v[76:79], a[30:33], 0
  s_waitcnt vmcnt(12)
  v_mfma_f32_32x32x8_bf16 v[128:143], v[80:81], a[34:35], v[128:143]
  v_mfma_f32_32x32x16_bf16 v[152:167], a[164:167], v[60:63], v[152:167]
  buffer_load_dwordx4 v[232:235], v246, s[12:15], s26 offen sc1
  v_add_f32 v11, 0x358637bd, v122
  v_rcp_f32 v11, v11
  s_nop 0
  v_mul_f32 v112, v112, v11
  v_mfma_f32_32x32x16_bf16 v[168:183], a[168:171], v[60:63], v[168:183]
  buffer_load_dwordx4 v[236:239], v246, s[12:15], s31 offen sc1
  v_mul_f32 v113, v113, v11
  v_mul_f32 v114, v114, v11
  v_mul_f32 v115, v115, v11
  buffer_load_dwordx2 v[240:241], v247, s[12:15], s32 offen sc1
  v_mfma_f32_32x32x16_bf16 v[184:199], a[172:175], v[60:63], v[184:199]
  v_mul_f32 v116, v116, v11
  v_mul_f32 v117, v117, v11
  v_mul_f32 v118, v118, v11
  s_addk_i32 s64, 4096
  buffer_load_dwordx4 a[232:235], v13, s[8:11], s64 offen offset:1024 sc1
  v_mfma_f32_32x32x16_bf16 v[200:215], a[176:179], v[60:63], v[200:215]
  v_mul_f32 v119, v119, v11
  v_mul_f32 v120, v120, v11
  v_mul_f32 v121, v121, v11
  buffer_load_dwordx4 a[228:231], v13, s[8:11], s64 offen offset:1152 sc1
  v_mfma_f32_32x32x16_bf16 v[216:231], a[180:183], v[60:63], v[216:231]
  v_cvt_pk_bf16_f32 v72, v112, v113
  v_cvt_pk_bf16_f32 v73, v114, v115
  v_cvt_pk_bf16_f32 v74, v116, v117
  v_cvt_pk_bf16_f32 v75, v118, v119
  v_cvt_pk_bf16_f32 v146, v120, v121
  s_waitcnt vmcnt(16)
  v_cvt_pk_bf16_f32 v88, v88, v89
  v_cvt_pk_bf16_f32 v89, v90, v91
  s_waitcnt vmcnt(15)
  v_cvt_pk_bf16_f32 v90, v92, v93
  v_cvt_pk_bf16_f32 v91, v94, v95
  s_waitcnt vmcnt(14)
  v_cvt_pk_bf16_f32 v92, v96, v97
  v_mov_b32 v93, 0
  s_waitcnt vmcnt(13)
  v_mfma_f32_32x32x16_bf16 v[112:127], v[88:91], a[36:39], 0
  s_waitcnt vmcnt(12)
  v_mfma_f32_32x32x8_bf16 v[112:127], v[92:93], a[40:41], v[112:127]
  v_mfma_f32_32x32x16_bf16 v[152:167], a[144:147], v[72:75], v[152:167]
  buffer_load_dwordx4 a[224:227], v13, s[8:11], s64 offen offset:2048 sc1
  v_add_f32 v11, 0x358637bd, v138
  v_rcp_f32 v11, v11
  v_mfma_f32_32x32x16_bf16 v[168:183], a[148:151], v[72:75], v[168:183]
  v_mul_f32 v128, v128, v11
  v_mul_f32 v129, v129, v11
  v_mul_f32 v130, v130, v11
  v_mul_f32 v131, v131, v11
  v_mfma_f32_32x32x16_bf16 v[184:199], a[152:155], v[72:75], v[184:199]
  v_mul_f32 v132, v132, v11
  v_mul_f32 v133, v133, v11
  buffer_load_dwordx4 a[220:223], v13, s[8:11], s64 offen offset:2176 sc1
  v_mul_f32 v134, v134, v11
  v_mfma_f32_32x32x16_bf16 v[200:215], a[156:159], v[72:75], v[200:215]
  v_mul_f32 v135, v135, v11
  v_mul_f32 v136, v136, v11
  v_mul_f32 v137, v137, v11
  v_cvt_pk_bf16_f32 v84, v128, v129
  v_mfma_f32_32x32x16_bf16 v[216:231], a[160:163], v[72:75], v[216:231]
  v_cvt_pk_bf16_f32 v85, v130, v131
  v_cvt_pk_bf16_f32 v86, v132, v133
  v_cvt_pk_bf16_f32 v87, v134, v135
  v_cvt_pk_bf16_f32 v150, v136, v137
  s_waitcnt vmcnt(13)
  v_cvt_pk_bf16_f32 v100, v100, v101
  v_cvt_pk_bf16_f32 v101, v102, v103
  s_waitcnt vmcnt(12)
  v_cvt_pk_bf16_f32 v102, v104, v105
  v_cvt_pk_bf16_f32 v103, v106, v107
  s_waitcnt vmcnt(11)
  v_cvt_pk_bf16_f32 v104, v108, v109
  v_mov_b32 v105, 0
  s_waitcnt vmcnt(10)
  v_mfma_f32_32x32x16_bf16 v[128:143], v[100:103], a[42:45], 0
  s_waitcnt vmcnt(9)
  v_mfma_f32_32x32x8_bf16 v[128:143], v[104:105], a[46:47], v[128:143]
  v_mfma_f32_32x32x16_bf16 v[152:167], a[124:127], v[84:87], v[152:167]
  buffer_load_dwordx4 a[216:219], v1, s[8:11], s64 offen offset:3072 sc1
  v_add_f32 v11, 0x358637bd, v122
  v_rcp_f32 v11, v11
  v_mfma_f32_32x32x16_bf16 v[168:183], a[128:131], v[84:87], v[168:183]
  v_mul_f32 v112, v112, v11
  v_mul_f32 v113, v113, v11
  v_mul_f32 v114, v114, v11
  v_mul_f32 v115, v115, v11
  v_mfma_f32_32x32x16_bf16 v[184:199], a[132:135], v[84:87], v[184:199]
  v_mul_f32 v116, v116, v11
  v_mul_f32 v117, v117, v11
  s_addk_i32 s64, 4096
  buffer_load_dwordx4 a[212:215], v13, s[8:11], s64 offen offset:2048 sc1
  v_mul_f32 v118, v118, v11
  v_mfma_f32_32x32x16_bf16 v[200:215], a[136:139], v[84:87], v[200:215]
  v_mul_f32 v119, v119, v11
  v_mul_f32 v120, v120, v11
  v_mul_f32 v121, v121, v11
  v_cvt_pk_bf16_f32 v96, v112, v113
  v_mfma_f32_32x32x16_bf16 v[216:231], a[140:143], v[84:87], v[216:231]
  v_cvt_pk_bf16_f32 v97, v114, v115
  v_cvt_pk_bf16_f32 v98, v116, v117
  v_cvt_pk_bf16_f32 v99, v118, v119
  v_cvt_pk_bf16_f32 v147, v120, v121
  s_nop 0
  v_mfma_f32_32x32x16_bf16 v[152:167], a[104:107], v[96:99], v[152:167]
  buffer_load_dwordx4 a[208:211], v13, s[8:11], s64 offen offset:2176 sc1
  v_add_f32 v11, 0x358637bd, v138
  v_rcp_f32 v11, v11
  v_mfma_f32_32x32x16_bf16 v[168:183], a[108:111], v[96:99], v[168:183]
  v_mul_f32 v128, v128, v11
  v_mul_f32 v129, v129, v11
  v_mul_f32 v130, v130, v11
  v_mul_f32 v131, v131, v11
  v_mfma_f32_32x32x16_bf16 v[184:199], a[112:115], v[96:99], v[184:199]
  v_mul_f32 v132, v132, v11
  v_mul_f32 v133, v133, v11
  buffer_load_dwordx4 a[204:207], v13, s[8:11], s64 offen offset:3072 sc1
  v_mul_f32 v134, v134, v11
  v_mfma_f32_32x32x16_bf16 v[200:215], a[116:119], v[96:99], v[200:215]
  v_mul_f32 v135, v135, v11
  v_mul_f32 v136, v136, v11
  v_mul_f32 v137, v137, v11
  v_cvt_pk_bf16_f32 v108, v128, v129
  v_mfma_f32_32x32x16_bf16 v[216:231], a[120:123], v[96:99], v[216:231]
  v_cvt_pk_bf16_f32 v109, v130, v131
  v_cvt_pk_bf16_f32 v110, v132, v133
  v_cvt_pk_bf16_f32 v111, v134, v135
  v_cvt_pk_bf16_f32 v151, v136, v137
  s_nop 0
  v_mfma_f32_32x32x16_bf16 v[152:167], a[84:87], v[108:111], v[152:167]
  buffer_load_dwordx4 a[200:203], v13, s[8:11], s64 offen offset:3200 sc1
  v_mfma_f32_32x32x16_bf16 v[168:183], a[88:91], v[108:111], v[168:183]
  v_permlane32_swap_b32 v144, v148
  v_permlane32_swap_b32 v145, v149
  v_mfma_f32_32x32x16_bf16 v[184:199], a[92:95], v[108:111], v[184:199]
  s_addk_i32 s64, 4096
  buffer_load_dwordx4 a[196:199], v1, s[8:11], s64 offen offset:0 sc1
  v_mfma_f32_32x32x16_bf16 v[200:215], a[96:99], v[108:111], v[200:215]
  v_permlane32_swap_b32 v146, v150
  v_mfma_f32_32x32x16_bf16 v[216:231], a[100:103], v[108:111], v[216:231]
  v_permlane32_swap_b32 v147, v151
  s_nop 1
  v_mfma_f32_32x32x16_bf16 v[152:167], a[64:67], v[144:147], v[152:167]
  v_mfma_f32_32x32x16_bf16 v[168:183], a[68:71], v[144:147], v[168:183]
  buffer_load_dwordx4 a[192:195], v13, s[8:11], s64 offen offset:3072 sc1
  v_mfma_f32_32x32x16_bf16 v[184:199], a[72:75], v[144:147], v[184:199]
  v_mfma_f32_32x32x16_bf16 v[200:215], a[76:79], v[144:147], v[200:215]
  buffer_load_dwordx4 a[188:191], v13, s[8:11], s64 offen offset:3200 sc1
  v_mfma_f32_32x32x16_bf16 v[216:231], a[80:83], v[144:147], v[216:231]
  s_nop 5
  ds_write_b128 v243, v[156:159] offset:0
  ds_write_b128 v244, v[160:163] offset:0
  s_addk_i32 s64, 4096
  buffer_load_dwordx4 a[184:187], v13, s[8:11], s64 offen offset:0 sc1
  ds_write_b128 v245, v[164:167] offset:0
  buffer_load_dwordx4 a[180:183], v13, s[8:11], s64 offen offset:128 sc1
  ds_write_b128 v243, v[172:175] offset:1024
  ds_write_b128 v244, v[176:179] offset:1024
  buffer_load_dwordx4 a[176:179], v1, s[8:11], s64 offen offset:1024 sc1
  ds_write_b128 v245, v[180:183] offset:1024
  s_addk_i32 s64, 4096
  buffer_load_dwordx4 a[172:175], v13, s[8:11], s64 offen offset:0 sc1
  ds_write_b128 v243, v[188:191] offset:2048
  ds_write_b128 v244, v[192:195] offset:2048
  buffer_load_dwordx4 a[168:171], v13, s[8:11], s64 offen offset:128 sc1
  ds_write_b128 v245, v[196:199] offset:2048
  buffer_load_dwordx4 a[164:167], v13, s[8:11], s64 offen offset:1024 sc1
  ds_write_b128 v243, v[204:207] offset:3072
  buffer_load_dwordx4 a[160:163], v13, s[8:11], s64 offen offset:1152 sc1
  ds_write_b128 v244, v[208:211] offset:3072
  buffer_load_dwordx4 a[156:159], v1, s[8:11], s64 offen offset:2048 sc1
  ds_write_b128 v245, v[212:215] offset:3072
  ds_write_b128 v243, v[220:223] offset:4096
  s_addk_i32 s64, 4096
  buffer_load_dwordx4 a[152:155], v13, s[8:11], s64 offen offset:1024 sc1
  ds_write_b128 v244, v[224:227] offset:4096
  ds_write_b128 v245, v[228:231] offset:4096
  buffer_load_dwordx4 a[148:151], v13, s[8:11], s64 offen offset:1152 sc1
  s_waitcnt lgkmcnt(0)
  s_barrier
  ds_read_b128 v[16:19], v14 offset:0
  ds_read_b128 v[20:23], v14 offset:5120
  ds_read_b128 v[24:27], v14 offset:10240
  ds_read_b128 v[28:31], v14 offset:1024
  ds_read_b128 v[32:35], v14 offset:6144
  ds_read_b128 v[36:39], v14 offset:11264
  ds_read_b128 v[40:43], v14 offset:2048
  ds_read_b128 v[44:47], v14 offset:7168
  ds_read_b128 v[48:51], v14 offset:12288
  ds_read_b128 v[52:55], v14 offset:3072
  ds_read_b128 v[56:59], v14 offset:8192
  ds_read_b128 v[60:63], v14 offset:13312
  ds_read_b128 v[64:67], v14 offset:4096
  ds_read_b128 v[68:71], v14 offset:9216
  ds_read_b128 v[72:75], v14 offset:14336
  buffer_load_dwordx4 a[144:147], v13, s[8:11], s64 offen offset:2048 sc1
  buffer_load_dwordx4 a[140:143], v13, s[8:11], s64 offen offset:2176 sc1
  buffer_load_dwordx4 a[136:139], v1, s[8:11], s64 offen offset:3072 sc1
  s_addk_i32 s64, 4096
  buffer_load_dwordx4 a[132:135], v13, s[8:11], s64 offen offset:2048 sc1
  v_mov_b32 v15, 0
  v_mov_b32 v11, 0
  s_waitcnt vmcnt(28)
  v_permlane32_swap_b32 v232, v234
  v_permlane32_swap_b32 v233, v235
  s_waitcnt vmcnt(27)
  v_permlane32_swap_b32 v236, v238
  v_permlane32_swap_b32 v237, v239
  v_lshlrev_b32 v156, 16, v232
  v_and_b32 v157, 0xffff0000, v232
  v_lshlrev_b32 v158, 16, v233
  v_and_b32 v159, 0xffff0000, v233
  v_add_f32 v152, v152, v156
  v_add_f32 v153, v153, v157
  v_add_f32 v154, v154, v158
  v_add_f32 v155, v155, v159
  v_lshlrev_b32 v172, 16, v234
  v_and_b32 v173, 0xffff0000, v234
  v_lshlrev_b32 v174, 16, v235
  v_and_b32 v175, 0xffff0000, v235
  v_add_f32 v168, v168, v172
  v_add_f32 v169, v169, v173
  v_add_f32 v170, v170, v174
  v_add_f32 v171, v171, v175
  v_lshlrev_b32 v188, 16, v236
  v_and_b32 v189, 0xffff0000, v236
  v_lshlrev_b32 v190, 16, v237
  v_and_b32 v191, 0xffff0000, v237
  v_add_f32 v184, v184, v188
  v_add_f32 v185, v185, v189
  v_add_f32 v186, v186, v190
  v_add_f32 v187, v187, v191
  v_lshlrev_b32 v204, 16, v238
  v_and_b32 v205, 0xffff0000, v238
  v_lshlrev_b32 v206, 16, v239
  v_and_b32 v207, 0xffff0000, v239
  v_add_f32 v200, v200, v204
  v_add_f32 v201, v201, v205
  v_add_f32 v202, v202, v206
  v_add_f32 v203, v203, v207
  s_waitcnt vmcnt(26)
  v_lshlrev_b32 v220, 16, v240
  v_and_b32 v221, 0xffff0000, v240
  v_lshlrev_b32 v222, 16, v241
  v_and_b32 v223, 0xffff0000, v241
  v_add_f32 v216, v216, v220
  v_add_f32 v217, v217, v221
  v_add_f32 v218, v218, v222
  v_add_f32 v219, v219, v223
  s_waitcnt lgkmcnt(14)
  v_add_f32 v152, v152, v16
  v_add_f32 v153, v153, v17
  v_add_f32 v154, v154, v18
  v_add_f32 v155, v155, v19
  s_waitcnt lgkmcnt(12)
  v_add_f32 v20, v20, v24
  v_add_f32 v21, v21, v25
  v_add_f32 v22, v22, v26
  v_add_f32 v23, v23, v27
  v_add_f32 v152, v152, v20
  v_add_f32 v153, v153, v21
  v_add_f32 v154, v154, v22
  v_add_f32 v155, v155, v23
  v_cvt_pk_bf16_f32 v232, v152, v153
  v_cvt_pk_bf16_f32 v233, v154, v155
  s_waitcnt lgkmcnt(11)
  v_add_f32 v168, v168, v28
  v_add_f32 v169, v169, v29
  v_add_f32 v170, v170, v30
  v_add_f32 v171, v171, v31
  s_waitcnt lgkmcnt(9)
  v_add_f32 v32, v32, v36
  v_add_f32 v33, v33, v37
  v_add_f32 v34, v34, v38
  v_add_f32 v35, v35, v39
  v_add_f32 v168, v168, v32
  v_add_f32 v169, v169, v33
  v_add_f32 v170, v170, v34
  v_add_f32 v171, v171, v35
  v_cvt_pk_bf16_f32 v234, v168, v169
  v_cvt_pk_bf16_f32 v235, v170, v171
  s_nop 0
  v_permlane32_swap_b32 v232, v234
  v_permlane32_swap_b32 v233, v235
  buffer_store_dwordx4 v[232:235], v8, s[8:11], s27 offen sc1
  s_waitcnt lgkmcnt(8)
  v_add_f32 v184, v184, v40
  v_add_f32 v185, v185, v41
  v_add_f32 v186, v186, v42
  v_add_f32 v187, v187, v43
  s_waitcnt lgkmcnt(6)
  v_add_f32 v44, v44, v48
  v_add_f32 v45, v45, v49
  v_add_f32 v46, v46, v50
  v_add_f32 v47, v47, v51
  v_add_f32 v184, v184, v44
  v_add_f32 v185, v185, v45
  v_add_f32 v186, v186, v46
  v_add_f32 v187, v187, v47
  v_cvt_pk_bf16_f32 v236, v184, v185
  v_cvt_pk_bf16_f32 v237, v186, v187
  s_waitcnt lgkmcnt(5)
  v_add_f32 v200, v200, v52
  v_add_f32 v201, v201, v53
  v_add_f32 v202, v202, v54
  v_add_f32 v203, v203, v55
  s_waitcnt lgkmcnt(3)
  v_add_f32 v56, v56, v60
  v_add_f32 v57, v57, v61
  v_add_f32 v58, v58, v62
  v_add_f32 v59, v59, v63
  v_add_f32 v200, v200, v56
  v_add_f32 v201, v201, v57
  v_add_f32 v202, v202, v58
  v_add_f32 v203, v203, v59
  v_cvt_pk_bf16_f32 v238, v200, v201
  v_cvt_pk_bf16_f32 v239, v202, v203
  s_nop 0
  v_permlane32_swap_b32 v236, v238
  v_permlane32_swap_b32 v237, v239
  buffer_store_dwordx4 v[236:239], v9, s[8:11], s27 offen sc1
  s_waitcnt lgkmcnt(2)
  v_add_f32 v216, v216, v64
  v_add_f32 v217, v217, v65
  v_add_f32 v218, v218, v66
  v_add_f32 v219, v219, v67
  s_waitcnt lgkmcnt(0)
  v_add_f32 v68, v68, v72
  v_add_f32 v69, v69, v73
  v_add_f32 v70, v70, v74
  v_add_f32 v71, v71, v75
  v_add_f32 v216, v216, v68
  v_add_f32 v217, v217, v69
  v_add_f32 v218, v218, v70
  v_add_f32 v219, v219, v71
  v_cvt_pk_bf16_f32 v240, v216, v217
  v_cvt_pk_bf16_f32 v241, v218, v219
  buffer_store_dwordx2 v[240:241], v10, s[8:11], s27 offen offset:0 sc1
  v_lshlrev_b32 v156, 16, v232
  v_and_b32 v157, 0xffff0000, v232
  v_lshlrev_b32 v158, 16, v233
  v_and_b32 v159, 0xffff0000, v233
  v_add_f32 v15, v15, v156
  v_fmac_f32 v11, v156, v156
  v_add_f32 v15, v15, v157
  v_fmac_f32 v11, v157, v157
  v_add_f32 v15, v15, v158
  v_fmac_f32 v11, v158, v158
  v_add_f32 v15, v15, v159
  v_fmac_f32 v11, v159, v159
  v_lshlrev_b32 v172, 16, v234
  v_and_b32 v173, 0xffff0000, v234
  v_lshlrev_b32 v174, 16, v235
  v_and_b32 v175, 0xffff0000, v235
  v_add_f32 v15, v15, v172
  v_fmac_f32 v11, v172, v172
  v_add_f32 v15, v15, v173
  v_fmac_f32 v11, v173, v173
  v_add_f32 v15, v15, v174
  v_fmac_f32 v11, v174, v174
  v_add_f32 v15, v15, v175
  v_fmac_f32 v11, v175, v175
  v_lshlrev_b32 v188, 16, v236
  v_and_b32 v189, 0xffff0000, v236
  v_lshlrev_b32 v190, 16, v237
  v_and_b32 v191, 0xffff0000, v237
  v_add_f32 v15, v15, v188
  v_fmac_f32 v11, v188, v188
  v_add_f32 v15, v15, v189
  v_fmac_f32 v11, v189, v189
  v_add_f32 v15, v15, v190
  v_fmac_f32 v11, v190, v190
  v_add_f32 v15, v15, v191
  v_fmac_f32 v11, v191, v191
  v_lshlrev_b32 v204, 16, v238
  v_and_b32 v205, 0xffff0000, v238
  v_lshlrev_b32 v206, 16, v239
  v_and_b32 v207, 0xffff0000, v239
  v_add_f32 v15, v15, v204
  v_fmac_f32 v11, v204, v204
  v_add_f32 v15, v15, v205
  v_fmac_f32 v11, v205, v205
  v_add_f32 v15, v15, v206
  v_fmac_f32 v11, v206, v206
  v_add_f32 v15, v15, v207
  v_fmac_f32 v11, v207, v207
  v_lshlrev_b32 v220, 16, v240
  v_and_b32 v221, 0xffff0000, v240
  v_lshlrev_b32 v222, 16, v241
  v_and_b32 v223, 0xffff0000, v241
  v_add_f32 v15, v15, v220
  v_fmac_f32 v11, v220, v220
  v_add_f32 v15, v15, v221
  v_fmac_f32 v11, v221, v221
  v_add_f32 v15, v15, v222
  v_fmac_f32 v11, v222, v222
  v_add_f32 v15, v15, v223
  v_fmac_f32 v11, v223, v223
  s_nop 1
  v_permlane32_swap_b32 v15, v11
  v_add_f32 v15, v15, v11
  buffer_atomic_add_f32 v15, v5, s[8:11], s28 offen
  v_lshlrev_b32 v4, 14, v2
  v_mov_b32 v6, 1
  s_waitcnt vmcnt(0)
  s_mov_b64 exec, 15
  buffer_atomic_add v6, v4, s[8:11], s67 offen
  s_mov_b64 exec, -1
  s_branch L_bc_c
L_b4:
  s_lshl_b32 s19, s16, 3
  s_mul_i32 s20, s19, 2560
  s_add_u32 s20, s20, 9699328
  s_add_u32 s20, s20, s63
  s_lshl_b32 s21, s17, 5
  s_add_u32 s21, s21, s19
  s_lshl_b32 s22, s21, 8
  s_lshl_b32 s21, s21, 10
  s_add_u32 s21, s21, 7077888
  s_add_u32 s21, s21, s63
  s_add_u32 s22, s22, 9175040
  s_add_u32 s22, s22, s63
  v_lshlrev_b32 v4, 3, v2
  v_lshlrev_b32 v5, 2, v2
  v_and_b32 v6, 24, v2
  v_cmp_eq_u32 vcc, 24, v6
  v_mov_b32 v6, 0x40000000
  s_nop 0
  v_cndmask_b32 v12, v3, v6, vcc
  v_cndmask_b32 v4, v4, v6, vcc
  v_add_u32 v6, 4096, v3
  s_mul_i32 s25, s17, 36864
  s_lshl_b32 s26, s18, 11
  s_add_u32 s25, s25, s26
  s_lshl_b32 s26, s16, 9
  s_add_u32 s25, s25, s26
  s_add_u32 s25, s25, s63
  s_add_u32 s26, s25, 2359296
  s_add_u32 s27, s25, 4718592
  v_and_b32 v8, 31, v2
  v_lshlrev_b32 v8, 4, v8
  v_lshrrev_b32 v9, 5, v2
  v_lshl_add_u32 v8, v9, 3, v8
  v_add_u32 v9, 4096, v8
  v_add_u32 v10, 8192, v8
  v_and_b32 v246, 31, v2
  v_lshrrev_b32 v247, 5, v2
  v_lshlrev_b32 v8, 4, v246
  v_lshl_add_u32 v8, v247, 11, v8
  v_add_u32 v9, 4096, v8
  s_mul_i32 s31, s17, 36864
  s_lshl_b32 s32, s18, 6
  s_add_u32 s31, s31, s32
  s_lshl_b32 s32, s16, 4
  s_add_u32 s31, s31, s32
  s_cmp_eq_u32 s63, 0
  s_cselect_b32 s26, s31, s26
  s_cselect_b32 s31, 1152, 16
  s_cselect_b32 s32, 64, 2048
  v_mul_u32_u24 v246, s31, v246
  v_mul_u32_u24 v13, s32, v247
  v_lshl_add_u32 v247, v247, 3, v246
  v_add_u32 v246, v246, v13
  s_lshl_b32 s32, s32, 1
  s_add_u32 s31, s26, s32
  s_add_u32 s32, s31, s32
  v_accvgpr_write_b32 a5, 0
  v_accvgpr_write_b32 a11, 0
  v_accvgpr_write_b32 a17, 0
  v_accvgpr_write_b32 a23, 0
  v_accvgpr_write_b32 a29, 0
  v_accvgpr_write_b32 a35, 0
  v_accvgpr_write_b32 a41, 0
  v_accvgpr_write_b32 a47, 0
  s_add_u32 s28, s16, 1
  s_and_b32 s28, s28, 3
  s_mul_i32 s28, s28, 12288
  s_add_u32 s28, s28, 0
  v_add_u32 v243, s28, v3
  s_add_u32 s28, s16, 2
  s_and_b32 s28, s28, 3
  s_mul_i32 s28, s28, 12288
  s_add_u32 s28, s28, 4096
  v_add_u32 v244, s28, v3
  s_add_u32 s28, s16, 3
  s_and_b32 s28, s28, 3
  s_mul_i32 s28, s28, 12288
  s_add_u32 s28, s28, 8192
  v_add_u32 v245, s28, v3
  s_mul_i32 s28, s16, 12288
  v_add_u32 v14, s28, v3
  s_lshl_b32 s28, s17, 8
  s_add_u32 s28, s28, 9781248
  s_add_u32 s28, s28, s63
  s_and_b32 s64, s2, 3
  s_lshl_b32 s64, s64, 1
  s_bfe_u32 s65, s2, 0x10003
  s_add_u32 s64, s64, s65
  s_bfe_u32 s65, s2, 0x10002
  s_lshl_b32 s65, s65, 4
  s_lshr_b32 s66, s2, 4
  s_add_u32 s65, s65, s66
  s_lshl_b32 s64, s64, 2
  s_add_u32 s64, s64, s16
  s_mul_i32 s64, s64, 336896
  s_add_u32 s64, s64, 140172288
  s_lshl_b32 s65, s65, 9
  s_add_u32 s65, s65, 9879552
  s_add_u32 s65, s65, s63
  s_and_b32 s66, s2, 3
  s_lshl_b32 s66, s66, 14
  s_add_u32 s65, s65, s66
  v_bfe_u32 v11, v2, 4, 1
  v_lshlrev_b32 v13, 9, v11
  v_bfe_u32 v11, v2, 3, 1
  v_lshl_add_u32 v13, v11, 8, v13
  v_and_b32 v11, 7, v2
  v_lshl_add_u32 v13, v11, 4, v13
  v_add_u32 v13, 336896, v13
  s_and_b32 s66, s16, 1
  s_lshl_b32 s67, s66, 7
  v_add_u32 v1, s67, v13
  s_mul_i32 s66, s66, 4294293504
  s_add_u32 s66, s66, 336896
  v_lshrrev_b32 v11, 5, v2
  v_mul_lo_u32 v15, v11, s66
  v_add_u32 v1, v1, v15
  v_mul_u32_u24 v11, 3072, v11
  v_add_u32 v13, v13, v11
  s_lshr_b32 s67, s17, 1
  s_lshl_b32 s67, s67, 2
  s_add_u32 s67, s67, s16
  s_lshl_b32 s67, s67, 7
  s_add_u32 s67, s67, 9879552
  s_add_u32 s67, s67, s63
  buffer_load_dwordx4 a[252:255], v13, s[8:11], s64 offen offset:0 sc1
  buffer_load_dwordx4 a[248:251], v13, s[8:11], s64 offen offset:128 sc1
  buffer_load_dwordx4 a[244:247], v13, s[8:11], s64 offen offset:1024 sc1
  s_lshl_b32 s29, s16, 10
  s_bfe_u32 s30, s2, 0x30000
  s_lshl_b32 s30, s30, 12
  s_add_u32 s29, s29, s30
  s_add_u32 s29, s29, 9846784
  s_add_u32 s29, s29, s63
  v_lshlrev_b32 v7, 7, v2
  s_mov_b32 s49, 0x40000
  s_cmp_eq_u32 s16, 0
  s_cbranch_scc0 L_ab4_go
  s_mov_b32 exec_hi, 0
L_ab4_poll:
  buffer_load_dword v250, v7, s[8:11], s29 offen sc1
  s_waitcnt vmcnt(0)
  v_cmp_gt_u32 vcc, 8, v250
  s_nop 4
  s_cbranch_vccz L_ab4_ok
  s_sub_u32 s49, s49, 1
  s_cmp_eq_u32 s49, 0
  s_cbranch_scc0 L_ab4_poll
L_ab4_ok:
  s_mov_b64 exec, -1
L_ab4_go:
  s_barrier
  buffer_load_dwordx4 v[16:19], v12, s[8:11], s20 offen sc1
  buffer_load_dwordx4 v[20:23], v12, s[8:11], s20 offen offset:1024 sc1
  buffer_load_dwordx2 v[24:25], v4, s[8:11], s20 offen offset:2048 sc1
  s_addk_i32 s20, 2560
  buffer_load_dwordx4 a[0:3], v3, s[8:11], s21 offen offset:0 sc1
  buffer_load_dword a4, v5, s[8:11], s22 offen offset:0 sc1
  buffer_load_dwordx4 v[28:31], v12, s[8:11], s20 offen sc1
  buffer_load_dwordx4 v[32:35], v12, s[8:11], s20 offen offset:1024 sc1
  buffer_load_dwordx2 v[36:37], v4, s[8:11], s20 offen offset:2048 sc1
  s_addk_i32 s20, 2560
  buffer_load_dwordx4 a[6:9], v3, s[8:11], s21 offen offset:1024 sc1
  buffer_load_dword a10, v5, s[8:11], s22 offen offset:256 sc1
  buffer_load_dwordx4 v[40:43], v12, s[8:11], s20 offen sc1
  buffer_load_dwordx4 v[44:47], v12, s[8:11], s20 offen offset:1024 sc1
  buffer_load_dwordx2 v[48:49], v4, s[8:11], s20 offen offset:2048 sc1
  s_addk_i32 s20, 2560
  buffer_load_dwordx4 a[12:15], v3, s[8:11], s21 offen offset:2048 sc1
  buffer_load_dword a16, v5, s[8:11], s22 offen offset:512 sc1
  s_waitcnt vmcnt(14)
  v_cvt_pk_bf16_f32 v16, v16, v17
  v_cvt_pk_bf16_f32 v17, v18, v19
  s_waitcnt vmcnt(13)
  v_cvt_pk_bf16_f32 v18, v20, v21
  v_cvt_pk_bf16_f32 v19, v22, v23
  s_waitcnt vmcnt(12)
  v_cvt_pk_bf16_f32 v20, v24, v25
  v_mov_b32 v21, 0
  s_waitcnt vmcnt(11)
  v_mfma_f32_32x32x16_bf16 v[112:127], v[16:19], a[0:3], 0
  s_waitcnt vmcnt(10)
  v_mfma_f32_32x32x8_bf16 v[112:127], v[20:21], a[4:5], v[112:127]
  buffer_load_dwordx4 v[52:55], v12, s[8:11], s20 offen sc1
  buffer_load_dwordx4 v[56:59], v12, s[8:11], s20 offen offset:1024 sc1
  buffer_load_dwordx2 v[60:61], v4, s[8:11], s20 offen offset:2048 sc1
  s_addk_i32 s20, 2560
  buffer_load_dwordx4 a[18:21], v3, s[8:11], s21 offen offset:3072 sc1
  buffer_load_dword a22, v5, s[8:11], s22 offen offset:768 sc1
  s_waitcnt vmcnt(14)
  v_cvt_pk_bf16_f32 v28, v28, v29
  v_cvt_pk_bf16_f32 v29, v30, v31
  s_waitcnt vmcnt(13)
  v_cvt_pk_bf16_f32 v30, v32, v33
  v_cvt_pk_bf16_f32 v31, v34, v35
  s_waitcnt vmcnt(12)
  v_cvt_pk_bf16_f32 v32, v36, v37
  v_mov_b32 v33, 0
  s_waitcnt vmcnt(11)
  v_mfma_f32_32x32x16_bf16 v[128:143], v[28:31], a[6:9], 0
  s_waitcnt vmcnt(10)
  v_mfma_f32_32x32x8_bf16 v[128:143], v[32:33], a[10:11], v[128:143]
  buffer_load_dwordx4 v[64:67], v12, s[8:11], s20 offen sc1
  v_add_f32 v11, 0x358637bd, v122
  v_rcp_f32 v11, v11
  s_nop 0
  v_mul_f32 v112, v112, v11
  buffer_load_dwordx4 v[68:71], v12, s[8:11], s20 offen offset:1024 sc1
  v_mul_f32 v113, v113, v11
  v_mul_f32 v114, v114, v11
  v_mul_f32 v115, v115, v11
  buffer_load_dwordx2 v[72:73], v4, s[8:11], s20 offen offset:2048 sc1
  s_addk_i32 s20, 2560
  v_mul_f32 v116, v116, v11
  v_mul_f32 v117, v117, v11
  v_mul_f32 v118, v118, v11
  buffer_load_dwordx4 a[24:27], v6, s[8:11], s21 offen offset:0 sc1
  v_mul_f32 v119, v119, v11
  v_mul_f32 v120, v120, v11
  v_mul_f32 v121, v121, v11
  buffer_load_dword a28, v5, s[8:11], s22 offen offset:1024 sc1
  v_cvt_pk_bf16_f32 v24, v112, v113
  v_cvt_pk_bf16_f32 v25, v114, v115
  v_cvt_pk_bf16_f32 v26, v116, v117
  v_cvt_pk_bf16_f32 v27, v118, v119
  v_cvt_pk_bf16_f32 v144, v120, v121
  s_waitcnt vmcnt(14)
  v_cvt_pk_bf16_f32 v40, v40, v41
  v_cvt_pk_bf16_f32 v41, v42, v43
  s_waitcnt vmcnt(13)
  v_cvt_pk_bf16_f32 v42, v44, v45
  v_cvt_pk_bf16_f32 v43, v46, v47
  s_waitcnt vmcnt(12)
  v_cvt_pk_bf16_f32 v44, v48, v49
  v_mov_b32 v45, 0
  s_waitcnt vmcnt(11)
  v_mfma_f32_32x32x16_bf16 v[112:127], v[40:43], a[12:15], 0
  s_waitcnt vmcnt(10)
  v_mfma_f32_32x32x8_bf16 v[112:127], v[44:45], a[16:17], v[112:127]
  v_mfma_f32_32x32x16_bf16 v[152:167], a[224:227], v[24:27], 0
  buffer_load_dwordx4 v[76:79], v12, s[8:11], s20 offen sc1
  v_add_f32 v11, 0x358637bd, v138
  v_rcp_f32 v11, v11
  s_nop 0
  v_mul_f32 v128, v128, v11
  buffer_load_dwordx4 v[80:83], v12, s[8:11], s20 offen offset:1024 sc1
  v_mfma_f32_32x32x16_bf16 v[168:183], a[228:231], v[24:27], 0
  v_mul_f32 v129, v129, v11
  v_mul_f32 v130, v130, v11
  v_mul_f32 v131, v131, v11
  buffer_load_dwordx2 v[84:85], v4, s[8:11], s20 offen offset:2048 sc1
  s_addk_i32 s20, 2560
  v_mul_f32 v132, v132, v11
  v_mfma_f32_32x32x16_bf16 v[184:199], a[232:235], v[24:27], 0
  v_mul_f32 v133, v133, v11
  v_mul_f32 v134, v134, v11
  buffer_load_dwordx4 a[30:33], v6, s[8:11], s21 offen offset:1024 sc1
  v_mul_f32 v135, v135, v11
  v_mul_f32 v136, v136, v11
  v_mul_f32 v137, v137, v11
  v_mfma_f32_32x32x16_bf16 v[200:215], a[236:239], v[24:27], 0
  buffer_load_dword a34, v5, s[8:11], s22 offen offset:1280 sc1
  v_cvt_pk_bf16_f32 v36, v128, v129
  v_cvt_pk_bf16_f32 v37, v130, v131
  v_cvt_pk_bf16_f32 v38, v132, v133
  v_cvt_pk_bf16_f32 v39, v134, v135
  v_cvt_pk_bf16_f32 v148, v136, v137
  s_waitcnt vmcnt(14)
  v_cvt_pk_bf16_f32 v52, v52, v53
  v_cvt_pk_bf16_f32 v53, v54, v55
  s_waitcnt vmcnt(13)
  v_cvt_pk_bf16_f32 v54, v56, v57
  v_cvt_pk_bf16_f32 v55, v58, v59
  s_waitcnt vmcnt(12)
  v_cvt_pk_bf16_f32 v56, v60, v61
  v_mov_b32 v57, 0
  s_waitcnt vmcnt(11)
  v_mfma_f32_32x32x16_bf16 v[128:143], v[52:55], a[18:21], 0
  s_waitcnt vmcnt(10)
  v_mfma_f32_32x32x8_bf16 v[128:143], v[56:57], a[22:23], v[128:143]
  v_mfma_f32_32x32x16_bf16 v[152:167], a[204:207], v[36:39], v[152:167]
  buffer_load_dwordx4 v[88:91], v12, s[8:11], s20 offen sc1
  v_add_f32 v11, 0x358637bd, v122
  v_rcp_f32 v11, v11
  s_nop 0
  v_mul_f32 v112, v112, v11
  buffer_load_dwordx4 v[92:95], v12, s[8:11], s20 offen offset:1024 sc1
  v_mfma_f32_32x32x16_bf16 v[168:183], a[208:211], v[36:39], v[168:183]
  v_mul_f32 v113, v113, v11
  v_mul_f32 v114, v114, v11
  v_mul_f32 v115, v115, v11
  buffer_load_dwordx2 v[96:97], v4, s[8:11], s20 offen offset:2048 sc1
  s_addk_i32 s20, 2560
  v_mul_f32 v116, v116, v11
  v_mfma_f32_32x32x16_bf16 v[184:199], a[212:215], v[36:39], v[184:199]
  v_mul_f32 v117, v117, v11
  v_mul_f32 v118, v118, v11
  buffer_load_dwordx4 a[36:39], v6, s[8:11], s21 offen offset:2048 sc1
  v_mul_f32 v119, v119, v11
  v_mul_f32 v120, v120, v11
  v_mul_f32 v121, v121, v11
  v_mfma_f32_32x32x16_bf16 v[200:215], a[216:219], v[36:39], v[200:215]
  buffer_load_dword a40, v5, s[8:11], s22 offen offset:1536 sc1
  v_cvt_pk_bf16_f32 v48, v112, v113
  v_cvt_pk_bf16_f32 v49, v114, v115
  v_cvt_pk_bf16_f32 v50, v116, v117
  v_cvt_pk_bf16_f32 v51, v118, v119
  v_cvt_pk_bf16_f32 v145, v120, v121
  s_waitcnt vmcnt(14)
  v_cvt_pk_bf16_f32 v64, v64, v65
  v_cvt_pk_bf16_f32 v65, v66, v67
  s_waitcnt vmcnt(13)
  v_cvt_pk_bf16_f32 v66, v68, v69
  v_cvt_pk_bf16_f32 v67, v70, v71
  s_waitcnt vmcnt(12)
  v_cvt_pk_bf16_f32 v68, v72, v73
  v_mov_b32 v69, 0
  s_waitcnt vmcnt(11)
  v_mfma_f32_32x32x16_bf16 v[112:127], v[64:67], a[24:27], 0
  s_waitcnt vmcnt(10)
  v_mfma_f32_32x32x8_bf16 v[112:127], v[68:69], a[28:29], v[112:127]
  v_mfma_f32_32x32x16_bf16 v[152:167], a[184:187], v[48:51], v[152:167]
  buffer_load_dwordx4 v[100:103], v12, s[8:11], s20 offen sc1
  v_add_f32 v11, 0x358637bd, v138
  v_rcp_f32 v11, v11
  buffer_load_dwordx4 v[104:107], v12, s[8:11], s20 offen offset:1024 sc1
  v_mul_f32 v128, v128, v11
  v_mfma_f32_32x32x16_bf16 v[168:183], a[188:191], v[48:51], v[168:183]
  v_mul_f32 v129, v129, v11
  buffer_load_dwordx2 v[108:109], v4, s[8:11], s20 offen offset:2048 sc1
  v_mul_f32 v130, v130, v11
  v_mul_f32 v131, v131, v11
  buffer_load_dwordx4 a[42:45], v6, s[8:11], s21 offen offset:3072 sc1
  v_mul_f32 v132, v132, v11
  v_mul_f32 v133, v133, v11
  v_mfma_f32_32x32x16_bf16 v[184:199], a[192:195], v[48:51], v[184:199]
  buffer_load_dword a46, v5, s[8:11], s22 offen offset:1792 sc1
  v_mul_f32 v134, v134, v11
  v_mul_f32 v135, v135, v11
  buffer_load_dwordx4 a[240:243], v13, s[8:11], s64 offen offset:1152 sc1
  v_mul_f32 v136, v136, v11
  v_mul_f32 v137, v137, v11
  v_mfma_f32_32x32x16_bf16 v[200:215], a[196:199], v[48:51], v[200:215]
  buffer_load_dwordx4 a[236:239], v1, s[8:11], s64 offen offset:2048 sc1
  v_cvt_pk_bf16_f32 v60, v128, v129
  v_cvt_pk_bf16_f32 v61, v130, v131
  v_cvt_pk_bf16_f32 v62, v132, v133
  v_cvt_pk_bf16_f32 v63, v134, v135
  v_cvt_pk_bf16_f32 v149, v136, v137
  s_waitcnt vmcnt(16)
  v_cvt_pk_bf16_f32 v76, v76, v77
  v_cvt_pk_bf16_f32 v77, v78, v79
  s_waitcnt vmcnt(15)
  v_cvt_pk_bf16_f32 v78, v80, v81
  v_cvt_pk_bf16_f32 v79, v82, v83
  s_waitcnt vmcnt(14)
  v_cvt_pk_bf16_f32 v80, v84, v85
  v_mov_b32 v81, 0
  s_waitcnt vmcnt(13)
  v_mfma_f32_32x32x16_bf16 v[128:143], v[76:79], a[30:33], 0
  s_waitcnt vmcnt(12)
  v_mfma_f32_32x32x8_bf16 v[128:143], v[80:81], a[34:35], v[128:143]
  v_mfma_f32_32x32x16_bf16 v[152:167], a[164:167], v[60:63], v[152:167]
  buffer_load_dwordx4 v[232:235], v246, s[12:15], s26 offen sc1
  v_add_f32 v11, 0x358637bd, v122
  v_rcp_f32 v11, v11
  s_nop 0
  v_mul_f32 v112, v112, v11
  v_mul_f32 v113, v113, v11
  v_mfma_f32_32x32x16_bf16 v[168:183], a[168:171], v[60:63], v[168:183]
  buffer_load_dwordx4 v[236:239], v246, s[12:15], s31 offen sc1
  v_mul_f32 v114, v114, v11
  v_mul_f32 v115, v115, v11
  v_mul_f32 v116, v116, v11
  v_mul_f32 v117, v117, v11
  v_mfma_f32_32x32x16_bf16 v[184:199], a[172:175], v[60:63], v[184:199]
  s_addk_i32 s64, 4096
  buffer_load_dwordx4 a[232:235], v13, s[8:11], s64 offen offset:1024 sc1
  v_mul_f32 v118, v118, v11
  v_mul_f32 v119, v119, v11
  v_mul_f32 v120, v120, v11
  v_mul_f32 v121, v121, v11
  v_mfma_f32_32x32x16_bf16 v[200:215], a[176:179], v[60:63], v[200:215]
  buffer_load_dwordx4 a[228:231], v13, s[8:11], s64 offen offset:1152 sc1
  v_cvt_pk_bf16_f32 v72, v112, v113
  v_cvt_pk_bf16_f32 v73, v114, v115
  v_cvt_pk_bf16_f32 v74, v116, v117
  v_cvt_pk_bf16_f32 v75, v118, v119
  v_cvt_pk_bf16_f32 v146, v120, v121
  s_waitcnt vmcnt(15)
  v_cvt_pk_bf16_f32 v88, v88, v89
  v_cvt_pk_bf16_f32 v89, v90, v91
  s_waitcnt vmcnt(14)
  v_cvt_pk_bf16_f32 v90, v92, v93
  v_cvt_pk_bf16_f32 v91, v94, v95
  s_waitcnt vmcnt(13)
  v_cvt_pk_bf16_f32 v92, v96, v97
  v_mov_b32 v93, 0
  s_waitcnt vmcnt(12)
  v_mfma_f32_32x32x16_bf16 v[112:127], v[88:91], a[36:39], 0
  s_waitcnt vmcnt(11)
  v_mfma_f32_32x32x8_bf16 v[112:127], v[92:93], a[40:41], v[112:127]
  v_mfma_f32_32x32x16_bf16 v[152:167], a[144:147], v[72:75], v[152:167]
  buffer_load_dwordx4 a[224:227], v13, s[8:11], s64 offen offset:2048 sc1
  v_add_f32 v11, 0x358637bd, v138
  v_rcp_f32 v11, v11
  s_nop 0
  v_mul_f32 v128, v128, v11
  v_mfma_f32_32x32x16_bf16 v[168:183], a[148:151], v[72:75], v[168:183]
  v_mul_f32 v129, v129, v11
  v_mul_f32 v130, v130, v11
  v_mul_f32 v131, v131, v11
  v_mul_f32 v132, v132, v11
  v_mul_f32 v133, v133, v11
  v_mfma_f32_32x32x16_bf16 v[184:199], a[152:155], v[72:75], v[184:199]
  buffer_load_dwordx4 a[220:223], v13, s[8:11], s64 offen offset:2176 sc1
  v_mul_f32 v134, v134, v11
  v_mul_f32 v135, v135, v11
  v_mul_f32 v136, v136, v11
  v_mul_f32 v137, v137, v11
  v_mfma_f32_32x32x16_bf16 v[200:215], a[156:159], v[72:75], v[200:215]
  v_cvt_pk_bf16_f32 v84, v128, v129
  v_cvt_pk_bf16_f32 v85, v130, v131
  v_cvt_pk_bf16_f32 v86, v132, v133
  v_cvt_pk_bf16_f32 v87, v134, v135
  v_cvt_pk_bf16_f32 v150, v136, v137
  s_waitcnt vmcnt(12)
  v_cvt_pk_bf16_f32 v100, v100, v101
  v_cvt_pk_bf16_f32 v101, v102, v103
  s_waitcnt vmcnt(11)
  v_cvt_pk_bf16_f32 v102, v104, v105
  v_cvt_pk_bf16_f32 v103, v106, v107
  s_waitcnt vmcnt(10)
  v_cvt_pk_bf16_f32 v104, v108, v109
  v_mov_b32 v105, 0
  s_waitcnt vmcnt(9)
  v_mfma_f32_32x32x16_bf16 v[128:143], v[100:103], a[42:45], 0
  s_waitcnt vmcnt(8)
  v_mfma_f32_32x32x8_bf16 v[128:143], v[104:105], a[46:47], v[128:143]
  v_mfma_f32_32x32x16_bf16 v[152:167], a[124:127], v[84:87], v[152:167]
  buffer_load_dwordx4 a[216:219], v1, s[8:11], s64 offen offset:3072 sc1
  v_add_f32 v11, 0x358637bd, v122
  v_rcp_f32 v11, v11
  s_nop 0
  v_mul_f32 v112, v112, v11
  v_mfma_f32_32x32x16_bf16 v[168:183], a[128:131], v[84:87], v[168:183]
  v_mul_f32 v113, v113, v11
  v_mul_f32 v114, v114, v11
  v_mul_f32 v115, v115, v11
  v_mul_f32 v116, v116, v11
  v_mul_f32 v117, v117, v11
  v_mfma_f32_32x32x16_bf16 v[184:199], a[132:135], v[84:87], v[184:199]
  s_addk_i32 s64, 4096
  buffer_load_dwordx4 a[212:215], v13, s[8:11], s64 offen offset:2048 sc1
  v_mul_f32 v118, v118, v11
  v_mul_f32 v119, v119, v11
  v_mul_f32 v120, v120, v11
  v_mul_f32 v121, v121, v11
  v_mfma_f32_32x32x16_bf16 v[200:215], a[136:139], v[84:87], v[200:215]
  v_cvt_pk_bf16_f32 v96, v112, v113
  v_cvt_pk_bf16_f32 v97, v114, v115
  v_cvt_pk_bf16_f32 v98, v116, v117
  v_cvt_pk_bf16_f32 v99, v118, v119
  v_cvt_pk_bf16_f32 v147, v120, v121
  s_nop 0
  v_mfma_f32_32x32x16_bf16 v[152:167], a[104:107], v[96:99], v[152:167]
  buffer_load_dwordx4 a[208:211], v13, s[8:11], s64 offen offset:2176 sc1
  v_add_f32 v11, 0x358637bd, v138
  v_rcp_f32 v11, v11
  s_nop 0
  v_mul_f32 v128, v128, v11
  v_mfma_f32_32x32x16_bf16 v[168:183], a[108:111], v[96:99], v[168:183]
  v_mul_f32 v129, v129, v11
  v_mul_f32 v130, v130, v11
  v_mul_f32 v131, v131, v11
  v_mul_f32 v132, v132, v11
  v_mul_f32 v133, v133, v11
  v_mfma_f32_32x32x16_bf16 v[184:199], a[112:115], v[96:99], v[184:199]
  buffer_load_dwordx4 a[204:207], v13, s[8:11], s64 offen offset:3072 sc1
  v_mul_f32 v134, v134, v11
  v_mul_f32 v135, v135, v11
  v_mul_f32 v136, v136, v11
  v_mul_f32 v137, v137, v11
  v_mfma_f32_32x32x16_bf16 v[200:215], a[116:119], v[96:99], v[200:215]
  v_cvt_pk_bf16_f32 v108, v128, v129
  v_cvt_pk_bf16_f32 v109, v130, v131
  v_cvt_pk_bf16_f32 v110, v132, v133
  v_cvt_pk_bf16_f32 v111, v134, v135
  v_cvt_pk_bf16_f32 v151, v136, v137
  s_nop 0
  v_mfma_f32_32x32x16_bf16 v[152:167], a[84:87], v[108:111], v[152:167]
  buffer_load_dwordx4 a[200:203], v13, s[8:11], s64 offen offset:3200 sc1
  v_permlane32_swap_b32 v144, v148
  v_mfma_f32_32x32x16_bf16 v[168:183], a[88:91], v[108:111], v[168:183]
  v_permlane32_swap_b32 v145, v149
  v_mfma_f32_32x32x16_bf16 v[184:199], a[92:95], v[108:111], v[184:199]
  s_addk_i32 s64, 4096
  buffer_load_dwordx4 a[196:199], v1, s[8:11], s64 offen offset:0 sc1
  v_mfma_f32_32x32x16_bf16 v[200:215], a[96:99], v[108:111], v[200:215]
  v_permlane32_swap_b32 v146, v150
  v_permlane32_swap_b32 v147, v151
  s_nop 1
  v_mfma_f32_32x32x16_bf16 v[152:167], a[64:67], v[144:147], v[152:167]
  buffer_load_dwordx4 a[192:195], v13, s[8:11], s64 offen offset:3072 sc1
  v_mfma_f32_32x32x16_bf16 v[168:183], a[68:71], v[144:147], v[168:183]
  v_mfma_f32_32x32x16_bf16 v[184:199], a[72:75], v[144:147], v[184:199]
  buffer_load_dwordx4 a[188:191], v13, s[8:11], s64 offen offset:3200 sc1
  v_mfma_f32_32x32x16_bf16 v[200:215], a[76:79], v[144:147], v[200:215]
  s_nop 6
  ds_write_b128 v243, v[156:159] offset:0
  s_addk_i32 s64, 4096
  buffer_load_dwordx4 a[184:187], v13, s[8:11], s64 offen offset:0 sc1
  ds_write_b128 v244, v[160:163] offset:0
  ds_write_b128 v245, v[164:167] offset:0
  buffer_load_dwordx4 a[180:183], v13, s[8:11], s64 offen offset:128 sc1
  ds_write_b128 v243, v[172:175] offset:1024
  buffer_load_dwordx4 a[176:179], v1, s[8:11], s64 offen offset:1024 sc1
  ds_write_b128 v244, v[176:179] offset:1024
  s_addk_i32 s64, 4096
  buffer_load_dwordx4 a[172:175], v13, s[8:11], s64 offen offset:0 sc1
  ds_write_b128 v245, v[180:183] offset:1024
  buffer_load_dwordx4 a[168:171], v13, s[8:11], s64 offen offset:128 sc1
  ds_write_b128 v243, v[188:191] offset:2048
  buffer_load_dwordx4 a[164:167], v13, s[8:11], s64 offen offset:1024 sc1
  ds_write_b128 v244, v[192:195] offset:2048
  buffer_load_dwordx4 a[160:163], v13, s[8:11], s64 offen offset:1152 sc1
  ds_write_b128 v245, v[196:199] offset:2048
  buffer_load_dwordx4 a[156:159], v1, s[8:11], s64 offen offset:2048 sc1
  ds_write_b128 v243, v[204:207] offset:3072
  ds_write_b128 v244, v[208:211] offset:3072
  s_addk_i32 s64, 4096
  buffer_load_dwordx4 a[152:155], v13, s[8:11], s64 offen offset:1024 sc1
  ds_write_b128 v245, v[212:215] offset:3072
  buffer_load_dwordx4 a[148:151], v13, s[8:11], s64 offen offset:1152 sc1
  s_waitcnt lgkmcnt(0)
  s_barrier
  ds_read_b128 v[16:19], v14 offset:0
  ds_read_b128 v[20:23], v14 offset:4096
  ds_read_b128 v[24:27], v14 offset:8192
  ds_read_b128 v[28:31], v14 offset:1024
  ds_read_b128 v[32:35], v14 offset:5120
  ds_read_b128 v[36:39], v14 offset:9216
  ds_read_b128 v[40:43], v14 offset:2048
  ds_read_b128 v[44:47], v14 offset:6144
  ds_read_b128 v[48:51], v14 offset:10240
  ds_read_b128 v[52:55], v14 offset:3072
  ds_read_b128 v[56:59], v14 offset:7168
  ds_read_b128 v[60:63], v14 offset:11264
  buffer_load_dwordx4 a[144:147], v13, s[8:11], s64 offen offset:2048 sc1
  buffer_load_dwordx4 a[140:143], v13, s[8:11], s64 offen offset:2176 sc1
  buffer_load_dwordx4 a[136:139], v1, s[8:11], s64 offen offset:3072 sc1
  s_addk_i32 s64, 4096
  buffer_load_dwordx4 a[132:135], v13, s[8:11], s64 offen offset:2048 sc1
  v_mov_b32 v15, 0
  v_mov_b32 v11, 0
  s_waitcnt vmcnt(27)
  v_permlane32_swap_b32 v232, v234
  v_permlane32_swap_b32 v233, v235
  s_waitcnt vmcnt(26)
  v_permlane32_swap_b32 v236, v238
  v_permlane32_swap_b32 v237, v239
  v_lshlrev_b32 v156, 16, v232
  v_and_b32 v157, 0xffff0000, v232
  v_lshlrev_b32 v158, 16, v233
  v_and_b32 v159, 0xffff0000, v233
  v_add_f32 v152, v152, v156
  v_add_f32 v153, v153, v157
  v_add_f32 v154, v154, v158
  v_add_f32 v155, v155, v159
  v_lshlrev_b32 v172, 16, v234
  v_and_b32 v173, 0xffff0000, v234
  v_lshlrev_b32 v174, 16, v235
  v_and_b32 v175, 0xffff0000, v235
  v_add_f32 v168, v168, v172
  v_add_f32 v169, v169, v173
  v_add_f32 v170, v170, v174
  v_add_f32 v171, v171, v175
  v_lshlrev_b32 v188, 16, v236
  v_and_b32 v189, 0xffff0000, v236
  v_lshlrev_b32 v190, 16, v237
  v_and_b32 v191, 0xffff0000, v237
  v_add_f32 v184, v184, v188
  v_add_f32 v185, v185, v189
  v_add_f32 v186, v186, v190
  v_add_f32 v187, v187, v191
  v_lshlrev_b32 v204, 16, v238
  v_and_b32 v205, 0xffff0000, v238
  v_lshlrev_b32 v206, 16, v239
  v_and_b32 v207, 0xffff0000, v239
  v_add_f32 v200, v200, v204
  v_add_f32 v201, v201, v205
  v_add_f32 v202, v202, v206
  v_add_f32 v203, v203, v207
  s_waitcnt lgkmcnt(11)
  v_add_f32 v152, v152, v16
  v_add_f32 v153, v153, v17
  v_add_f32 v154, v154, v18
  v_add_f32 v155, v155, v19
  s_waitcnt lgkmcnt(9)
  v_add_f32 v20, v20, v24
  v_add_f32 v21, v21, v25
  v_add_f32 v22, v22, v26
  v_add_f32 v23, v23, v27
  v_add_f32 v152, v152, v20
  v_add_f32 v153, v153, v21
  v_add_f32 v154, v154, v22
  v_add_f32 v155, v155, v23
  v_cvt_pk_bf16_f32 v232, v152, v153
  v_cvt_pk_bf16_f32 v233, v154, v155
  s_waitcnt lgkmcnt(8)
  v_add_f32 v168, v168, v28
  v_add_f32 v169, v169, v29
  v_add_f32 v170, v170, v30
  v_add_f32 v171, v171, v31
  s_waitcnt lgkmcnt(6)
  v_add_f32 v32, v32, v36
  v_add_f32 v33, v33, v37
  v_add_f32 v34, v34, v38
  v_add_f32 v35, v35, v39
  v_add_f32 v168, v168, v32
  v_add_f32 v169, v169, v33
  v_add_f32 v170, v170, v34
  v_add_f32 v171, v171, v35
  v_cvt_pk_bf16_f32 v234, v168, v169
  v_cvt_pk_bf16_f32 v235, v170, v171
  s_nop 0
  v_permlane32_swap_b32 v232, v234
  v_permlane32_swap_b32 v233, v235
  buffer_store_dwordx4 v[232:235], v8, s[8:11], s27 offen sc1
  s_waitcnt lgkmcnt(5)
  v_add_f32 v184, v184, v40
  v_add_f32 v185, v185, v41
  v_add_f32 v186, v186, v42
  v_add_f32 v187, v187, v43
  s_waitcnt lgkmcnt(3)
  v_add_f32 v44, v44, v48
  v_add_f32 v45, v45, v49
  v_add_f32 v46, v46, v50
  v_add_f32 v47, v47, v51
  v_add_f32 v184, v184, v44
  v_add_f32 v185, v185, v45
  v_add_f32 v186, v186, v46
  v_add_f32 v187, v187, v47
  v_cvt_pk_bf16_f32 v236, v184, v185
  v_cvt_pk_bf16_f32 v237, v186, v187
  s_waitcnt lgkmcnt(2)
  v_add_f32 v200, v200, v52
  v_add_f32 v201, v201, v53
  v_add_f32 v202, v202, v54
  v_add_f32 v203, v203, v55
  s_waitcnt lgkmcnt(0)
  v_add_f32 v56, v56, v60
  v_add_f32 v57, v57, v61
  v_add_f32 v58, v58, v62
  v_add_f32 v59, v59, v63
  v_add_f32 v200, v200, v56
  v_add_f32 v201, v201, v57
  v_add_f32 v202, v202, v58
  v_add_f32 v203, v203, v59
  v_cvt_pk_bf16_f32 v238, v200, v201
  v_cvt_pk_bf16_f32 v239, v202, v203
  s_nop 0
  v_permlane32_swap_b32 v236, v238
  v_permlane32_swap_b32 v237, v239
  buffer_store_dwordx4 v[236:239], v9, s[8:11], s27 offen sc1
  v_lshlrev_b32 v156, 16, v232
  v_and_b32 v157, 0xffff0000, v232
  v_lshlrev_b32 v158, 16, v233
  v_and_b32 v159, 0xffff0000, v233
  v_add_f32 v15, v15, v156
  v_fmac_f32 v11, v156, v156
  v_add_f32 v15, v15, v157
  v_fmac_f32 v11, v157, v157
  v_add_f32 v15, v15, v158
  v_fmac_f32 v11, v158, v158
  v_add_f32 v15, v15, v159
  v_fmac_f32 v11, v159, v159
  v_lshlrev_b32 v172, 16, v234
  v_and_b32 v173, 0xffff0000, v234
  v_lshlrev_b32 v174, 16, v235
  v_and_b32 v175, 0xffff0000, v235
  v_add_f32 v15, v15, v172
  v_fmac_f32 v11, v172, v172
  v_add_f32 v15, v15, v173
  v_fmac_f32 v11, v173, v173
  v_add_f32 v15, v15, v174
  v_fmac_f32 v11, v174, v174
  v_add_f32 v15, v15, v175
  v_fmac_f32 v11, v175, v175
  v_lshlrev_b32 v188, 16, v236
  v_and_b32 v189, 0xffff0000, v236
  v_lshlrev_b32 v190, 16, v237
  v_and_b32 v191, 0xffff0000, v237
  v_add_f32 v15, v15, v188
  v_fmac_f32 v11, v188, v188
  v_add_f32 v15, v15, v189
  v_fmac_f32 v11, v189, v189
  v_add_f32 v15, v15, v190
  v_fmac_f32 v11, v190, v190
  v_add_f32 v15, v15, v191
  v_fmac_f32 v11, v191, v191
  v_lshlrev_b32 v204, 16, v238
  v_and_b32 v205, 0xffff0000, v238
  v_lshlrev_b32 v206, 16, v239
  v_and_b32 v207, 0xffff0000, v239
  v_add_f32 v15, v15, v204
  v_fmac_f32 v11, v204, v204
  v_add_f32 v15, v15, v205
  v_fmac_f32 v11, v205, v205
  v_add_f32 v15, v15, v206
  v_fmac_f32 v11, v206, v206
  v_add_f32 v15, v15, v207
  v_fmac_f32 v11, v207, v207
  s_nop 1
  v_permlane32_swap_b32 v15, v11
  v_add_f32 v15, v15, v11
  buffer_atomic_add_f32 v15, v5, s[8:11], s28 offen
  v_lshlrev_b32 v4, 14, v2
  v_mov_b32 v6, 1
  s_waitcnt vmcnt(0)
  s_mov_b64 exec, 15
  buffer_atomic_add v6, v4, s[8:11], s67 offen
  s_mov_b64 exec, -1
L_bc_c:
  s_mov_b32 s38, s55
  s_cmp_eq_u32 s55, 0
  s_cbranch_scc1 L_lp_e
  s_cmp_eq_u32 s55, 1
  s_cbranch_scc0 L_lp_2
  v_and_b32 v112, 3, v2
  v_bfe_u32 v113, v2, 4, 1
  v_lshl_add_u32 v113, v113, 2, v112
  v_bfe_u32 v114, v2, 2, 2
  v_lshlrev_b32 v114, 6, v114
  v_lshrrev_b32 v112, 5, v2
  v_lshl_add_u32 v114, v112, 10, v114
  v_lshl_add_u32 v116, v113, 3, v114
  v_add_u32 v116, s62, v116
  v_mov_b32 v117, 0
  v_mov_b32 v118, 0
  v_mov_b32 v119, 0x3f803f80
  ds_read_b64_tr_b16 v[152:153], v116 offset:0
  ds_read_b64_tr_b16 v[154:155], v116 offset:256
  ds_read_b64_tr_b16 v[156:157], v116 offset:512
  ds_read_b64_tr_b16 v[158:159], v116 offset:768
  ds_read_b64_tr_b16 v[160:161], v116 offset:2048
  ds_read_b64_tr_b16 v[162:163], v116 offset:2304
  ds_read_b64_tr_b16 v[164:165], v116 offset:2560
  ds_read_b64_tr_b16 v[166:167], v116 offset:2816
  ds_read_b64_tr_b16 v[168:169], v116 offset:4096
  ds_read_b64_tr_b16 v[170:171], v116 offset:4352
  ds_read_b64_tr_b16 v[172:173], v116 offset:4608
  ds_read_b64_tr_b16 v[174:175], v116 offset:4864
  ds_read_b64_tr_b16 v[176:177], v116 offset:6144
  ds_read_b64_tr_b16 v[178:179], v116 offset:6400
  s_mul_i32 s101, s100, 9
  s_lshr_b32 s62, s59, 1
  s_and_b32 s87, s59, 1
  s_lshl_b32 s87, s87, 1
  s_lshl_b32 s88, s58, 2
  s_add_u32 s87, s87, s88
  s_mul_i32 s87, s87, 336896
  s_add_u32 s87, s87, 140509184
  s_add_u32 s88, s62, 91
  s_add_u32 s89, s62, 90
  s_add_u32 s96, s62, 163
  s_cmp_lt_u32 s59, 4
  s_cselect_b32 s60, 5, 4
  s_cselect_b32 s61, 3, 2
  s_cselect_b32 s62, s62, s88
  s_cselect_b32 s96, s89, s96
  s_lshl_b32 s61, s61, 10
  s_sub_u32 s99, 0, s61
  s_cmp_eq_u32 s59, 8
  s_cselect_b32 s60, 5, s60
  s_cselect_b32 s86, 0, s61
  s_cselect_b32 s61, 336896, s61
  s_cselect_b32 s99, s61, s99
  s_cselect_b32 s62, 2, s62
  s_cselect_b32 s96, 92, s96
  s_cselect_b32 s97, 336896, 0
  s_add_u32 s98, s97, 336896
  v_lshrrev_b32 v112, 5, v2
  v_mul_u32_u24 v112, s98, v112
  v_and_b32 v249, 31, v2
  v_lshl_add_u32 v249, v249, 4, v112
  s_add_u32 s86, s86, s98
  s_lshl_b32 s60, s60, 10
  s_lshl_b32 s96, s96, 10
  s_add_u32 s96, s96, s87
  s_lshr_b32 s88, s100, 1
  s_lshl_b32 s88, s88, 9
  s_add_u32 s96, s96, s88
  s_and_b32 s88, s100, 1
  s_lshl_b32 s88, s88, 3
  s_add_u32 s96, s96, s88
  s_add_u32 s97, s97, s96
  s_lshl_b32 s62, s62, 10
  s_add_u32 s87, s87, s62
  s_lshr_b32 s62, s101, 1
  s_mul_i32 s62, s62, s60
  s_add_u32 s87, s87, s62
  s_add_u32 s86, s86, s87
  s_and_b32 s101, s101, 1
  s_mul_i32 s62, s101, s61
  s_add_u32 s87, s87, s62
  s_mul_i32 s62, s101, s99
  s_add_u32 s86, s86, s62
  s_sub_u32 s62, s60, s61
  s_sub_u32 s60, s60, s99
  s_cmp_eq_u32 s101, 0
  s_cselect_b32 s88, s61, s62
  s_cselect_b32 s89, s62, s61
  s_cselect_b32 s90, s99, s60
  s_cselect_b32 s91, s60, s99
  s_cmp_lt_u32 s100, 2
  s_cselect_b32 s93, 0xffff, 0
  s_waitcnt lgkmcnt(13)
  v_dot2c_f32_bf16 v117, v119, v152
  v_dot2c_f32_bf16 v117, v119, v153
  s_waitcnt lgkmcnt(12)
  v_dot2c_f32_bf16 v117, v119, v154
  v_dot2c_f32_bf16 v117, v119, v155
  ds_read_b64_tr_b16 v[180:181], v116 offset:6656
  ds_read_b64_tr_b16 v[182:183], v116 offset:6912
  s_waitcnt lgkmcnt(13)
  v_dot2c_f32_bf16 v118, v119, v156
  v_dot2c_f32_bf16 v118, v119, v157
  s_waitcnt lgkmcnt(12)
  v_dot2c_f32_bf16 v118, v119, v158
  v_dot2c_f32_bf16 v118, v119, v159
  ds_read_b64_tr_b16 v[184:185], v116 offset:8192
  ds_read_b64_tr_b16 v[186:187], v116 offset:8448
  s_waitcnt lgkmcnt(13)
  v_dot2c_f32_bf16 v117, v119, v160
  v_dot2c_f32_bf16 v117, v119, v161
  s_waitcnt lgkmcnt(12)
  v_dot2c_f32_bf16 v117, v119, v162
  v_dot2c_f32_bf16 v117, v119, v163
  ds_read_b64_tr_b16 v[188:189], v116 offset:8704
  ds_read_b64_tr_b16 v[190:191], v116 offset:8960
  s_waitcnt lgkmcnt(13)
  v_dot2c_f32_bf16 v118, v119, v164
  v_dot2c_f32_bf16 v118, v119, v165
  s_waitcnt lgkmcnt(12)
  v_dot2c_f32_bf16 v118, v119, v166
  v_dot2c_f32_bf16 v118, v119, v167
  ds_read_b64_tr_b16 v[192:193], v116 offset:10240
  ds_read_b64_tr_b16 v[194:195], v116 offset:10496
  s_waitcnt lgkmcnt(13)
  v_dot2c_f32_bf16 v117, v119, v168
  v_dot2c_f32_bf16 v117, v119, v169
  s_waitcnt lgkmcnt(12)
  v_dot2c_f32_bf16 v117, v119, v170
  v_dot2c_f32_bf16 v117, v119, v171
  ds_read_b64_tr_b16 v[196:197], v116 offset:10752
  ds_read_b64_tr_b16 v[198:199], v116 offset:11008
  s_waitcnt lgkmcnt(13)
  v_dot2c_f32_bf16 v118, v119, v172
  v_dot2c_f32_bf16 v118, v119, v173
  s_waitcnt lgkmcnt(12)
  v_dot2c_f32_bf16 v118, v119, v174
  v_dot2c_f32_bf16 v118, v119, v175
  ds_read_b64_tr_b16 v[200:201], v116 offset:12288
  ds_read_b64_tr_b16 v[202:203], v116 offset:12544
  s_waitcnt lgkmcnt(13)
  v_dot2c_f32_bf16 v117, v119, v176
  v_dot2c_f32_bf16 v117, v119, v177
  s_waitcnt lgkmcnt(12)
  v_dot2c_f32_bf16 v117, v119, v178
  v_dot2c_f32_bf16 v117, v119, v179
  ds_read_b64_tr_b16 v[204:205], v116 offset:12800
  ds_read_b64_tr_b16 v[206:207], v116 offset:13056
  s_waitcnt lgkmcnt(13)
  v_dot2c_f32_bf16 v118, v119, v180
  v_dot2c_f32_bf16 v118, v119, v181
  s_waitcnt lgkmcnt(12)
  v_dot2c_f32_bf16 v118, v119, v182
  v_dot2c_f32_bf16 v118, v119, v183
  ds_read_b64_tr_b16 v[208:209], v116 offset:14336
  ds_read_b64_tr_b16 v[210:211], v116 offset:14592
  s_waitcnt lgkmcnt(13)
  v_dot2c_f32_bf16 v117, v119, v184
  v_dot2c_f32_bf16 v117, v119, v185
  s_waitcnt lgkmcnt(12)
  v_dot2c_f32_bf16 v117, v119, v186
  v_dot2c_f32_bf16 v117, v119, v187
  ds_read_b64_tr_b16 v[212:213], v116 offset:14848
  ds_read_b64_tr_b16 v[214:215], v116 offset:15104
  s_waitcnt lgkmcnt(13)
  v_dot2c_f32_bf16 v118, v119, v188
  v_dot2c_f32_bf16 v118, v119, v189
  s_waitcnt lgkmcnt(12)
  v_dot2c_f32_bf16 v118, v119, v190
  v_dot2c_f32_bf16 v118, v119, v191
  ds_read_b64_tr_b16 v[216:217], v116 offset:16384
  ds_read_b64_tr_b16 v[218:219], v116 offset:16640
  s_waitcnt lgkmcnt(13)
  v_dot2c_f32_bf16 v117, v119, v192
  v_dot2c_f32_bf16 v117, v119, v193
  s_waitcnt lgkmcnt(12)
  v_dot2c_f32_bf16 v117, v119, v194
  v_dot2c_f32_bf16 v117, v119, v195
  ds_read_b64_tr_b16 v[220:221], v116 offset:16896
  ds_read_b64_tr_b16 v[222:223], v116 offset:17152
  s_waitcnt lgkmcnt(13)
  v_dot2c_f32_bf16 v118, v119, v196
  v_dot2c_f32_bf16 v118, v119, v197
  s_waitcnt lgkmcnt(12)
  v_dot2c_f32_bf16 v118, v119, v198
  v_dot2c_f32_bf16 v118, v119, v199
  s_waitcnt lgkmcnt(11)
  v_dot2c_f32_bf16 v117, v119, v200
  v_dot2c_f32_bf16 v117, v119, v201
  s_waitcnt lgkmcnt(10)
  v_dot2c_f32_bf16 v117, v119, v202
  v_dot2c_f32_bf16 v117, v119, v203
  s_waitcnt lgkmcnt(9)
  v_dot2c_f32_bf16 v118, v119, v204
  v_dot2c_f32_bf16 v118, v119, v205
  s_waitcnt lgkmcnt(8)
  v_dot2c_f32_bf16 v118, v119, v206
  v_dot2c_f32_bf16 v118, v119, v207
  s_waitcnt lgkmcnt(7)
  v_dot2c_f32_bf16 v117, v119, v208
  v_dot2c_f32_bf16 v117, v119, v209
  s_waitcnt lgkmcnt(6)
  v_dot2c_f32_bf16 v117, v119, v210
  v_dot2c_f32_bf16 v117, v119, v211
  s_waitcnt lgkmcnt(5)
  v_dot2c_f32_bf16 v118, v119, v212
  v_dot2c_f32_bf16 v118, v119, v213
  s_waitcnt lgkmcnt(4)
  v_dot2c_f32_bf16 v118, v119, v214
  v_dot2c_f32_bf16 v118, v119, v215
  s_waitcnt lgkmcnt(3)
  v_dot2c_f32_bf16 v117, v119, v216
  v_dot2c_f32_bf16 v117, v119, v217
  s_waitcnt lgkmcnt(2)
  v_dot2c_f32_bf16 v117, v119, v218
  v_dot2c_f32_bf16 v117, v119, v219
  s_waitcnt lgkmcnt(1)
  v_dot2c_f32_bf16 v118, v119, v220
  v_dot2c_f32_bf16 v118, v119, v221
  s_waitcnt lgkmcnt(0)
  v_dot2c_f32_bf16 v118, v119, v222
  v_dot2c_f32_bf16 v118, v119, v223
  s_nop 2
  v_permlane32_swap_b32 v117, v118
  v_add_f32 v117, v117, v118
  v_cvt_pk_bf16_f32 v252, v117, v117
  v_and_b32 v118, 0xffff0000, v252
  v_sub_f32 v118, v117, v118
  v_cvt_pk_bf16_f32 v253, v118, 0
  v_and_b32 v251, s93, v251
  v_lshl_or_b32 v253, v251, 16, v253
  s_branch L_lp_e
L_lp_2:
  v_and_b32 v112, 3, v2
  v_bfe_u32 v113, v2, 4, 1
  v_lshl_add_u32 v113, v113, 2, v112
  v_bfe_u32 v114, v2, 2, 2
  v_lshlrev_b32 v114, 6, v114
  v_lshrrev_b32 v112, 5, v2
  v_lshl_add_u32 v114, v112, 8, v114
  v_lshl_add_u32 v116, v113, 3, v114
  v_add_u32 v116, s62, v116
  ds_read_b64_tr_b16 v[184:185], v116 offset:0
  ds_read_b64_tr_b16 v[186:187], v116 offset:1024
  ds_read_b64_tr_b16 v[188:189], v116 offset:512
  ds_read_b64_tr_b16 v[190:191], v116 offset:1536
  ds_read_b64_tr_b16 v[192:193], v116 offset:2048
  ds_read_b64_tr_b16 v[194:195], v116 offset:3072
  ds_read_b64_tr_b16 v[196:197], v116 offset:2560
  ds_read_b64_tr_b16 v[198:199], v116 offset:3584
  ds_read_b64_tr_b16 v[200:201], v116 offset:4096
  ds_read_b64_tr_b16 v[202:203], v116 offset:5120
  ds_read_b64_tr_b16 v[204:205], v116 offset:4608
  ds_read_b64_tr_b16 v[206:207], v116 offset:5632
  ds_read_b64_tr_b16 v[208:209], v116 offset:6144
  ds_read_b64_tr_b16 v[210:211], v116 offset:7168
  ds_read_b64_tr_b16 v[212:213], v116 offset:6656
  ds_read_b64_tr_b16 v[214:215], v116 offset:7680
  s_and_b32 s62, s59, 1
  s_lshl_b32 s62, s62, 1
  s_lshl_b32 s60, s58, 2
  s_add_u32 s62, s62, s60
  s_mul_i32 s62, s62, 336896
  s_add_u32 s62, s62, 140509184
  s_lshr_b32 s68, s59, 1
  s_add_u32 s61, s68, 1
  s_and_b32 s61, s61, 3
  s_lshl_b32 s61, s61, 4
  s_add_u32 s61, s61, 265
  s_cmp_eq_u32 s59, 8
  s_cselect_b32 s69, 2, 1
  s_cselect_b32 s61, 257, s61
  s_cselect_b32 s101, 0, 1
  s_mul_i32 s69, s69, 336896
  s_lshl_b32 s100, s100, 1
  s_sub_u32 s60, s100, 8
  s_cmp_lt_u32 s100, 8
  s_cselect_b32 s86, s100, s60
  s_mul_i32 s86, s86, 9
  s_add_u32 s86, s86, 167
  s_add_u32 s86, s86, s68
  s_lshl_b32 s99, s60, s101
  s_add_u32 s99, s99, s61
  s_cmp_lt_u32 s60, 8
  s_cselect_b32 s86, s99, s86
  s_cselect_b32 s99, 1, 5
  s_lshl_b32 s99, s99, 10
  s_cmp_eq_u32 s101, 0
  s_cselect_b32 s99, 336896, s99
  s_cselect_b32 s98, 0, s99
  s_lshl_b32 s86, s86, 10
  s_add_u32 s86, s86, s62
  s_add_u32 s88, s86, s99
  s_add_u32 s87, s86, s69
  s_add_u32 s89, s87, s99
  s_sub_u32 s89, s89, s98
  s_add_u32 s87, s87, s98
  s_add_u32 s100, s100, 1
  s_sub_u32 s60, s100, 8
  s_cmp_lt_u32 s100, 8
  s_cselect_b32 s90, s100, s60
  s_mul_i32 s90, s90, 9
  s_add_u32 s90, s90, 167
  s_add_u32 s90, s90, s68
  s_lshl_b32 s99, s60, s101
  s_add_u32 s99, s99, s61
  s_cmp_lt_u32 s60, 8
  s_cselect_b32 s90, s99, s90
  s_cselect_b32 s99, 1, 5
  s_lshl_b32 s99, s99, 10
  s_cmp_eq_u32 s101, 0
  s_cselect_b32 s99, 336896, s99
  s_cselect_b32 s98, 0, s99
  s_lshl_b32 s90, s90, 10
  s_add_u32 s90, s90, s62
  s_add_u32 s96, s90, s99
  s_add_u32 s91, s90, s69
  s_add_u32 s97, s91, s99
  s_sub_u32 s97, s97, s98
  s_add_u32 s91, s91, s98
  s_add_u32 s100, s100, 1
  s_waitcnt lgkmcnt(0)
L_lp_e:
  s_cmp_eq_u32 s55, 0
  s_cbranch_scc1 L_lo_e
  s_cmp_eq_u32 s55, 1
  s_cbranch_scc0 L_lo_2
  buffer_store_dwordx4 v[152:155], v3, s[8:11], s87 offen sc1
  s_add_u32 s87, s87, s88
  buffer_store_dwordx4 v[156:159], v3, s[8:11], s86 offen sc1
  s_add_u32 s86, s86, s90
  buffer_store_dwordx4 v[160:163], v3, s[8:11], s87 offen sc1
  s_add_u32 s87, s87, s89
  buffer_store_dwordx4 v[164:167], v3, s[8:11], s86 offen sc1
  s_add_u32 s86, s86, s91
  buffer_store_dwordx4 v[168:171], v3, s[8:11], s87 offen sc1
  s_add_u32 s87, s87, s88
  buffer_store_dwordx4 v[172:175], v3, s[8:11], s86 offen sc1
  s_add_u32 s86, s86, s90
  buffer_store_dwordx4 v[176:179], v3, s[8:11], s87 offen sc1
  s_add_u32 s87, s87, s89
  buffer_store_dwordx4 v[180:183], v3, s[8:11], s86 offen sc1
  s_add_u32 s86, s86, s91
  buffer_store_dwordx4 v[184:187], v3, s[8:11], s87 offen sc1
  s_add_u32 s87, s87, s88
  buffer_store_dwordx4 v[188:191], v3, s[8:11], s86 offen sc1
  s_add_u32 s86, s86, s90
  buffer_store_dwordx4 v[192:195], v3, s[8:11], s87 offen sc1
  s_add_u32 s87, s87, s89
  buffer_store_dwordx4 v[196:199], v3, s[8:11], s86 offen sc1
  s_add_u32 s86, s86, s91
  buffer_store_dwordx4 v[200:203], v3, s[8:11], s87 offen sc1
  s_add_u32 s87, s87, s88
  buffer_store_dwordx4 v[204:207], v3, s[8:11], s86 offen sc1
  s_add_u32 s86, s86, s90
  buffer_store_dwordx4 v[208:211], v3, s[8:11], s87 offen sc1
  s_add_u32 s87, s87, s89
  buffer_store_dwordx4 v[212:215], v3, s[8:11], s86 offen sc1
  s_add_u32 s86, s86, s91
  buffer_store_dwordx4 v[216:219], v3, s[8:11], s87 offen sc1
  buffer_store_dwordx4 v[220:223], v3, s[8:11], s86 offen sc1
  buffer_store_dwordx2 v[252:253], v249, s[8:11], s96 offen sc1
  s_cmp_eq_u32 s96, s97
  s_cbranch_scc1 L_lo_e
  buffer_store_dwordx2 v[252:253], v249, s[8:11], s97 offen sc1
  s_branch L_lo_e
L_lo_2:
L_lo_e:
  s_and_b32 s17, s2, 3
  s_lshl_b32 s17, s17, 1
  s_bfe_u32 s18, s2, 0x10003
  s_add_u32 s17, s17, s18
  s_bfe_u32 s18, s2, 0x10002
  s_lshl_b32 s18, s18, 4
  s_lshr_b32 s19, s2, 4
  s_add_u32 s18, s18, s19
  s_and_b32 s19, s16, 1
  s_lshr_b32 s20, s16, 1
  s_mul_i32 s25, s18, 73728
  s_lshl_b32 s26, s16, 10
  s_add_u32 s27, s25, s26
  s_add_u32 s27, s27, 4718592
  s_add_u32 s27, s27, s63
  s_add_u32 s28, s27, 36864
  s_add_u32 s31, s26, 36864
  s_lshl_b32 s21, s18, 1
  s_xor_b32 s29, s19, 1
  s_add_u32 s45, s21, s19
  s_add_u32 s46, s21, s29
  s_lshl_b32 s47, s45, 8
  s_lshl_b32 s48, s46, 8
  s_add_u32 s47, s47, 9781248
  s_add_u32 s47, s47, s63
  s_add_u32 s48, s48, 9781248
  s_add_u32 s48, s48, s63
  v_lshlrev_b32 v15, 2, v2
  s_and_b32 s60, s2, 7
  s_lshl_b32 s60, s60, 10
  s_add_u32 s60, s60, 159391744
  s_lshl_b32 s61, s2, 2
  s_add_u32 s61, s61, 159391744
  s_cmp_eq_u32 s16, 0
  s_cbranch_scc1 L_lp_skip
  s_add_u32 s50, s64, 338944
  s_mul_i32 s51, s16, 18432
  s_add_u32 s51, s51, 90112
  s_mul_i32 s52, s16, 331776
  s_sub_u32 s52, s50, s52
  s_sub_u32 s52, s52, 5120
  s_mul_i32 s53, s16, 5120
  s_add_u32 s53, s53, 68608
  s_add_u32 m0, s51, 0
  s_nop 0
  buffer_load_dwordx4 v3, s[8:11], s50 offen offset:0 sc1 lds
  buffer_load_dwordx4 v3, s[8:11], s50 offen offset:1024 sc1 lds
  buffer_load_dwordx4 v3, s[8:11], s50 offen offset:2048 sc1 lds
  buffer_load_dwordx4 v3, s[8:11], s50 offen offset:3072 sc1 lds
  s_add_u32 m0, s53, 0
  s_nop 0
  buffer_load_dwordx4 v3, s[8:11], s52 offen offset:0 sc1 lds
  buffer_load_dwordx4 v3, s[8:11], s52 offen offset:1024 sc1 lds
  buffer_load_dwordx4 v3, s[8:11], s52 offen offset:2048 sc1 lds
  buffer_load_dwordx4 v3, s[8:11], s52 offen offset:3072 sc1 lds
  s_add_u32 m0, s51, 4096
  s_addk_i32 s50, 4096
  buffer_load_dwordx4 v3, s[8:11], s50 offen offset:0 sc1 lds
  buffer_load_dwordx4 v3, s[8:11], s50 offen offset:1024 sc1 lds
  buffer_load_dwordx4 v3, s[8:11], s50 offen offset:2048 sc1 lds
  buffer_load_dwordx4 v3, s[8:11], s50 offen offset:3072 sc1 lds
  s_add_u32 m0, s53, 4096
  s_addk_i32 s52, 4096
  buffer_load_dwordx4 v3, s[8:11], s52 offen offset:0 sc1 lds
  s_add_u32 m0, s51, 8192
  s_addk_i32 s50, 4096
  buffer_load_dwordx4 v3, s[8:11], s50 offen offset:0 sc1 lds
  buffer_load_dwordx4 v3, s[8:11], s50 offen offset:1024 sc1 lds
  buffer_load_dwordx4 v3, s[8:11], s50 offen offset:2048 sc1 lds
  buffer_load_dwordx4 v3, s[8:11], s50 offen offset:3072 sc1 lds
  s_add_u32 m0, s51, 12288
  s_addk_i32 s50, 4096
  buffer_load_dwordx4 v3, s[8:11], s50 offen offset:0 sc1 lds
  buffer_load_dwordx4 v3, s[8:11], s50 offen offset:1024 sc1 lds
  buffer_load_dwordx4 v3, s[8:11], s50 offen offset:2048 sc1 lds
L_lp_skip:
  s_mul_i32 s51, s16, 18432
  s_add_u32 s51, s51, 90112
  s_cmp_eq_u32 s16, 0
  s_cselect_b32 s51, 73728, s51
  s_xor_b32 s52, s16, 1
  s_mul_i32 s53, s52, 18432
  s_add_u32 s53, s53, 90112
  s_cmp_eq_u32 s52, 0
  s_cselect_b32 s53, 73728, s53
  s_sub_u32 s52, s51, 336896
  v_add_u32 v39, s52, v13
  v_and_b32 v38, 0x3ff, v13
  s_lshl_b32 s52, s19, 7
  v_add_u32 v38, s52, v38
  v_mov_b32 v32, s51
  v_mov_b32 v33, s53
  v_cmp_gt_u32 vcc, 32, v2
  s_nop 1
  v_cndmask_b32 v32, v33, v32, vcc
  v_add_u32 v38, v38, v32
  s_mov_b32 s30, s64
  v_lshlrev_b32 v4, 7, v2
  s_mov_b32 s49, 0x40000
  s_cmp_eq_u32 s16, 0
  s_cbranch_scc0 L_bc_go
  s_mov_b64 exec, 15
L_bc_poll:
  buffer_load_dword v250, v4, s[8:11], s65 offen sc1
  s_waitcnt vmcnt(0)
  v_cmp_gt_u32 vcc, 8, v250
  s_nop 4
  s_cbranch_vccz L_bc_ok
  s_sub_u32 s49, s49, 1
  s_cmp_eq_u32 s49, 0
  s_cbranch_scc0 L_bc_poll
L_bc_ok:
  s_mov_b64 exec, -1
L_bc_go:
  s_barrier
  s_mov_b32 m0, s26
  s_nop 0
  buffer_load_dwordx4 v3, s[8:11], s27 offen sc1 lds
  s_addk_i32 s27, 4096
  s_mov_b32 m0, s31
  s_nop 0
  buffer_load_dwordx4 v3, s[8:11], s28 offen sc1 lds
  s_addk_i32 s28, 4096
  s_add_u32 m0, s26, 4096
  s_nop 0
  buffer_load_dwordx4 v3, s[8:11], s27 offen sc1 lds
  s_addk_i32 s27, 4096
  s_add_u32 m0, s31, 4096
  s_nop 0
  buffer_load_dwordx4 v3, s[8:11], s28 offen sc1 lds
  s_addk_i32 s28, 4096
  s_add_u32 m0, s26, 8192
  s_nop 0
  buffer_load_dwordx4 v3, s[8:11], s27 offen sc1 lds
  s_addk_i32 s27, 4096
  s_add_u32 m0, s31, 8192
  s_nop 0
  buffer_load_dwordx4 v3, s[8:11], s28 offen sc1 lds
  s_addk_i32 s28, 4096
  s_add_u32 m0, s26, 12288
  s_nop 0
  buffer_load_dwordx4 v3, s[8:11], s27 offen sc1 lds
  s_addk_i32 s27, 4096
  s_add_u32 m0, s31, 12288
  s_nop 0
  buffer_load_dwordx4 v3, s[8:11], s28 offen sc1 lds
  s_addk_i32 s28, 4096
  s_add_u32 m0, s26, 16384
  s_nop 0
  buffer_load_dwordx4 v3, s[8:11], s27 offen sc1 lds
  s_addk_i32 s27, 4096
  s_add_u32 m0, s31, 16384
  s_nop 0
  buffer_load_dwordx4 v3, s[8:11], s28 offen sc1 lds
  s_addk_i32 s28, 4096
  s_add_u32 m0, s26, 20480
  s_nop 0
  buffer_load_dwordx4 v3, s[8:11], s27 offen sc1 lds
  s_addk_i32 s27, 4096
  s_add_u32 m0, s31, 20480
  s_nop 0
  buffer_load_dwordx4 v3, s[8:11], s28 offen sc1 lds
  s_addk_i32 s28, 4096
  s_add_u32 m0, s26, 24576
  s_nop 0
  buffer_load_dwordx4 v3, s[8:11], s27 offen sc1 lds
  s_addk_i32 s27, 4096
  s_add_u32 m0, s31, 24576
  s_nop 0
  buffer_load_dwordx4 v3, s[8:11], s28 offen sc1 lds
  s_addk_i32 s28, 4096
  buffer_load_dword v22, v15, s[8:11], s47 offen sc1
  buffer_load_dword v23, v15, s[8:11], s48 offen sc1
  v_lshrrev_b32 v35, 4, v2
  v_and_b32 v34, 15, v2
  v_lshlrev_b32 v34, 4, v34
  v_lshl_add_u32 v34, v35, 9, v34
  s_lshl_b32 s50, s19, 10
  v_xor_b32 v35, s50, v34
  s_mul_i32 s50, s19, 36864
  s_mul_i32 s51, s29, 36864
  v_add_u32 v6, s50, v35
  v_add_u32 v7, s51, v35
  s_waitcnt vmcnt(14)
  s_barrier
  ds_read_b128 a[24:27], v6 offset:0
  ds_read_b128 a[28:31], v6 offset:256
  ds_read_b128 a[32:35], v7 offset:0
  ds_read_b128 a[36:39], v7 offset:256
  s_waitcnt lgkmcnt(3)
  v_mfma_f32_16x16x32_bf16 v[40:43], a[252:255], a[24:27], 0
  ds_read_b128 a[40:43], v6 offset:2048
  s_waitcnt lgkmcnt(3)
  v_mfma_f32_16x16x32_bf16 v[48:51], a[252:255], a[28:31], 0
  s_waitcnt lgkmcnt(2)
  v_mfma_f32_16x16x32_bf16 v[56:59], a[252:255], a[32:35], 0
  ds_read_b128 a[44:47], v6 offset:2304
  s_waitcnt lgkmcnt(2)
  v_mfma_f32_16x16x32_bf16 v[64:67], a[252:255], a[36:39], 0
  ds_read_b128 a[128:131], v39 offset:128
  v_mfma_f32_16x16x32_bf16 v[44:47], a[248:251], a[24:27], 0
  ds_read_b128 a[48:51], v7 offset:2048
  v_mfma_f32_16x16x32_bf16 v[52:55], a[248:251], a[28:31], 0
  v_mfma_f32_16x16x32_bf16 v[60:63], a[248:251], a[32:35], 0
  ds_read_b128 a[52:55], v7 offset:2304
  v_mfma_f32_16x16x32_bf16 v[68:71], a[248:251], a[36:39], 0
  ds_read_b128 a[252:255], v39 offset:1024
  v_mfma_f32_16x16x32_bf16 v[72:75], a[244:247], a[24:27], 0
  s_mul_i32 s50, s19, 36864
  v_mfma_f32_16x16x32_bf16 v[80:83], a[244:247], a[28:31], 0
  s_mul_i32 s51, s29, 36864
  v_mfma_f32_16x16x32_bf16 v[88:91], a[244:247], a[32:35], 0
  s_lshl_b32 s52, s16, 11
  v_mfma_f32_16x16x32_bf16 v[96:99], a[244:247], a[36:39], 0
  ds_read_b128 a[248:251], v39 offset:1152
  s_add_u32 s53, s50, s52
  v_mfma_f32_16x16x32_bf16 v[76:79], a[240:243], a[24:27], 0
  v_mfma_f32_16x16x32_bf16 v[84:87], a[240:243], a[28:31], 0
  s_add_u32 s53, s53, 73728
  v_mfma_f32_16x16x32_bf16 v[92:95], a[240:243], a[32:35], 0
  v_add_u32 v10, s53, v34
  v_mfma_f32_16x16x32_bf16 v[100:103], a[240:243], a[36:39], 0
  ds_read_b128 a[244:247], v38 offset:2048
  s_add_u32 s53, s51, s52
  v_mfma_f32_16x16x32_bf16 v[168:171], a[236:239], a[24:27], 0
  s_add_u32 s53, s53, 73728
  v_mfma_f32_16x16x32_bf16 v[172:175], a[236:239], a[28:31], 0
  v_add_u32 v11, s53, v34
  v_mfma_f32_16x16x32_bf16 v[176:179], a[236:239], a[32:35], 0
  s_lshl_b32 s52, s20, 11
  v_mfma_f32_16x16x32_bf16 v[180:183], a[236:239], a[36:39], 0
  ds_read_b128 a[240:243], v39 offset:5120
  s_lshl_b32 s53, s19, 3
  s_waitcnt lgkmcnt(4)
  v_mfma_f32_16x16x32_bf16 v[40:43], a[232:235], a[40:43], v[40:43]
  s_waitcnt vmcnt(12)
  s_barrier
  s_cmp_eq_u32 s16, 0
  s_cbranch_scc0 L_f3_ns
  v_mov_b32 v36, s3
  v_lshlrev_b32 v37, 10, v2
  s_mov_b64 exec, 0xff
  buffer_store_dword v36, v37, s[8:11], s61 offen sc1
  s_mov_b64 exec, -1
L_f3_ns:
  ds_read_b128 a[24:27], v6 offset:4096
  v_mfma_f32_16x16x32_bf16 v[48:51], a[232:235], a[44:47], v[48:51]
  s_add_u32 s52, s52, s53
  v_mfma_f32_16x16x32_bf16 v[56:59], a[232:235], a[48:51], v[56:59]
  ds_read_b128 a[28:31], v6 offset:4352
  s_add_u32 s52, s52, 106496
  v_mfma_f32_16x16x32_bf16 v[64:67], a[232:235], a[52:55], v[64:67]
  ds_read_b128 a[236:239], v39 offset:5248
  s_add_u32 s53, s50, s52
  v_mfma_f32_16x16x32_bf16 v[44:47], a[228:231], a[40:43], v[44:47]
  ds_read_b128 a[32:35], v7 offset:4096
  v_add_u32 v12, s53, v34
  v_mfma_f32_16x16x32_bf16 v[52:55], a[228:231], a[44:47], v[52:55]
  s_add_u32 s53, s51, s52
  v_mfma_f32_16x16x32_bf16 v[60:63], a[228:231], a[48:51], v[60:63]
  ds_read_b128 a[36:39], v7 offset:4352
  v_add_u32 v14, s53, v34
  v_mfma_f32_16x16x32_bf16 v[68:71], a[228:231], a[52:55], v[68:71]
  ds_read_b128 a[232:235], v39 offset:6144
  s_mul_i32 s54, s17, 2359296
  v_mfma_f32_16x16x32_bf16 v[72:75], a[224:227], a[40:43], v[72:75]
  v_mfma_f32_16x16x32_bf16 v[80:83], a[224:227], a[44:47], v[80:83]
  s_add_u32 s54, s54, 10485760
  v_mfma_f32_16x16x32_bf16 v[88:91], a[224:227], a[48:51], v[88:91]
  s_add_u32 s54, s54, s63
  v_mfma_f32_16x16x32_bf16 v[96:99], a[224:227], a[52:55], v[96:99]
  ds_read_b128 a[228:231], v39 offset:6272
  s_mul_i32 s55, s45, 36864
  v_mfma_f32_16x16x32_bf16 v[76:79], a[220:223], a[40:43], v[76:79]
  s_mul_i32 s56, s46, 36864
  v_mfma_f32_16x16x32_bf16 v[84:87], a[220:223], a[44:47], v[84:87]
  s_add_u32 s55, s55, s54
  v_mfma_f32_16x16x32_bf16 v[92:95], a[220:223], a[48:51], v[92:95]
  s_add_u32 s56, s56, s54
  v_mfma_f32_16x16x32_bf16 v[100:103], a[220:223], a[52:55], v[100:103]
  ds_read_b128 a[224:227], v38 offset:7168
  s_lshl_b32 s57, s20, 11
  v_mfma_f32_16x16x32_bf16 v[168:171], a[216:219], a[40:43], v[168:171]
  v_mfma_f32_16x16x32_bf16 v[172:175], a[216:219], a[44:47], v[172:175]
  s_add_u32 s57, s57, 32768
  v_mfma_f32_16x16x32_bf16 v[176:179], a[216:219], a[48:51], v[176:179]
  s_add_u32 s54, s57, s56
  v_mfma_f32_16x16x32_bf16 v[180:183], a[216:219], a[52:55], v[180:183]
  s_add_u32 m0, s26, 28672
  s_nop 0
  buffer_load_dwordx4 v3, s[8:11], s27 offen sc1 lds
  s_addk_i32 s27, 4096
  s_add_u32 m0, s31, 28672
  s_nop 0
  buffer_load_dwordx4 v3, s[8:11], s28 offen sc1 lds
  s_addk_i32 s28, 4096
  ds_read_b128 a[220:223], v39 offset:10240
  s_add_u32 s57, s57, s55
  s_waitcnt lgkmcnt(4)
  v_mfma_f32_16x16x32_bf16 v[40:43], a[212:215], a[24:27], v[40:43]
  ds_read_b128 a[40:43], v6 offset:6144
  s_lshl_b32 s58, s16, 11
  v_mfma_f32_16x16x32_bf16 v[48:51], a[212:215], a[28:31], v[48:51]
  s_add_u32 s55, s55, s58
  v_mfma_f32_16x16x32_bf16 v[56:59], a[212:215], a[32:35], v[56:59]
  ds_read_b128 a[44:47], v6 offset:6400
  s_add_u32 s56, s56, s58
  v_mfma_f32_16x16x32_bf16 v[64:67], a[212:215], a[36:39], v[64:67]
  ds_read_b128 a[216:219], v39 offset:10368
  v_lshrrev_b32 v35, 5, v2
  v_mfma_f32_16x16x32_bf16 v[44:47], a[208:211], a[24:27], v[44:47]
  ds_read_b128 a[48:51], v7 offset:6144
  v_mfma_f32_16x16x32_bf16 v[52:55], a[208:211], a[28:31], v[52:55]
  v_lshlrev_b32 v15, 9, v35
  v_mfma_f32_16x16x32_bf16 v[60:63], a[208:211], a[32:35], v[60:63]
  ds_read_b128 a[52:55], v7 offset:6400
  v_bfe_u32 v35, v2, 4, 1
  v_mfma_f32_16x16x32_bf16 v[68:71], a[208:211], a[36:39], v[68:71]
  ds_read_b128 a[212:215], v39 offset:11264
  v_lshl_add_u32 v15, v35, 3, v15
  v_mfma_f32_16x16x32_bf16 v[72:75], a[204:207], a[24:27], v[72:75]
  v_and_b32 v35, 0x1ff, v13
  v_mfma_f32_16x16x32_bf16 v[80:83], a[204:207], a[28:31], v[80:83]
  v_add_u32 v15, v15, v35
  v_mfma_f32_16x16x32_bf16 v[88:91], a[204:207], a[32:35], v[88:91]
  v_add_u32 v15, 336896, v15
  v_mfma_f32_16x16x32_bf16 v[96:99], a[204:207], a[36:39], v[96:99]
  ds_read_b128 a[208:211], v39 offset:11392
  v_mfma_f32_16x16x32_bf16 v[76:79], a[200:203], a[24:27], v[76:79]
  v_mfma_f32_16x16x32_bf16 v[84:87], a[200:203], a[28:31], v[84:87]
  v_mfma_f32_16x16x32_bf16 v[92:95], a[200:203], a[32:35], v[92:95]
  v_mfma_f32_16x16x32_bf16 v[100:103], a[200:203], a[36:39], v[100:103]
  ds_read_b128 a[204:207], v38 offset:12288
  v_bfe_u32 v4, v2, 3, 1
  s_and_b32 s50, s17, 1
  v_cmp_eq_u32 vcc, s50, v4
  v_mov_b32 v35, 0x40000000
  s_nop 0
  v_cndmask_b32 v35, v34, v35, vcc
  s_lshr_b32 s44, s17, 1
  s_lshl_b32 s50, s19, 1
  s_xor_b32 s44, s44, s50
  v_mfma_f32_16x16x32_bf16 v[168:171], a[196:199], a[24:27], v[168:171]
  v_mfma_f32_16x16x32_bf16 v[172:175], a[196:199], a[28:31], v[172:175]
  v_mfma_f32_16x16x32_bf16 v[176:179], a[196:199], a[32:35], v[176:179]
  v_mfma_f32_16x16x32_bf16 v[180:183], a[196:199], a[36:39], v[180:183]
  s_addk_i32 s30, 16384
  buffer_load_dwordx4 a[200:203], v13, s[8:11], s30 offen offset:1024 sc1
  s_waitcnt lgkmcnt(3)
  v_mfma_f32_16x16x32_bf16 v[40:43], a[192:195], a[40:43], v[40:43]
  s_waitcnt vmcnt(13)
  s_barrier
  ds_read_b128 a[24:27], v6 offset:8192
  v_mfma_f32_16x16x32_bf16 v[48:51], a[192:195], a[44:47], v[48:51]
  v_mfma_f32_16x16x32_bf16 v[56:59], a[192:195], a[48:51], v[56:59]
  ds_read_b128 a[28:31], v6 offset:8448
  s_cmp_eq_u32 s44, 0
  s_cselect_b64 vcc, -1, 0
  v_cndmask_b32 v4, v34, v35, vcc
  v_mfma_f32_16x16x32_bf16 v[64:67], a[192:195], a[52:55], v[64:67]
  buffer_load_dwordx4 a[196:199], v13, s[8:11], s30 offen offset:1152 sc1
  v_mfma_f32_16x16x32_bf16 v[44:47], a[188:191], a[40:43], v[44:47]
  ds_read_b128 a[32:35], v7 offset:8192
  v_mfma_f32_16x16x32_bf16 v[52:55], a[188:191], a[44:47], v[52:55]
  s_cmp_eq_u32 s44, 1
  s_cselect_b64 vcc, -1, 0
  v_cndmask_b32 v5, v34, v35, vcc
  v_mfma_f32_16x16x32_bf16 v[60:63], a[188:191], a[48:51], v[60:63]
  ds_read_b128 a[36:39], v7 offset:8448
  v_mfma_f32_16x16x32_bf16 v[68:71], a[188:191], a[52:55], v[68:71]
  buffer_load_dwordx4 a[192:195], v13, s[8:11], s30 offen offset:2048 sc1
  v_mfma_f32_16x16x32_bf16 v[72:75], a[184:187], a[40:43], v[72:75]
  v_mfma_f32_16x16x32_bf16 v[80:83], a[184:187], a[44:47], v[80:83]
  s_cmp_eq_u32 s44, 2
  s_cselect_b64 vcc, -1, 0
  v_cndmask_b32 v8, v34, v35, vcc
  v_mfma_f32_16x16x32_bf16 v[88:91], a[184:187], a[48:51], v[88:91]
  v_mfma_f32_16x16x32_bf16 v[96:99], a[184:187], a[52:55], v[96:99]
  buffer_load_dwordx4 a[188:191], v13, s[8:11], s30 offen offset:2176 sc1
  v_mfma_f32_16x16x32_bf16 v[76:79], a[180:183], a[40:43], v[76:79]
  s_cmp_eq_u32 s44, 3
  s_cselect_b64 vcc, -1, 0
  v_cndmask_b32 v9, v34, v35, vcc
  v_mfma_f32_16x16x32_bf16 v[84:87], a[180:183], a[44:47], v[84:87]
  v_mfma_f32_16x16x32_bf16 v[92:95], a[180:183], a[48:51], v[92:95]
  s_lshl_b32 s66, s18, 2
  v_mfma_f32_16x16x32_bf16 v[100:103], a[180:183], a[52:55], v[100:103]
  s_addk_i32 s64, 16384
  buffer_load_dwordx4 a[184:187], v1, s[8:11], s64 offen offset:3072 sc1
  s_add_u32 s66, s66, s16
  v_mfma_f32_16x16x32_bf16 v[168:171], a[176:179], a[40:43], v[168:171]
  v_mfma_f32_16x16x32_bf16 v[172:175], a[176:179], a[44:47], v[172:175]
  s_lshl_b32 s66, s66, 7
  v_mfma_f32_16x16x32_bf16 v[176:179], a[176:179], a[48:51], v[176:179]
  s_add_u32 s66, s66, 9814016
  v_mfma_f32_16x16x32_bf16 v[180:183], a[176:179], a[52:55], v[180:183]
  s_add_u32 m0, s26, 32768
  s_nop 0
  buffer_load_dwordx4 v3, s[8:11], s27 offen sc1 lds
  s_addk_i32 s27, 4096
  s_add_u32 m0, s31, 32768
  s_nop 0
  buffer_load_dwordx4 v3, s[8:11], s28 offen sc1 lds
  s_addk_i32 s28, 4096
  s_addk_i32 s30, 4096
  buffer_load_dwordx4 a[180:183], v13, s[8:11], s30 offen offset:2048 sc1
  s_add_u32 s66, s66, s63
  s_waitcnt lgkmcnt(0)
  v_mfma_f32_16x16x32_bf16 v[40:43], a[172:175], a[24:27], v[40:43]
  ds_read_b128 a[40:43], v6 offset:10240
  v_mfma_f32_16x16x32_bf16 v[48:51], a[172:175], a[28:31], v[48:51]
  v_mfma_f32_16x16x32_bf16 v[56:59], a[172:175], a[32:35], v[56:59]
  ds_read_b128 a[44:47], v6 offset:10496
  v_mfma_f32_16x16x32_bf16 v[64:67], a[172:175], a[36:39], v[64:67]
  buffer_load_dwordx4 a[176:179], v13, s[8:11], s30 offen offset:2176 sc1
  v_mfma_f32_16x16x32_bf16 v[44:47], a[168:171], a[24:27], v[44:47]
  ds_read_b128 a[48:51], v7 offset:10240
  v_mfma_f32_16x16x32_bf16 v[52:55], a[168:171], a[28:31], v[52:55]
  v_mfma_f32_16x16x32_bf16 v[60:63], a[168:171], a[32:35], v[60:63]
  ds_read_b128 a[52:55], v7 offset:10496
  v_mfma_f32_16x16x32_bf16 v[68:71], a[168:171], a[36:39], v[68:71]
  buffer_load_dwordx4 a[172:175], v13, s[8:11], s30 offen offset:3072 sc1
  v_mfma_f32_16x16x32_bf16 v[72:75], a[164:167], a[24:27], v[72:75]
  v_mfma_f32_16x16x32_bf16 v[80:83], a[164:167], a[28:31], v[80:83]
  v_mfma_f32_16x16x32_bf16 v[88:91], a[164:167], a[32:35], v[88:91]
  v_mfma_f32_16x16x32_bf16 v[96:99], a[164:167], a[36:39], v[96:99]
  buffer_load_dwordx4 a[168:171], v13, s[8:11], s30 offen offset:3200 sc1
  v_mfma_f32_16x16x32_bf16 v[76:79], a[160:163], a[24:27], v[76:79]
  v_mfma_f32_16x16x32_bf16 v[84:87], a[160:163], a[28:31], v[84:87]
  v_mfma_f32_16x16x32_bf16 v[92:95], a[160:163], a[32:35], v[92:95]
  v_mfma_f32_16x16x32_bf16 v[100:103], a[160:163], a[36:39], v[100:103]
  s_addk_i32 s64, 8192
  buffer_load_dwordx4 a[164:167], v1, s[8:11], s64 offen offset:0 sc1
  v_mfma_f32_16x16x32_bf16 v[168:171], a[156:159], a[24:27], v[168:171]
  v_mfma_f32_16x16x32_bf16 v[172:175], a[156:159], a[28:31], v[172:175]
  v_mfma_f32_16x16x32_bf16 v[176:179], a[156:159], a[32:35], v[176:179]
  v_mfma_f32_16x16x32_bf16 v[180:183], a[156:159], a[36:39], v[180:183]
  s_addk_i32 s30, 4096
  buffer_load_dwordx4 a[160:163], v13, s[8:11], s30 offen offset:3072 sc1
  s_waitcnt lgkmcnt(0)
  v_mfma_f32_16x16x32_bf16 v[40:43], a[152:155], a[40:43], v[40:43]
  s_waitcnt vmcnt(23)
  s_barrier
  ds_read_b128 a[24:27], v6 offset:12288
  v_mfma_f32_16x16x32_bf16 v[48:51], a[152:155], a[44:47], v[48:51]
  v_mfma_f32_16x16x32_bf16 v[56:59], a[152:155], a[48:51], v[56:59]
  ds_read_b128 a[28:31], v6 offset:12544
  v_mfma_f32_16x16x32_bf16 v[64:67], a[152:155], a[52:55], v[64:67]
  buffer_load_dwordx4 a[156:159], v13, s[8:11], s30 offen offset:3200 sc1
  v_mfma_f32_16x16x32_bf16 v[44:47], a[148:151], a[40:43], v[44:47]
  ds_read_b128 a[32:35], v7 offset:12288
  v_mfma_f32_16x16x32_bf16 v[52:55], a[148:151], a[44:47], v[52:55]
  v_mfma_f32_16x16x32_bf16 v[60:63], a[148:151], a[48:51], v[60:63]
  ds_read_b128 a[36:39], v7 offset:12544
  v_mfma_f32_16x16x32_bf16 v[68:71], a[148:151], a[52:55], v[68:71]
  s_addk_i32 s30, 4096
  buffer_load_dwordx4 a[152:155], v13, s[8:11], s30 offen offset:0 sc1
  v_mfma_f32_16x16x32_bf16 v[72:75], a[144:147], a[40:43], v[72:75]
  v_mfma_f32_16x16x32_bf16 v[80:83], a[144:147], a[44:47], v[80:83]
  v_mfma_f32_16x16x32_bf16 v[88:91], a[144:147], a[48:51], v[88:91]
  v_mfma_f32_16x16x32_bf16 v[96:99], a[144:147], a[52:55], v[96:99]
  buffer_load_dwordx4 a[148:151], v13, s[8:11], s30 offen offset:128 sc1
  v_mfma_f32_16x16x32_bf16 v[76:79], a[140:143], a[40:43], v[76:79]
  v_mfma_f32_16x16x32_bf16 v[84:87], a[140:143], a[44:47], v[84:87]
  v_mfma_f32_16x16x32_bf16 v[92:95], a[140:143], a[48:51], v[92:95]
  v_mfma_f32_16x16x32_bf16 v[100:103], a[140:143], a[52:55], v[100:103]
  s_addk_i32 s64, 4096
  buffer_load_dwordx4 a[144:147], v1, s[8:11], s64 offen offset:1024 sc1
  v_mfma_f32_16x16x32_bf16 v[168:171], a[136:139], a[40:43], v[168:171]
  v_mfma_f32_16x16x32_bf16 v[172:175], a[136:139], a[44:47], v[172:175]
  v_mfma_f32_16x16x32_bf16 v[176:179], a[136:139], a[48:51], v[176:179]
  v_mfma_f32_16x16x32_bf16 v[180:183], a[136:139], a[52:55], v[180:183]
  s_addk_i32 s30, 4096
  buffer_load_dwordx4 a[140:143], v13, s[8:11], s30 offen offset:0 sc1
  s_waitcnt lgkmcnt(0)
  v_mfma_f32_16x16x32_bf16 v[40:43], a[132:135], a[24:27], v[40:43]
  ds_read_b128 a[40:43], v6 offset:14336
  s_waitcnt vmcnt(21)
  v_mov_b32 v24, v22
  v_mfma_f32_16x16x32_bf16 v[48:51], a[132:135], a[28:31], v[48:51]
  v_mfma_f32_16x16x32_bf16 v[56:59], a[132:135], a[32:35], v[56:59]
  ds_read_b128 a[44:47], v6 offset:14592
  v_mov_b32 v32, v22
  v_mfma_f32_16x16x32_bf16 v[64:67], a[132:135], a[36:39], v[64:67]
  buffer_load_dwordx4 a[136:139], v13, s[8:11], s30 offen offset:128 sc1
  v_permlane32_swap_b32 v32, v24
  v_mfma_f32_16x16x32_bf16 v[44:47], a[128:131], a[24:27], v[44:47]
  ds_read_b128 a[48:51], v7 offset:14336
  v_mfma_f32_16x16x32_bf16 v[52:55], a[128:131], a[28:31], v[52:55]
  v_mul_f32 v32, 0x3ae38e39, v32
  v_mfma_f32_16x16x32_bf16 v[60:63], a[128:131], a[32:35], v[60:63]
  ds_read_b128 a[52:55], v7 offset:14592
  v_mfma_f32_16x16x32_bf16 v[68:71], a[128:131], a[36:39], v[68:71]
  buffer_load_dwordx4 a[132:135], v13, s[8:11], s30 offen offset:1024 sc1
  v_mul_f32 v24, 0x3ae38e39, v24
  v_mfma_f32_16x16x32_bf16 v[72:75], a[252:255], a[24:27], v[72:75]
  v_fma_f32 v24, -v32, v32, v24
  v_mfma_f32_16x16x32_bf16 v[80:83], a[252:255], a[28:31], v[80:83]
  v_mfma_f32_16x16x32_bf16 v[88:91], a[252:255], a[32:35], v[88:91]
  v_max_f32 v24, 0, v24
  v_mfma_f32_16x16x32_bf16 v[96:99], a[252:255], a[36:39], v[96:99]
  buffer_load_dwordx4 a[128:131], v13, s[8:11], s30 offen offset:1152 sc1
  v_mov_b32 v25, 0x3f800054
  v_mfma_f32_16x16x32_bf16 v[76:79], a[248:251], a[24:27], v[76:79]
  v_mfma_f32_16x16x32_bf16 v[84:87], a[248:251], a[28:31], v[84:87]
  v_mov_b32 v26, 0x2edbe6ff
  v_mfma_f32_16x16x32_bf16 v[92:95], a[248:251], a[32:35], v[92:95]
  v_fma_f32 v24, v24, v25, v26
  v_mfma_f32_16x16x32_bf16 v[100:103], a[248:251], a[36:39], v[100:103]
  s_addk_i32 s64, 4096
  buffer_load_dwordx4 a[252:255], v1, s[8:11], s64 offen offset:2048 sc1
  v_mfma_f32_16x16x32_bf16 v[168:171], a[244:247], a[24:27], v[168:171]
  v_mfma_f32_16x16x32_bf16 v[172:175], a[244:247], a[28:31], v[172:175]
  v_rsq_f32 v25, v24
  v_mfma_f32_16x16x32_bf16 v[176:179], a[244:247], a[32:35], v[176:179]
  v_mfma_f32_16x16x32_bf16 v[180:183], a[244:247], a[36:39], v[180:183]
  s_addk_i32 s30, 4096
  buffer_load_dwordx4 a[248:251], v13, s[8:11], s30 offen offset:1024 sc1
  v_mul_f32 v24, v24, v25
  s_waitcnt lgkmcnt(0)
  v_mfma_f32_16x16x32_bf16 v[40:43], a[240:243], a[40:43], v[40:43]
  s_barrier
  ds_read_b128 a[24:27], v6 offset:16384
  v_mfma_f32_16x16x32_bf16 v[48:51], a[240:243], a[44:47], v[48:51]
  v_mul_f32 v16, 0xc0135761, v25
  v_mfma_f32_16x16x32_bf16 v[56:59], a[240:243], a[48:51], v[56:59]
  ds_read_b128 a[28:31], v6 offset:16640
  v_mul_f32 v17, 0xc0135761, v25
  v_mfma_f32_16x16x32_bf16 v[64:67], a[240:243], a[52:55], v[64:67]
  buffer_load_dwordx4 a[244:247], v13, s[8:11], s30 offen offset:1152 sc1
  v_mfma_f32_16x16x32_bf16 v[44:47], a[236:239], a[40:43], v[44:47]
  ds_read_b128 a[32:35], v7 offset:16384
  v_mul_f32 v26, v25, v25
  v_mfma_f32_16x16x32_bf16 v[52:55], a[236:239], a[44:47], v[52:55]
  v_mfma_f32_16x16x32_bf16 v[60:63], a[236:239], a[48:51], v[60:63]
  ds_read_b128 a[36:39], v7 offset:16640
  v_mul_f32 v26, v26, v25
  v_mfma_f32_16x16x32_bf16 v[68:71], a[236:239], a[52:55], v[68:71]
  buffer_load_dwordx4 a[240:243], v13, s[8:11], s30 offen offset:2048 sc1
  v_mul_f32 v33, 0xbdd2d3e8, v26
  v_mfma_f32_16x16x32_bf16 v[72:75], a[232:235], a[40:43], v[72:75]
  v_mfma_f32_16x16x32_bf16 v[80:83], a[232:235], a[44:47], v[80:83]
  v_mul_f32 v36, 0xbdd2d3e8, v26
  v_mfma_f32_16x16x32_bf16 v[88:91], a[232:235], a[48:51], v[88:91]
  v_permlane16_swap_b32 v16, v17
  v_mfma_f32_16x16x32_bf16 v[96:99], a[232:235], a[52:55], v[96:99]
  buffer_load_dwordx4 a[236:239], v13, s[8:11], s30 offen offset:2176 sc1
  v_mfma_f32_16x16x32_bf16 v[76:79], a[228:231], a[40:43], v[76:79]
  v_sub_f32 v32, 0, v32
  v_mfma_f32_16x16x32_bf16 v[84:87], a[228:231], a[44:47], v[84:87]
  v_permlane16_swap_b32 v33, v36
  v_mfma_f32_16x16x32_bf16 v[92:95], a[228:231], a[48:51], v[92:95]
  v_mfma_f32_16x16x32_bf16 v[100:103], a[228:231], a[52:55], v[100:103]
  s_addk_i32 s64, 4096
  buffer_load_dwordx4 a[232:235], v1, s[8:11], s64 offen offset:3072 sc1
  v_cvt_pk_bf16_f32 v27, v32, v24
  v_mfma_f32_16x16x32_bf16 v[168:171], a[224:227], a[40:43], v[168:171]
  v_mfma_f32_16x16x32_bf16 v[172:175], a[224:227], a[44:47], v[172:175]
  v_lshlrev_b32 v28, 16, v27
  v_mfma_f32_16x16x32_bf16 v[176:179], a[224:227], a[48:51], v[176:179]
  v_and_b32 v29, 0xffff0000, v27
  v_mfma_f32_16x16x32_bf16 v[180:183], a[224:227], a[52:55], v[180:183]
  s_addk_i32 s30, 4096
  buffer_load_dwordx4 a[228:231], v13, s[8:11], s30 offen offset:2048 sc1
  s_waitcnt lgkmcnt(0)
  v_mfma_f32_16x16x32_bf16 v[40:43], a[220:223], a[24:27], v[40:43]
  ds_read_b128 a[40:43], v6 offset:18432
  v_sub_f32 v28, v32, v28
  v_mfma_f32_16x16x32_bf16 v[48:51], a[220:223], a[28:31], v[48:51]
  v_sub_f32 v29, v24, v29
  v_mfma_f32_16x16x32_bf16 v[56:59], a[220:223], a[32:35], v[56:59]
  ds_read_b128 a[44:47], v6 offset:18688
  v_mfma_f32_16x16x32_bf16 v[64:67], a[220:223], a[36:39], v[64:67]
  buffer_load_dwordx4 a[224:227], v13, s[8:11], s30 offen offset:2176 sc1
  v_cvt_pk_bf16_f32 v30, v32, v28
  v_mfma_f32_16x16x32_bf16 v[44:47], a[216:219], a[24:27], v[44:47]
  ds_read_b128 a[48:51], v7 offset:18432
  v_cvt_pk_bf16_f32 v26, v32, v28
  v_mfma_f32_16x16x32_bf16 v[52:55], a[216:219], a[28:31], v[52:55]
  v_mfma_f32_16x16x32_bf16 v[60:63], a[216:219], a[32:35], v[60:63]
  ds_read_b128 a[52:55], v7 offset:18688
  v_cvt_pk_bf16_f32 v31, v32, v29
  v_mfma_f32_16x16x32_bf16 v[68:71], a[216:219], a[36:39], v[68:71]
  buffer_load_dwordx4 a[220:223], v13, s[8:11], s30 offen offset:3072 sc1
  v_mfma_f32_16x16x32_bf16 v[72:75], a[212:215], a[24:27], v[72:75]
  buffer_load_dwordx4 v[248:251], v3, s[8:11], s60 offen sc1
  v_permlane16_swap_b32 v30, v26
  v_mfma_f32_16x16x32_bf16 v[80:83], a[212:215], a[28:31], v[80:83]
  v_permlane16_swap_b32 v27, v31
  v_mfma_f32_16x16x32_bf16 v[88:91], a[212:215], a[32:35], v[88:91]
  v_mfma_f32_16x16x32_bf16 v[96:99], a[212:215], a[36:39], v[96:99]
  buffer_load_dwordx4 a[216:219], v13, s[8:11], s30 offen offset:3200 sc1
  v_accvgpr_write_b32 a16, v30
  v_mfma_f32_16x16x32_bf16 v[76:79], a[208:211], a[24:27], v[76:79]
  v_accvgpr_write_b32 a17, v27
  v_mfma_f32_16x16x32_bf16 v[84:87], a[208:211], a[28:31], v[84:87]
  v_mfma_f32_16x16x32_bf16 v[92:95], a[208:211], a[32:35], v[92:95]
  v_accvgpr_write_b32 a18, v26
  v_mfma_f32_16x16x32_bf16 v[100:103], a[208:211], a[36:39], v[100:103]
  s_addk_i32 s64, 8192
  buffer_load_dwordx4 a[212:215], v1, s[8:11], s64 offen offset:0 sc1
  v_mfma_f32_16x16x32_bf16 v[168:171], a[204:207], a[24:27], v[168:171]
  v_accvgpr_write_b32 a19, v31
  v_mfma_f32_16x16x32_bf16 v[172:175], a[204:207], a[28:31], v[172:175]
  v_mov_b32 v20, v33
  v_mfma_f32_16x16x32_bf16 v[176:179], a[204:207], a[32:35], v[176:179]
  v_mfma_f32_16x16x32_bf16 v[180:183], a[204:207], a[36:39], v[180:183]
  s_addk_i32 s30, 4096
  buffer_load_dwordx4 a[208:211], v13, s[8:11], s30 offen offset:3072 sc1
  v_mov_b32 v21, v36
  s_waitcnt vmcnt(29) lgkmcnt(0)
  v_mfma_f32_16x16x32_bf16 v[40:43], a[200:203], a[40:43], v[40:43]
  s_barrier
  ds_read_b128 a[24:27], v6 offset:20480
  v_mov_b32 v24, v23
  v_mfma_f32_16x16x32_bf16 v[48:51], a[200:203], a[44:47], v[48:51]
  v_mfma_f32_16x16x32_bf16 v[56:59], a[200:203], a[48:51], v[56:59]
  ds_read_b128 a[28:31], v6 offset:20736
  v_mov_b32 v32, v23
  v_mfma_f32_16x16x32_bf16 v[64:67], a[200:203], a[52:55], v[64:67]
  buffer_load_dwordx4 a[204:207], v13, s[8:11], s30 offen offset:3200 sc1
  v_permlane32_swap_b32 v32, v24
  v_mfma_f32_16x16x32_bf16 v[44:47], a[196:199], a[40:43], v[44:47]
  ds_read_b128 a[32:35], v7 offset:20480
  v_mfma_f32_16x16x32_bf16 v[52:55], a[196:199], a[44:47], v[52:55]
  v_mul_f32 v32, 0x3ae38e39, v32
  v_mfma_f32_16x16x32_bf16 v[60:63], a[196:199], a[48:51], v[60:63]
  ds_read_b128 a[36:39], v7 offset:20736
  v_mfma_f32_16x16x32_bf16 v[68:71], a[196:199], a[52:55], v[68:71]
  s_addk_i32 s30, 4096
  buffer_load_dwordx4 a[200:203], v13, s[8:11], s30 offen offset:0 sc1
  v_mul_f32 v24, 0x3ae38e39, v24
  v_mfma_f32_16x16x32_bf16 v[72:75], a[192:195], a[40:43], v[72:75]
  v_fma_f32 v24, -v32, v32, v24
  v_mfma_f32_16x16x32_bf16 v[80:83], a[192:195], a[44:47], v[80:83]
  v_mfma_f32_16x16x32_bf16 v[88:91], a[192:195], a[48:51], v[88:91]
  v_max_f32 v24, 0, v24
  v_mfma_f32_16x16x32_bf16 v[96:99], a[192:195], a[52:55], v[96:99]
  buffer_load_dwordx4 a[196:199], v13, s[8:11], s30 offen offset:128 sc1
  v_mov_b32 v25, 0x3f800054
  v_mfma_f32_16x16x32_bf16 v[76:79], a[188:191], a[40:43], v[76:79]
  s_cmp_eq_u32 s38, 2
  s_cbranch_scc0 L_lw2_e
  buffer_store_dwordx4 v[184:187], v3, s[8:11], s86 offen sc1
  buffer_store_dwordx4 v[188:191], v3, s[8:11], s87 offen sc1
  buffer_store_dwordx4 v[192:195], v3, s[8:11], s88 offen sc1
  buffer_store_dwordx4 v[196:199], v3, s[8:11], s89 offen sc1
  buffer_store_dwordx4 v[200:203], v3, s[8:11], s90 offen sc1
  buffer_store_dwordx4 v[204:207], v3, s[8:11], s91 offen sc1
  buffer_store_dwordx4 v[208:211], v3, s[8:11], s96 offen sc1
  buffer_store_dwordx4 v[212:215], v3, s[8:11], s97 offen sc1
L_lw2_e:
  v_mfma_f32_16x16x32_bf16 v[84:87], a[188:191], a[44:47], v[84:87]
  v_mov_b32 v26, 0x2edbe6ff
  v_mfma_f32_16x16x32_bf16 v[92:95], a[188:191], a[48:51], v[92:95]
  v_fma_f32 v24, v24, v25, v26
  v_mfma_f32_16x16x32_bf16 v[100:103], a[188:191], a[52:55], v[100:103]
  s_addk_i32 s64, 4096
  buffer_load_dwordx4 a[192:195], v1, s[8:11], s64 offen offset:1024 sc1
  v_mfma_f32_16x16x32_bf16 v[168:171], a[184:187], a[40:43], v[168:171]
  v_mfma_f32_16x16x32_bf16 v[172:175], a[184:187], a[44:47], v[172:175]
  v_rsq_f32 v25, v24
  v_mfma_f32_16x16x32_bf16 v[176:179], a[184:187], a[48:51], v[176:179]
  v_mfma_f32_16x16x32_bf16 v[180:183], a[184:187], a[52:55], v[180:183]
  s_addk_i32 s30, 4096
  buffer_load_dwordx4 a[188:191], v13, s[8:11], s30 offen offset:0 sc1
  v_mul_f32 v24, v24, v25
  s_waitcnt vmcnt(27) lgkmcnt(0)
  v_mfma_f32_16x16x32_bf16 v[40:43], a[180:183], a[24:27], v[40:43]
  ds_read_b128 a[40:43], v6 offset:22528
  v_mfma_f32_16x16x32_bf16 v[48:51], a[180:183], a[28:31], v[48:51]
  v_mul_f32 v18, 0xc0135761, v25
  v_mfma_f32_16x16x32_bf16 v[56:59], a[180:183], a[32:35], v[56:59]
  ds_read_b128 a[44:47], v6 offset:22784
  v_mul_f32 v19, 0xc0135761, v25
  v_mfma_f32_16x16x32_bf16 v[64:67], a[180:183], a[36:39], v[64:67]
  buffer_load_dwordx4 a[184:187], v13, s[8:11], s30 offen offset:128 sc1
  v_mfma_f32_16x16x32_bf16 v[44:47], a[176:179], a[24:27], v[44:47]
  ds_read_b128 a[48:51], v7 offset:22528
  v_mul_f32 v26, v25, v25
  v_mfma_f32_16x16x32_bf16 v[52:55], a[176:179], a[28:31], v[52:55]
  v_mfma_f32_16x16x32_bf16 v[60:63], a[176:179], a[32:35], v[60:63]
  ds_read_b128 a[52:55], v7 offset:22784
  v_mul_f32 v26, v26, v25
  v_mfma_f32_16x16x32_bf16 v[68:71], a[176:179], a[36:39], v[68:71]
  buffer_load_dwordx4 a[180:183], v13, s[8:11], s30 offen offset:1024 sc1
  v_mul_f32 v33, 0xbdd2d3e8, v26
  v_mfma_f32_16x16x32_bf16 v[72:75], a[172:175], a[24:27], v[72:75]
  v_mfma_f32_16x16x32_bf16 v[80:83], a[172:175], a[28:31], v[80:83]
  v_mul_f32 v36, 0xbdd2d3e8, v26
  v_mfma_f32_16x16x32_bf16 v[88:91], a[172:175], a[32:35], v[88:91]
  v_permlane16_swap_b32 v18, v19
  v_mfma_f32_16x16x32_bf16 v[96:99], a[172:175], a[36:39], v[96:99]
  buffer_load_dwordx4 a[176:179], v13, s[8:11], s30 offen offset:1152 sc1
  v_mfma_f32_16x16x32_bf16 v[76:79], a[168:171], a[24:27], v[76:79]
  v_sub_f32 v32, 0, v32
  v_mfma_f32_16x16x32_bf16 v[84:87], a[168:171], a[28:31], v[84:87]
  v_permlane16_swap_b32 v33, v36
  v_mfma_f32_16x16x32_bf16 v[92:95], a[168:171], a[32:35], v[92:95]
  v_mfma_f32_16x16x32_bf16 v[100:103], a[168:171], a[36:39], v[100:103]
  s_addk_i32 s64, 4096
  buffer_load_dwordx4 a[172:175], v1, s[8:11], s64 offen offset:2048 sc1
  v_cvt_pk_bf16_f32 v27, v32, v24
  v_mfma_f32_16x16x32_bf16 v[168:171], a[164:167], a[24:27], v[168:171]
  v_mfma_f32_16x16x32_bf16 v[172:175], a[164:167], a[28:31], v[172:175]
  v_lshlrev_b32 v28, 16, v27
  v_mfma_f32_16x16x32_bf16 v[176:179], a[164:167], a[32:35], v[176:179]
  v_and_b32 v29, 0xffff0000, v27
  v_mfma_f32_16x16x32_bf16 v[180:183], a[164:167], a[36:39], v[180:183]
  s_addk_i32 s30, 4096
  buffer_load_dwordx4 a[168:171], v13, s[8:11], s30 offen offset:1024 sc1
  s_waitcnt vmcnt(27) lgkmcnt(0)
  v_mfma_f32_16x16x32_bf16 v[40:43], a[160:163], a[40:43], v[40:43]
  s_barrier
  ds_read_b128 a[24:27], v6 offset:24576
  v_sub_f32 v28, v32, v28
  v_mfma_f32_16x16x32_bf16 v[48:51], a[160:163], a[44:47], v[48:51]
  v_sub_f32 v29, v24, v29
  v_mfma_f32_16x16x32_bf16 v[56:59], a[160:163], a[48:51], v[56:59]
  ds_read_b128 a[28:31], v6 offset:24832
  v_mfma_f32_16x16x32_bf16 v[64:67], a[160:163], a[52:55], v[64:67]
  buffer_load_dwordx4 a[164:167], v13, s[8:11], s30 offen offset:1152 sc1
  v_cvt_pk_bf16_f32 v30, v32, v28
  v_mfma_f32_16x16x32_bf16 v[44:47], a[156:159], a[40:43], v[44:47]
  ds_read_b128 a[32:35], v7 offset:24576
  s_waitcnt vmcnt(14)
  v_xor_b32 v248, s3, v248
  v_xor_b32 v249, s3, v249
  v_cvt_pk_bf16_f32 v26, v32, v28
  v_mfma_f32_16x16x32_bf16 v[52:55], a[156:159], a[44:47], v[52:55]
  v_xor_b32 v250, s3, v250
  v_xor_b32 v251, s3, v251
  v_mfma_f32_16x16x32_bf16 v[60:63], a[156:159], a[48:51], v[60:63]
  ds_read_b128 a[36:39], v7 offset:24832
  v_or3_b32 v248, v248, v249, v250
  v_or_b32 v248, v248, v251
  v_cvt_pk_bf16_f32 v31, v32, v29
  v_mfma_f32_16x16x32_bf16 v[68:71], a[156:159], a[52:55], v[68:71]
  buffer_load_dwordx4 a[160:163], v13, s[8:11], s30 offen offset:2048 sc1
  v_cmp_ne_u32 vcc, 0, v248
  v_mfma_f32_16x16x32_bf16 v[72:75], a[152:155], a[40:43], v[72:75]
  v_permlane16_swap_b32 v30, v26
  v_mfma_f32_16x16x32_bf16 v[80:83], a[152:155], a[44:47], v[80:83]
  s_nop 1
  s_cbranch_vccnz L_f3_w
L_f3_k:
  v_permlane16_swap_b32 v27, v31
  v_mfma_f32_16x16x32_bf16 v[88:91], a[152:155], a[48:51], v[88:91]
  s_add_u32 s60, s60, 16384
  s_add_u32 s61, s61, 16384
  v_mfma_f32_16x16x32_bf16 v[96:99], a[152:155], a[52:55], v[96:99]
  buffer_load_dwordx4 a[156:159], v13, s[8:11], s30 offen offset:2176 sc1
  v_accvgpr_write_b32 a20, v30
  v_mfma_f32_16x16x32_bf16 v[76:79], a[148:151], a[40:43], v[76:79]
  v_accvgpr_write_b32 a21, v27
  v_mfma_f32_16x16x32_bf16 v[84:87], a[148:151], a[44:47], v[84:87]
  v_mfma_f32_16x16x32_bf16 v[92:95], a[148:151], a[48:51], v[92:95]
  v_accvgpr_write_b32 a22, v26
  v_mfma_f32_16x16x32_bf16 v[100:103], a[148:151], a[52:55], v[100:103]
  s_addk_i32 s64, 4096
  buffer_load_dwordx4 a[152:155], v1, s[8:11], s64 offen offset:3072 sc1
  v_mfma_f32_16x16x32_bf16 v[168:171], a[144:147], a[40:43], v[168:171]
  v_accvgpr_write_b32 a23, v31
  v_mfma_f32_16x16x32_bf16 v[172:175], a[144:147], a[44:47], v[172:175]
  v_mov_b32 v22, v33
  v_mfma_f32_16x16x32_bf16 v[176:179], a[144:147], a[48:51], v[176:179]
  v_mfma_f32_16x16x32_bf16 v[180:183], a[144:147], a[52:55], v[180:183]
  s_addk_i32 s30, 4096
  buffer_load_dwordx2 a[148:149], v15, s[8:11], s30 offen offset:2048 sc1
  buffer_load_dwordx2 a[150:151], v15, s[8:11], s30 offen offset:2176 sc1
  v_mov_b32 v23, v36
  s_waitcnt lgkmcnt(0)
  v_mfma_f32_16x16x32_bf16 v[40:43], a[140:143], a[24:27], v[40:43]
  ds_read_b128 a[40:43], v6 offset:26624
  v_mfma_f32_16x16x32_bf16 v[48:51], a[140:143], a[28:31], v[48:51]
  v_mfma_f32_16x16x32_bf16 v[56:59], a[140:143], a[32:35], v[56:59]
  ds_read_b128 a[44:47], v6 offset:26880
  v_mfma_f32_16x16x32_bf16 v[64:67], a[140:143], a[36:39], v[64:67]
  buffer_load_dwordx2 a[144:145], v15, s[8:11], s30 offen offset:3072 sc1
  buffer_load_dwordx2 a[146:147], v15, s[8:11], s30 offen offset:3200 sc1
  v_mfma_f32_16x16x32_bf16 v[44:47], a[136:139], a[24:27], v[44:47]
  ds_read_b128 a[48:51], v7 offset:26624
  v_mfma_f32_16x16x32_bf16 v[52:55], a[136:139], a[28:31], v[52:55]
  v_mfma_f32_16x16x32_bf16 v[60:63], a[136:139], a[32:35], v[60:63]
  ds_read_b128 a[52:55], v7 offset:26880
  v_mfma_f32_16x16x32_bf16 v[68:71], a[136:139], a[36:39], v[68:71]
  s_addk_i32 s64, 8192
  s_lshl_b32 s50, s19, 7
  s_add_u32 s50, s50, s64
  buffer_load_dwordx2 a[140:141], v15, s[8:11], s50 offen offset:0 sc1
  v_mfma_f32_16x16x32_bf16 v[72:75], a[132:135], a[24:27], v[72:75]
  v_mfma_f32_16x16x32_bf16 v[80:83], a[132:135], a[28:31], v[80:83]
  v_mfma_f32_16x16x32_bf16 v[88:91], a[132:135], a[32:35], v[88:91]
  v_mfma_f32_16x16x32_bf16 v[96:99], a[132:135], a[36:39], v[96:99]
  s_addk_i32 s30, 4096
  s_mov_b32 exec_lo, 0
  v_add_u32 v13, 4294966272, v13
  s_mov_b32 exec_lo, -1
  buffer_load_dwordx4 a[136:139], v13, s[8:11], s30 offen offset:1024 sc1
  v_mfma_f32_16x16x32_bf16 v[76:79], a[128:131], a[24:27], v[76:79]
  v_mfma_f32_16x16x32_bf16 v[84:87], a[128:131], a[28:31], v[84:87]
  v_mfma_f32_16x16x32_bf16 v[92:95], a[128:131], a[32:35], v[92:95]
  v_mfma_f32_16x16x32_bf16 v[100:103], a[128:131], a[36:39], v[100:103]
  buffer_load_dwordx4 a[132:135], v13, s[8:11], s30 offen offset:1152 sc1
  v_mfma_f32_16x16x32_bf16 v[168:171], a[252:255], a[24:27], v[168:171]
  v_mfma_f32_16x16x32_bf16 v[172:175], a[252:255], a[28:31], v[172:175]
  v_mfma_f32_16x16x32_bf16 v[176:179], a[252:255], a[32:35], v[176:179]
  v_mfma_f32_16x16x32_bf16 v[180:183], a[252:255], a[36:39], v[180:183]
  buffer_load_dwordx4 a[128:131], v13, s[8:11], s30 offen offset:2048 sc1
  s_waitcnt lgkmcnt(0)
  v_mfma_f32_16x16x32_bf16 v[40:43], a[248:251], a[40:43], v[40:43]
  s_barrier
  ds_read_b128 a[24:27], v6 offset:28672
  v_mfma_f32_16x16x32_bf16 v[48:51], a[248:251], a[44:47], v[48:51]
  v_mfma_f32_16x16x32_bf16 v[56:59], a[248:251], a[48:51], v[56:59]
  ds_read_b128 a[28:31], v6 offset:28928
  v_mfma_f32_16x16x32_bf16 v[64:67], a[248:251], a[52:55], v[64:67]
  buffer_load_dwordx4 a[252:255], v13, s[8:11], s30 offen offset:2176 sc1
  v_mfma_f32_16x16x32_bf16 v[44:47], a[244:247], a[40:43], v[44:47]
  ds_read_b128 a[32:35], v7 offset:28672
  v_mfma_f32_16x16x32_bf16 v[52:55], a[244:247], a[44:47], v[52:55]
  v_mfma_f32_16x16x32_bf16 v[60:63], a[244:247], a[48:51], v[60:63]
  ds_read_b128 a[36:39], v7 offset:28928
  v_mfma_f32_16x16x32_bf16 v[68:71], a[244:247], a[52:55], v[68:71]
  s_addk_i32 s30, 4096
  buffer_load_dwordx4 a[248:251], v13, s[8:11], s30 offen offset:1024 sc1
  v_mfma_f32_16x16x32_bf16 v[72:75], a[240:243], a[40:43], v[72:75]
  v_mfma_f32_16x16x32_bf16 v[80:83], a[240:243], a[44:47], v[80:83]
  v_mfma_f32_16x16x32_bf16 v[88:91], a[240:243], a[48:51], v[88:91]
  v_mfma_f32_16x16x32_bf16 v[96:99], a[240:243], a[52:55], v[96:99]
  buffer_load_dwordx4 a[244:247], v13, s[8:11], s30 offen offset:1152 sc1
  v_mfma_f32_16x16x32_bf16 v[76:79], a[236:239], a[40:43], v[76:79]
  v_mfma_f32_16x16x32_bf16 v[84:87], a[236:239], a[44:47], v[84:87]
  v_mfma_f32_16x16x32_bf16 v[92:95], a[236:239], a[48:51], v[92:95]
  v_mfma_f32_16x16x32_bf16 v[100:103], a[236:239], a[52:55], v[100:103]
  buffer_load_dwordx4 a[240:243], v13, s[8:11], s30 offen offset:2048 sc1
  v_mfma_f32_16x16x32_bf16 v[168:171], a[232:235], a[40:43], v[168:171]
  v_mfma_f32_16x16x32_bf16 v[172:175], a[232:235], a[44:47], v[172:175]
  v_mfma_f32_16x16x32_bf16 v[176:179], a[232:235], a[48:51], v[176:179]
  v_mfma_f32_16x16x32_bf16 v[180:183], a[232:235], a[52:55], v[180:183]
  buffer_load_dwordx4 a[236:239], v13, s[8:11], s30 offen offset:2176 sc1
  s_waitcnt vmcnt(28) lgkmcnt(0)
  v_mfma_f32_16x16x32_bf16 v[40:43], a[228:231], a[24:27], v[40:43]
  ds_read_b128 a[40:43], v6 offset:30720
  v_mfma_f32_16x16x32_bf16 v[48:51], a[228:231], a[28:31], v[48:51]
  v_mfma_f32_16x16x32_bf16 v[56:59], a[228:231], a[32:35], v[56:59]
  ds_read_b128 a[44:47], v6 offset:30976
  v_mfma_f32_16x16x32_bf16 v[64:67], a[228:231], a[36:39], v[64:67]
  s_addk_i32 s30, 4096
  buffer_load_dwordx4 a[232:235], v13, s[8:11], s30 offen offset:1024 sc1
  v_mfma_f32_16x16x32_bf16 v[44:47], a[224:227], a[24:27], v[44:47]
  ds_read_b128 a[48:51], v7 offset:30720
  v_mfma_f32_16x16x32_bf16 v[52:55], a[224:227], a[28:31], v[52:55]
  v_mfma_f32_16x16x32_bf16 v[60:63], a[224:227], a[32:35], v[60:63]
  ds_read_b128 a[52:55], v7 offset:30976
  v_mfma_f32_16x16x32_bf16 v[68:71], a[224:227], a[36:39], v[68:71]
  buffer_load_dwordx4 a[228:231], v13, s[8:11], s30 offen offset:1152 sc1
  v_mfma_f32_16x16x32_bf16 v[72:75], a[220:223], a[24:27], v[72:75]
  v_mfma_f32_16x16x32_bf16 v[80:83], a[220:223], a[28:31], v[80:83]
  v_mfma_f32_16x16x32_bf16 v[88:91], a[220:223], a[32:35], v[88:91]
  v_mfma_f32_16x16x32_bf16 v[96:99], a[220:223], a[36:39], v[96:99]
  buffer_load_dwordx4 a[224:227], v13, s[8:11], s30 offen offset:2048 sc1
  v_mfma_f32_16x16x32_bf16 v[76:79], a[216:219], a[24:27], v[76:79]
  v_mfma_f32_16x16x32_bf16 v[84:87], a[216:219], a[28:31], v[84:87]
  v_mfma_f32_16x16x32_bf16 v[92:95], a[216:219], a[32:35], v[92:95]
  v_mfma_f32_16x16x32_bf16 v[100:103], a[216:219], a[36:39], v[100:103]
  buffer_load_dwordx4 a[220:223], v13, s[8:11], s30 offen offset:2176 sc1
  v_mfma_f32_16x16x32_bf16 v[168:171], a[212:215], a[24:27], v[168:171]
  v_mfma_f32_16x16x32_bf16 v[172:175], a[212:215], a[28:31], v[172:175]
  v_mfma_f32_16x16x32_bf16 v[176:179], a[212:215], a[32:35], v[176:179]
  v_mfma_f32_16x16x32_bf16 v[180:183], a[212:215], a[36:39], v[180:183]
  s_addk_i32 s30, 4096
  buffer_load_dwordx4 a[216:219], v13, s[8:11], s30 offen offset:1024 sc1
  s_waitcnt vmcnt(28) lgkmcnt(0)
  v_mfma_f32_16x16x32_bf16 v[40:43], a[208:211], a[40:43], v[40:43]
  s_barrier
  s_cmp_eq_u32 s16, 0
  s_cbranch_scc0 L_f4_ns
  v_mov_b32 v36, s3
  v_lshlrev_b32 v37, 10, v2
  s_mov_b64 exec, 0xff
  buffer_store_dword v36, v37, s[8:11], s61 offen sc1
  s_mov_b64 exec, -1
L_f4_ns:
  ds_read_b128 a[24:27], v6 offset:32768
  v_mfma_f32_16x16x32_bf16 v[48:51], a[208:211], a[44:47], v[48:51]
  v_mfma_f32_16x16x32_bf16 v[56:59], a[208:211], a[48:51], v[56:59]
  ds_read_b128 a[28:31], v6 offset:33024
  v_mfma_f32_16x16x32_bf16 v[64:67], a[208:211], a[52:55], v[64:67]
  buffer_load_dwordx4 a[212:215], v13, s[8:11], s30 offen offset:1152 sc1
  v_mfma_f32_16x16x32_bf16 v[44:47], a[204:207], a[40:43], v[44:47]
  ds_read_b128 a[32:35], v7 offset:32768
  v_mfma_f32_16x16x32_bf16 v[52:55], a[204:207], a[44:47], v[52:55]
  v_mfma_f32_16x16x32_bf16 v[60:63], a[204:207], a[48:51], v[60:63]
  ds_read_b128 a[36:39], v7 offset:33024
  v_mfma_f32_16x16x32_bf16 v[68:71], a[204:207], a[52:55], v[68:71]
  buffer_load_dwordx4 a[208:211], v13, s[8:11], s30 offen offset:2048 sc1
  v_mfma_f32_16x16x32_bf16 v[72:75], a[200:203], a[40:43], v[72:75]
  v_mfma_f32_16x16x32_bf16 v[80:83], a[200:203], a[44:47], v[80:83]
  v_mfma_f32_16x16x32_bf16 v[88:91], a[200:203], a[48:51], v[88:91]
  v_mfma_f32_16x16x32_bf16 v[96:99], a[200:203], a[52:55], v[96:99]
  buffer_load_dwordx4 a[204:207], v13, s[8:11], s30 offen offset:2176 sc1
  v_mfma_f32_16x16x32_bf16 v[76:79], a[196:199], a[40:43], v[76:79]
  v_mfma_f32_16x16x32_bf16 v[84:87], a[196:199], a[44:47], v[84:87]
  v_mfma_f32_16x16x32_bf16 v[92:95], a[196:199], a[48:51], v[92:95]
  v_mfma_f32_16x16x32_bf16 v[100:103], a[196:199], a[52:55], v[100:103]
  s_addk_i32 s30, 4096
  buffer_load_dwordx4 a[200:203], v13, s[8:11], s30 offen offset:1024 sc1
  v_mfma_f32_16x16x32_bf16 v[168:171], a[192:195], a[40:43], v[168:171]
  v_mfma_f32_16x16x32_bf16 v[172:175], a[192:195], a[44:47], v[172:175]
  v_mfma_f32_16x16x32_bf16 v[176:179], a[192:195], a[48:51], v[176:179]
  v_mfma_f32_16x16x32_bf16 v[180:183], a[192:195], a[52:55], v[180:183]
  buffer_load_dwordx4 a[196:199], v13, s[8:11], s30 offen offset:1152 sc1
  s_waitcnt vmcnt(28) lgkmcnt(0)
  v_mfma_f32_16x16x32_bf16 v[40:43], a[188:191], a[24:27], v[40:43]
  ds_read_b128 a[40:43], v6 offset:34816
  v_mfma_f32_16x16x32_bf16 v[48:51], a[188:191], a[28:31], v[48:51]
  v_mfma_f32_16x16x32_bf16 v[56:59], a[188:191], a[32:35], v[56:59]
  ds_read_b128 a[44:47], v6 offset:35072
  v_mfma_f32_16x16x32_bf16 v[64:67], a[188:191], a[36:39], v[64:67]
  buffer_load_dwordx4 a[192:195], v13, s[8:11], s30 offen offset:2048 sc1
  v_mfma_f32_16x16x32_bf16 v[44:47], a[184:187], a[24:27], v[44:47]
  ds_read_b128 a[48:51], v7 offset:34816
  v_mfma_f32_16x16x32_bf16 v[52:55], a[184:187], a[28:31], v[52:55]
  v_mfma_f32_16x16x32_bf16 v[60:63], a[184:187], a[32:35], v[60:63]
  ds_read_b128 a[52:55], v7 offset:35072
  v_mfma_f32_16x16x32_bf16 v[68:71], a[184:187], a[36:39], v[68:71]
  buffer_load_dwordx4 a[188:191], v13, s[8:11], s30 offen offset:2176 sc1
  v_mfma_f32_16x16x32_bf16 v[72:75], a[180:183], a[24:27], v[72:75]
  v_mfma_f32_16x16x32_bf16 v[80:83], a[180:183], a[28:31], v[80:83]
  v_mfma_f32_16x16x32_bf16 v[88:91], a[180:183], a[32:35], v[88:91]
  v_mfma_f32_16x16x32_bf16 v[96:99], a[180:183], a[36:39], v[96:99]
  s_addk_i32 s30, 4096
  buffer_load_dwordx4 a[184:187], v13, s[8:11], s30 offen offset:1024 sc1
  v_mfma_f32_16x16x32_bf16 v[76:79], a[176:179], a[24:27], v[76:79]
  v_mfma_f32_16x16x32_bf16 v[84:87], a[176:179], a[28:31], v[84:87]
  v_mfma_f32_16x16x32_bf16 v[92:95], a[176:179], a[32:35], v[92:95]
  v_mfma_f32_16x16x32_bf16 v[100:103], a[176:179], a[36:39], v[100:103]
  buffer_load_dwordx4 a[180:183], v13, s[8:11], s30 offen offset:1152 sc1
  v_mfma_f32_16x16x32_bf16 v[168:171], a[172:175], a[24:27], v[168:171]
  v_mfma_f32_16x16x32_bf16 v[172:175], a[172:175], a[28:31], v[172:175]
  v_mfma_f32_16x16x32_bf16 v[176:179], a[172:175], a[32:35], v[176:179]
  v_mfma_f32_16x16x32_bf16 v[180:183], a[172:175], a[36:39], v[180:183]
  buffer_load_dwordx4 a[176:179], v13, s[8:11], s30 offen offset:2048 sc1
  s_waitcnt vmcnt(28) lgkmcnt(0)
  v_mfma_f32_16x16x32_bf16 v[40:43], a[168:171], a[40:43], v[40:43]
  v_mfma_f32_16x16x32_bf16 v[48:51], a[168:171], a[44:47], v[48:51]
  v_mfma_f32_16x16x32_bf16 v[56:59], a[168:171], a[48:51], v[56:59]
  v_mfma_f32_16x16x32_bf16 v[64:67], a[168:171], a[52:55], v[64:67]
  buffer_load_dwordx4 a[172:175], v13, s[8:11], s30 offen offset:2176 sc1
  v_mfma_f32_16x16x32_bf16 v[44:47], a[164:167], a[40:43], v[44:47]
  v_mfma_f32_16x16x32_bf16 v[52:55], a[164:167], a[44:47], v[52:55]
  v_mfma_f32_16x16x32_bf16 v[60:63], a[164:167], a[48:51], v[60:63]
  v_mfma_f32_16x16x32_bf16 v[68:71], a[164:167], a[52:55], v[68:71]
  s_addk_i32 s30, 4096
  buffer_load_dwordx4 a[168:171], v13, s[8:11], s30 offen offset:1024 sc1
  v_mfma_f32_16x16x32_bf16 v[72:75], a[160:163], a[40:43], v[72:75]
  v_mfma_f32_16x16x32_bf16 v[80:83], a[160:163], a[44:47], v[80:83]
  v_mfma_f32_16x16x32_bf16 v[88:91], a[160:163], a[48:51], v[88:91]
  v_mfma_f32_16x16x32_bf16 v[96:99], a[160:163], a[52:55], v[96:99]
  buffer_load_dwordx4 a[164:167], v13, s[8:11], s30 offen offset:1152 sc1
  v_mfma_f32_16x16x32_bf16 v[76:79], a[156:159], a[40:43], v[76:79]
  v_mfma_f32_16x16x32_bf16 v[84:87], a[156:159], a[44:47], v[84:87]
  v_mfma_f32_16x16x32_bf16 v[92:95], a[156:159], a[48:51], v[92:95]
  v_mfma_f32_16x16x32_bf16 v[100:103], a[156:159], a[52:55], v[100:103]
  buffer_load_dwordx4 a[160:163], v13, s[8:11], s30 offen offset:2048 sc1
  v_mfma_f32_16x16x32_bf16 v[168:171], a[152:155], a[40:43], v[168:171]
  v_mfma_f32_16x16x32_bf16 v[172:175], a[152:155], a[44:47], v[172:175]
  v_mfma_f32_16x16x32_bf16 v[176:179], a[152:155], a[48:51], v[176:179]
  v_mfma_f32_16x16x32_bf16 v[180:183], a[152:155], a[52:55], v[180:183]
  buffer_load_dwordx4 a[156:159], v13, s[8:11], s30 offen offset:2176 sc1
  s_waitcnt vmcnt(28)
  v_mfma_f32_16x16x16_bf16 v[40:43], a[148:149], a[16:17], v[40:43]
  ds_read_b128 a[24:27], v6 offset:0
  v_mfma_f32_16x16x16_bf16 v[48:51], a[148:149], a[18:19], v[48:51]
  v_mfma_f32_16x16x16_bf16 v[56:59], a[148:149], a[20:21], v[56:59]
  ds_read_b128 a[28:31], v6 offset:256
  v_mfma_f32_16x16x16_bf16 v[64:67], a[148:149], a[22:23], v[64:67]
  v_mfma_f32_16x16x16_bf16 v[44:47], a[150:151], a[16:17], v[44:47]
  ds_read_b128 a[32:35], v7 offset:0
  v_mfma_f32_16x16x16_bf16 v[52:55], a[150:151], a[18:19], v[52:55]
  v_mfma_f32_16x16x16_bf16 v[60:63], a[150:151], a[20:21], v[60:63]
  ds_read_b128 a[36:39], v7 offset:256
  v_mfma_f32_16x16x16_bf16 v[68:71], a[150:151], a[22:23], v[68:71]
  s_addk_i32 s30, 4096
  buffer_load_dwordx4 a[152:155], v13, s[8:11], s30 offen offset:1024 sc1
  v_mfma_f32_16x16x16_bf16 v[72:75], a[144:145], a[16:17], v[72:75]
  v_mfma_f32_16x16x16_bf16 v[80:83], a[144:145], a[18:19], v[80:83]
  v_mfma_f32_16x16x16_bf16 v[88:91], a[144:145], a[20:21], v[88:91]
  v_mfma_f32_16x16x16_bf16 v[96:99], a[144:145], a[22:23], v[96:99]
  v_mfma_f32_16x16x16_bf16 v[76:79], a[146:147], a[16:17], v[76:79]
  v_mfma_f32_16x16x16_bf16 v[84:87], a[146:147], a[18:19], v[84:87]
  v_mfma_f32_16x16x16_bf16 v[92:95], a[146:147], a[20:21], v[92:95]
  v_mfma_f32_16x16x16_bf16 v[100:103], a[146:147], a[22:23], v[100:103]
  buffer_load_dwordx4 a[148:151], v13, s[8:11], s30 offen offset:1152 sc1
  v_mfma_f32_16x16x16_bf16 v[168:171], a[140:141], a[16:17], v[168:171]
  v_mfma_f32_16x16x16_bf16 v[172:175], a[140:141], a[18:19], v[172:175]
  v_mfma_f32_16x16x16_bf16 v[176:179], a[140:141], a[20:21], v[176:179]
  v_mfma_f32_16x16x16_bf16 v[180:183], a[140:141], a[22:23], v[180:183]
  buffer_load_dwordx4 a[144:147], v13, s[8:11], s30 offen offset:2048 sc1
  s_waitcnt vmcnt(27) lgkmcnt(0)
  v_mfma_f32_16x16x32_bf16 v[104:107], a[136:139], a[24:27], 0
  ds_read_b128 a[40:43], v6 offset:2048
  v_mfma_f32_16x16x32_bf16 v[112:115], a[136:139], a[28:31], 0
  v_mfma_f32_16x16x32_bf16 v[120:123], a[136:139], a[32:35], 0
  ds_read_b128 a[44:47], v6 offset:2304
  v_mfma_f32_16x16x32_bf16 v[128:131], a[136:139], a[36:39], 0
  buffer_load_dwordx4 a[140:143], v13, s[8:11], s30 offen offset:2176 sc1
  v_mfma_f32_16x16x32_bf16 v[108:111], a[132:135], a[24:27], 0
  ds_read_b128 a[48:51], v7 offset:2048
  v_mul_f32 v24, v40, v40
  v_mul_f32 v25, v41, v41
  v_mfma_f32_16x16x32_bf16 v[116:119], a[132:135], a[28:31], 0
  v_mul_f32 v26, v42, v42
  v_mul_f32 v27, v43, v43
  v_mfma_f32_16x16x32_bf16 v[124:127], a[132:135], a[32:35], 0
  ds_read_b128 a[52:55], v7 offset:2304
  v_fma_f32 v24, v24, v20, v16
  v_fma_f32 v25, v25, v20, v16
  v_fma_f32 v26, v26, v20, v16
  v_mfma_f32_16x16x32_bf16 v[132:135], a[132:135], a[36:39], 0
  s_addk_i32 s30, 4096
  buffer_load_dwordx4 a[136:139], v13, s[8:11], s30 offen offset:1024 sc1
  v_fma_f32 v27, v27, v20, v16
  v_mul_f32 v24, v24, v40
  v_mfma_f32_16x16x32_bf16 v[136:139], a[128:131], a[24:27], 0
  v_mul_f32 v25, v25, v41
  v_mul_f32 v26, v26, v42
  v_mfma_f32_16x16x32_bf16 v[144:147], a[128:131], a[28:31], 0
  v_mul_f32 v27, v27, v43
  v_exp_f32 v24, v24
  v_mfma_f32_16x16x32_bf16 v[152:155], a[128:131], a[32:35], 0
  v_exp_f32 v25, v25
  v_mfma_f32_16x16x32_bf16 v[160:163], a[128:131], a[36:39], 0
  buffer_load_dwordx4 a[132:135], v13, s[8:11], s30 offen offset:1152 sc1
  v_exp_f32 v26, v26
  v_mfma_f32_16x16x32_bf16 v[140:143], a[252:255], a[24:27], 0
  v_exp_f32 v27, v27
  v_mfma_f32_16x16x32_bf16 v[148:151], a[252:255], a[28:31], 0
  v_add_f32 v24, 1.0, v24
  v_add_f32 v25, 1.0, v25
  v_mfma_f32_16x16x32_bf16 v[156:159], a[252:255], a[32:35], 0
  v_add_f32 v26, 1.0, v26
  v_add_f32 v27, 1.0, v27
  v_mfma_f32_16x16x32_bf16 v[164:167], a[252:255], a[36:39], 0
  buffer_load_dwordx4 a[128:131], v13, s[8:11], s30 offen offset:2048 sc1
  v_rcp_f32 v24, v24
  s_waitcnt vmcnt(27) lgkmcnt(0)
  v_mfma_f32_16x16x32_bf16 v[104:107], a[248:251], a[40:43], v[104:107]
  ds_read_b128 a[24:27], v6 offset:4096
  v_rcp_f32 v25, v25
  v_rcp_f32 v26, v26
  v_mfma_f32_16x16x32_bf16 v[112:115], a[248:251], a[44:47], v[112:115]
  v_rcp_f32 v27, v27
  v_mfma_f32_16x16x32_bf16 v[120:123], a[248:251], a[48:51], v[120:123]
  ds_read_b128 a[28:31], v6 offset:4352
  v_mul_f32 v24, v24, v40
  v_mfma_f32_16x16x32_bf16 v[128:131], a[248:251], a[52:55], v[128:131]
  buffer_load_dwordx4 a[252:255], v13, s[8:11], s30 offen offset:2176 sc1
  v_mul_f32 v25, v25, v41
  v_mul_f32 v26, v26, v42
  v_mul_f32 v27, v27, v43
  v_mfma_f32_16x16x32_bf16 v[108:111], a[244:247], a[40:43], v[108:111]
  ds_read_b128 a[32:35], v7 offset:4096
  v_cvt_pk_bf16_f32 v32, v24, v25
  v_cvt_pk_bf16_f32 v33, v26, v27
  v_mfma_f32_16x16x32_bf16 v[116:119], a[244:247], a[44:47], v[116:119]
  v_mul_f32 v28, v44, v44
  v_mul_f32 v29, v45, v45
  v_mfma_f32_16x16x32_bf16 v[124:127], a[244:247], a[48:51], v[124:127]
  ds_read_b128 a[36:39], v7 offset:4352
  v_mul_f32 v30, v46, v46
  v_mul_f32 v31, v47, v47
  v_mfma_f32_16x16x32_bf16 v[132:135], a[244:247], a[52:55], v[132:135]
  s_addk_i32 s30, 4096
  buffer_load_dwordx4 a[248:251], v13, s[8:11], s30 offen offset:1024 sc1
  v_fma_f32 v28, v28, v20, v16
  v_fma_f32 v29, v29, v20, v16
  v_fma_f32 v30, v30, v20, v16
  v_mfma_f32_16x16x32_bf16 v[136:139], a[240:243], a[40:43], v[136:139]
  v_fma_f32 v31, v31, v20, v16
  v_mul_f32 v28, v28, v44
  v_mfma_f32_16x16x32_bf16 v[144:147], a[240:243], a[44:47], v[144:147]
  v_mul_f32 v29, v29, v45
  v_mul_f32 v30, v30, v46
  v_mfma_f32_16x16x32_bf16 v[152:155], a[240:243], a[48:51], v[152:155]
  v_mul_f32 v31, v31, v47
  v_exp_f32 v28, v28
  v_mfma_f32_16x16x32_bf16 v[160:163], a[240:243], a[52:55], v[160:163]
  buffer_load_dwordx4 a[244:247], v13, s[8:11], s30 offen offset:1152 sc1
  v_exp_f32 v29, v29
  v_mfma_f32_16x16x32_bf16 v[140:143], a[236:239], a[40:43], v[140:143]
  v_exp_f32 v30, v30
  v_mfma_f32_16x16x32_bf16 v[148:151], a[236:239], a[44:47], v[148:151]
  v_exp_f32 v31, v31
  v_mfma_f32_16x16x32_bf16 v[156:159], a[236:239], a[48:51], v[156:159]
  v_add_f32 v28, 1.0, v28
  v_add_f32 v29, 1.0, v29
  v_mfma_f32_16x16x32_bf16 v[164:167], a[236:239], a[52:55], v[164:167]
  buffer_load_dwordx4 a[240:243], v13, s[8:11], s30 offen offset:2048 sc1
  v_add_f32 v30, 1.0, v30
  v_add_f32 v31, 1.0, v31
  s_waitcnt vmcnt(27) lgkmcnt(0)
  v_mfma_f32_16x16x32_bf16 v[104:107], a[232:235], a[24:27], v[104:107]
  ds_read_b128 a[40:43], v6 offset:6144
  v_rcp_f32 v28, v28
  v_mfma_f32_16x16x32_bf16 v[112:115], a[232:235], a[28:31], v[112:115]
  v_rcp_f32 v29, v29
  v_mfma_f32_16x16x32_bf16 v[120:123], a[232:235], a[32:35], v[120:123]
  ds_read_b128 a[44:47], v6 offset:6400
  v_rcp_f32 v30, v30
  v_rcp_f32 v31, v31
  v_mfma_f32_16x16x32_bf16 v[128:131], a[232:235], a[36:39], v[128:131]
  buffer_load_dwordx4 a[236:239], v13, s[8:11], s30 offen offset:2176 sc1
  v_mul_f32 v28, v28, v44
  v_mfma_f32_16x16x32_bf16 v[108:111], a[228:231], a[24:27], v[108:111]
  ds_read_b128 a[48:51], v7 offset:6144
  v_mul_f32 v29, v29, v45
  v_mul_f32 v30, v30, v46
  v_mul_f32 v31, v31, v47
  v_mfma_f32_16x16x32_bf16 v[116:119], a[228:231], a[28:31], v[116:119]
  v_cvt_pk_bf16_f32 v34, v28, v29
  v_cvt_pk_bf16_f32 v35, v30, v31
  v_mfma_f32_16x16x32_bf16 v[124:127], a[228:231], a[32:35], v[124:127]
  ds_read_b128 a[52:55], v7 offset:6400
  ds_write_b128 v10, v[32:35] offset:0
  v_mul_f32 v24, v48, v48
  v_mfma_f32_16x16x32_bf16 v[132:135], a[228:231], a[36:39], v[132:135]
  s_addk_i32 s30, 4096
  buffer_load_dwordx4 a[232:235], v13, s[8:11], s30 offen offset:1024 sc1
  v_mul_f32 v25, v49, v49
  v_mul_f32 v26, v50, v50
  v_mfma_f32_16x16x32_bf16 v[136:139], a[224:227], a[24:27], v[136:139]
  v_mul_f32 v27, v51, v51
  v_fma_f32 v24, v24, v21, v17
  v_fma_f32 v25, v25, v21, v17
  v_mfma_f32_16x16x32_bf16 v[144:147], a[224:227], a[28:31], v[144:147]
  v_fma_f32 v26, v26, v21, v17
  v_fma_f32 v27, v27, v21, v17
  v_mfma_f32_16x16x32_bf16 v[152:155], a[224:227], a[32:35], v[152:155]
  v_mul_f32 v24, v24, v48
  v_mul_f32 v25, v25, v49
  v_mfma_f32_16x16x32_bf16 v[160:163], a[224:227], a[36:39], v[160:163]
  buffer_load_dwordx4 a[228:231], v13, s[8:11], s30 offen offset:1152 sc1
  v_mul_f32 v26, v26, v50
  v_mul_f32 v27, v27, v51
  v_mfma_f32_16x16x32_bf16 v[140:143], a[220:223], a[24:27], v[140:143]
  v_exp_f32 v24, v24
  v_mfma_f32_16x16x32_bf16 v[148:151], a[220:223], a[28:31], v[148:151]
  v_exp_f32 v25, v25
  v_mfma_f32_16x16x32_bf16 v[156:159], a[220:223], a[32:35], v[156:159]
  v_exp_f32 v26, v26
  v_mfma_f32_16x16x32_bf16 v[164:167], a[220:223], a[36:39], v[164:167]
  buffer_load_dwordx4 a[224:227], v13, s[8:11], s30 offen offset:2048 sc1
  v_exp_f32 v27, v27
  v_add_f32 v24, 1.0, v24
  s_waitcnt vmcnt(27) lgkmcnt(1)
  v_mfma_f32_16x16x32_bf16 v[104:107], a[216:219], a[40:43], v[104:107]
  ds_read_b128 a[24:27], v6 offset:8192
  v_add_f32 v25, 1.0, v25
  v_add_f32 v26, 1.0, v26
  v_mfma_f32_16x16x32_bf16 v[112:115], a[216:219], a[44:47], v[112:115]
  v_add_f32 v27, 1.0, v27
  v_rcp_f32 v24, v24
  v_mfma_f32_16x16x32_bf16 v[120:123], a[216:219], a[48:51], v[120:123]
  ds_read_b128 a[28:31], v6 offset:8448
  v_rcp_f32 v25, v25
  v_mfma_f32_16x16x32_bf16 v[128:131], a[216:219], a[52:55], v[128:131]
  buffer_load_dwordx4 a[220:223], v13, s[8:11], s30 offen offset:2176 sc1
  v_rcp_f32 v26, v26
  v_mfma_f32_16x16x32_bf16 v[108:111], a[212:215], a[40:43], v[108:111]
  ds_read_b128 a[32:35], v7 offset:8192
  v_rcp_f32 v27, v27
  v_mfma_f32_16x16x32_bf16 v[116:119], a[212:215], a[44:47], v[116:119]
  v_mul_f32 v24, v24, v48
  v_mul_f32 v25, v25, v49
  v_mul_f32 v26, v26, v50
  v_mfma_f32_16x16x32_bf16 v[124:127], a[212:215], a[48:51], v[124:127]
  ds_read_b128 a[36:39], v7 offset:8448
  v_mul_f32 v27, v27, v51
  v_cvt_pk_bf16_f32 v36, v24, v25
  v_mfma_f32_16x16x32_bf16 v[132:135], a[212:215], a[52:55], v[132:135]
  s_addk_i32 s30, 4096
  buffer_load_dwordx4 a[216:219], v13, s[8:11], s30 offen offset:1024 sc1
  v_cvt_pk_bf16_f32 v37, v26, v27
  v_mul_f32 v28, v52, v52
  v_mfma_f32_16x16x32_bf16 v[136:139], a[208:211], a[40:43], v[136:139]
  v_mul_f32 v29, v53, v53
  v_mul_f32 v30, v54, v54
  v_mfma_f32_16x16x32_bf16 v[144:147], a[208:211], a[44:47], v[144:147]
  v_mul_f32 v31, v55, v55
  v_fma_f32 v28, v28, v21, v17
  v_fma_f32 v29, v29, v21, v17
  v_mfma_f32_16x16x32_bf16 v[152:155], a[208:211], a[48:51], v[152:155]
  v_fma_f32 v30, v30, v21, v17
  v_fma_f32 v31, v31, v21, v17
  v_mfma_f32_16x16x32_bf16 v[160:163], a[208:211], a[52:55], v[160:163]
  buffer_load_dwordx4 a[212:215], v13, s[8:11], s30 offen offset:1152 sc1
  v_mul_f32 v28, v28, v52
  v_mul_f32 v29, v29, v53
  v_mfma_f32_16x16x32_bf16 v[140:143], a[204:207], a[40:43], v[140:143]
  v_mul_f32 v30, v30, v54
  v_mul_f32 v31, v31, v55
  v_mfma_f32_16x16x32_bf16 v[148:151], a[204:207], a[44:47], v[148:151]
  v_exp_f32 v28, v28
  v_mfma_f32_16x16x32_bf16 v[156:159], a[204:207], a[48:51], v[156:159]
  v_exp_f32 v29, v29
  v_mfma_f32_16x16x32_bf16 v[164:167], a[204:207], a[52:55], v[164:167]
  buffer_load_dwordx4 a[208:211], v13, s[8:11], s30 offen offset:2048 sc1
  v_exp_f32 v30, v30
  s_waitcnt vmcnt(27) lgkmcnt(0)
  v_mfma_f32_16x16x32_bf16 v[104:107], a[200:203], a[24:27], v[104:107]
  ds_read_b128 a[40:43], v6 offset:10240
  v_exp_f32 v31, v31
  v_add_f32 v28, 1.0, v28
  v_mfma_f32_16x16x32_bf16 v[112:115], a[200:203], a[28:31], v[112:115]
  v_add_f32 v29, 1.0, v29
  v_add_f32 v30, 1.0, v30
  v_mfma_f32_16x16x32_bf16 v[120:123], a[200:203], a[32:35], v[120:123]
  ds_read_b128 a[44:47], v6 offset:10496
  v_add_f32 v31, 1.0, v31
  v_rcp_f32 v28, v28
  v_mfma_f32_16x16x32_bf16 v[128:131], a[200:203], a[36:39], v[128:131]
  buffer_load_dwordx4 a[204:207], v13, s[8:11], s30 offen offset:2176 sc1
  v_rcp_f32 v29, v29
  v_mfma_f32_16x16x32_bf16 v[108:111], a[196:199], a[24:27], v[108:111]
  ds_read_b128 a[48:51], v7 offset:10240
  v_rcp_f32 v30, v30
  v_mfma_f32_16x16x32_bf16 v[116:119], a[196:199], a[28:31], v[116:119]
  v_rcp_f32 v31, v31
  v_mfma_f32_16x16x32_bf16 v[124:127], a[196:199], a[32:35], v[124:127]
  ds_read_b128 a[52:55], v7 offset:10496
  v_mul_f32 v28, v28, v52
  v_mul_f32 v29, v29, v53
  v_mul_f32 v30, v30, v54
  v_mfma_f32_16x16x32_bf16 v[132:135], a[196:199], a[36:39], v[132:135]
  s_addk_i32 s30, 4096
  buffer_load_dwordx4 a[200:203], v13, s[8:11], s30 offen offset:1024 sc1
  v_mul_f32 v31, v31, v55
  v_cvt_pk_bf16_f32 v38, v28, v29
  v_mfma_f32_16x16x32_bf16 v[136:139], a[192:195], a[24:27], v[136:139]
  v_cvt_pk_bf16_f32 v39, v30, v31
  ds_write_b128 v10, v[36:39] offset:256
  v_mfma_f32_16x16x32_bf16 v[144:147], a[192:195], a[28:31], v[144:147]
  v_mul_f32 v24, v56, v56
  v_mul_f32 v25, v57, v57
  v_mfma_f32_16x16x32_bf16 v[152:155], a[192:195], a[32:35], v[152:155]
  v_mul_f32 v26, v58, v58
  v_mul_f32 v27, v59, v59
  v_mfma_f32_16x16x32_bf16 v[160:163], a[192:195], a[36:39], v[160:163]
  buffer_load_dwordx4 a[196:199], v13, s[8:11], s30 offen offset:1152 sc1
  v_fma_f32 v24, v24, v22, v18
  v_fma_f32 v25, v25, v22, v18
  v_fma_f32 v26, v26, v22, v18
  v_mfma_f32_16x16x32_bf16 v[140:143], a[188:191], a[24:27], v[140:143]
  v_fma_f32 v27, v27, v22, v18
  v_mul_f32 v24, v24, v56
  v_mfma_f32_16x16x32_bf16 v[148:151], a[188:191], a[28:31], v[148:151]
  v_mul_f32 v25, v25, v57
  v_mul_f32 v26, v26, v58
  v_mfma_f32_16x16x32_bf16 v[156:159], a[188:191], a[32:35], v[156:159]
  v_mul_f32 v27, v27, v59
  v_exp_f32 v24, v24
  v_mfma_f32_16x16x32_bf16 v[164:167], a[188:191], a[36:39], v[164:167]
  buffer_load_dwordx4 a[192:195], v13, s[8:11], s30 offen offset:2048 sc1
  v_exp_f32 v25, v25
  s_waitcnt vmcnt(27) lgkmcnt(1)
  v_mfma_f32_16x16x32_bf16 v[104:107], a[184:187], a[40:43], v[104:107]
  ds_read_b128 a[24:27], v6 offset:12288
  buffer_load_dwordx4 v[248:251], v3, s[8:11], s60 offen sc1
  v_exp_f32 v26, v26
  v_mfma_f32_16x16x32_bf16 v[112:115], a[184:187], a[44:47], v[112:115]
  v_exp_f32 v27, v27
  v_mfma_f32_16x16x32_bf16 v[120:123], a[184:187], a[48:51], v[120:123]
  ds_read_b128 a[28:31], v6 offset:12544
  v_add_f32 v24, 1.0, v24
  v_add_f32 v25, 1.0, v25
  v_mfma_f32_16x16x32_bf16 v[128:131], a[184:187], a[52:55], v[128:131]
  buffer_load_dwordx4 a[188:191], v13, s[8:11], s30 offen offset:2176 sc1
  v_add_f32 v26, 1.0, v26
  v_add_f32 v27, 1.0, v27
  v_mfma_f32_16x16x32_bf16 v[108:111], a[180:183], a[40:43], v[108:111]
  ds_read_b128 a[32:35], v7 offset:12288
  v_rcp_f32 v24, v24
  v_mfma_f32_16x16x32_bf16 v[116:119], a[180:183], a[44:47], v[116:119]
  v_rcp_f32 v25, v25
  v_rcp_f32 v26, v26
  v_mfma_f32_16x16x32_bf16 v[124:127], a[180:183], a[48:51], v[124:127]
  ds_read_b128 a[36:39], v7 offset:12544
  v_rcp_f32 v27, v27
  v_mfma_f32_16x16x32_bf16 v[132:135], a[180:183], a[52:55], v[132:135]
  s_addk_i32 s30, 4096
  buffer_load_dwordx4 a[184:187], v13, s[8:11], s30 offen offset:1024 sc1
  v_mul_f32 v24, v24, v56
  v_mfma_f32_16x16x32_bf16 v[136:139], a[176:179], a[40:43], v[136:139]
  v_mul_f32 v25, v25, v57
  v_mul_f32 v26, v26, v58
  v_mul_f32 v27, v27, v59
  v_mfma_f32_16x16x32_bf16 v[144:147], a[176:179], a[44:47], v[144:147]
  v_cvt_pk_bf16_f32 v32, v24, v25
  v_cvt_pk_bf16_f32 v33, v26, v27
  v_mfma_f32_16x16x32_bf16 v[152:155], a[176:179], a[48:51], v[152:155]
  v_mul_f32 v28, v60, v60
  v_mul_f32 v29, v61, v61
  v_mfma_f32_16x16x32_bf16 v[160:163], a[176:179], a[52:55], v[160:163]
  buffer_load_dwordx4 a[180:183], v13, s[8:11], s30 offen offset:1152 sc1
  v_mul_f32 v30, v62, v62
  v_mul_f32 v31, v63, v63
  v_mfma_f32_16x16x32_bf16 v[140:143], a[172:175], a[40:43], v[140:143]
  v_fma_f32 v28, v28, v22, v18
  v_fma_f32 v29, v29, v22, v18
  v_fma_f32 v30, v30, v22, v18
  v_mfma_f32_16x16x32_bf16 v[148:151], a[172:175], a[44:47], v[148:151]
  v_fma_f32 v31, v31, v22, v18
  v_mul_f32 v28, v28, v60
  v_mfma_f32_16x16x32_bf16 v[156:159], a[172:175], a[48:51], v[156:159]
  v_mul_f32 v29, v29, v61
  v_mul_f32 v30, v30, v62
  v_mfma_f32_16x16x32_bf16 v[164:167], a[172:175], a[52:55], v[164:167]
  buffer_load_dwordx4 a[176:179], v13, s[8:11], s30 offen offset:2048 sc1
  v_mul_f32 v31, v31, v63
  v_exp_f32 v28, v28
  s_waitcnt vmcnt(28) lgkmcnt(0)
  v_mfma_f32_16x16x32_bf16 v[104:107], a[168:171], a[24:27], v[104:107]
  ds_read_b128 a[40:43], v6 offset:14336
  v_exp_f32 v29, v29
  v_mfma_f32_16x16x32_bf16 v[112:115], a[168:171], a[28:31], v[112:115]
  v_exp_f32 v30, v30
  v_mfma_f32_16x16x32_bf16 v[120:123], a[168:171], a[32:35], v[120:123]
  ds_read_b128 a[44:47], v6 offset:14592
  v_exp_f32 v31, v31
  v_mfma_f32_16x16x32_bf16 v[128:131], a[168:171], a[36:39], v[128:131]
  buffer_load_dwordx4 a[172:175], v13, s[8:11], s30 offen offset:2176 sc1
  v_add_f32 v28, 1.0, v28
  v_add_f32 v29, 1.0, v29
  v_mfma_f32_16x16x32_bf16 v[108:111], a[164:167], a[24:27], v[108:111]
  ds_read_b128 a[48:51], v7 offset:14336
  v_add_f32 v30, 1.0, v30
  v_add_f32 v31, 1.0, v31
  v_mfma_f32_16x16x32_bf16 v[116:119], a[164:167], a[28:31], v[116:119]
  v_rcp_f32 v28, v28
  v_mfma_f32_16x16x32_bf16 v[124:127], a[164:167], a[32:35], v[124:127]
  ds_read_b128 a[52:55], v7 offset:14592
  v_rcp_f32 v29, v29
  v_mfma_f32_16x16x32_bf16 v[132:135], a[164:167], a[36:39], v[132:135]
  s_addk_i32 s30, 4096
  buffer_load_dwordx4 a[168:171], v13, s[8:11], s30 offen offset:1024 sc1
  v_rcp_f32 v30, v30
  v_rcp_f32 v31, v31
  v_mfma_f32_16x16x32_bf16 v[136:139], a[160:163], a[24:27], v[136:139]
  v_mul_f32 v28, v28, v60
  v_mfma_f32_16x16x32_bf16 v[144:147], a[160:163], a[28:31], v[144:147]
  v_mul_f32 v29, v29, v61
  v_mul_f32 v30, v30, v62
  v_mul_f32 v31, v31, v63
  v_mfma_f32_16x16x32_bf16 v[152:155], a[160:163], a[32:35], v[152:155]
  v_cvt_pk_bf16_f32 v34, v28, v29
  v_cvt_pk_bf16_f32 v35, v30, v31
  v_mfma_f32_16x16x32_bf16 v[160:163], a[160:163], a[36:39], v[160:163]
  buffer_load_dwordx4 a[164:167], v13, s[8:11], s30 offen offset:1152 sc1
  ds_write_b128 v11, v[32:35] offset:0
  v_mul_f32 v24, v64, v64
  v_mfma_f32_16x16x32_bf16 v[140:143], a[156:159], a[24:27], v[140:143]
  v_mul_f32 v25, v65, v65
  v_mul_f32 v26, v66, v66
  v_mfma_f32_16x16x32_bf16 v[148:151], a[156:159], a[28:31], v[148:151]
  v_mul_f32 v27, v67, v67
  v_fma_f32 v24, v24, v23, v19
  v_fma_f32 v25, v25, v23, v19
  v_mfma_f32_16x16x32_bf16 v[156:159], a[156:159], a[32:35], v[156:159]
  v_fma_f32 v26, v26, v23, v19
  v_fma_f32 v27, v27, v23, v19
  v_mfma_f32_16x16x32_bf16 v[164:167], a[156:159], a[36:39], v[164:167]
  buffer_load_dwordx4 a[160:163], v13, s[8:11], s30 offen offset:2048 sc1
  v_mul_f32 v24, v24, v64
  v_mul_f32 v25, v25, v65
  s_waitcnt vmcnt(28) lgkmcnt(1)
  v_mfma_f32_16x16x32_bf16 v[104:107], a[152:155], a[40:43], v[104:107]
  ds_read_b128 a[24:27], v6 offset:16384
  v_mul_f32 v26, v26, v66
  v_mul_f32 v27, v27, v67
  v_mfma_f32_16x16x32_bf16 v[112:115], a[152:155], a[44:47], v[112:115]
  v_exp_f32 v24, v24
  v_mfma_f32_16x16x32_bf16 v[120:123], a[152:155], a[48:51], v[120:123]
  ds_read_b128 a[28:31], v6 offset:16640
  v_exp_f32 v25, v25
  v_mfma_f32_16x16x32_bf16 v[128:131], a[152:155], a[52:55], v[128:131]
  buffer_load_dwordx4 a[156:159], v13, s[8:11], s30 offen offset:2176 sc1
  v_exp_f32 v26, v26
  v_mfma_f32_16x16x32_bf16 v[108:111], a[148:151], a[40:43], v[108:111]
  ds_read_b128 a[32:35], v7 offset:16384
  v_exp_f32 v27, v27
  v_add_f32 v24, 1.0, v24
  v_mfma_f32_16x16x32_bf16 v[116:119], a[148:151], a[44:47], v[116:119]
  v_add_f32 v25, 1.0, v25
  v_add_f32 v26, 1.0, v26
  v_mfma_f32_16x16x32_bf16 v[124:127], a[148:151], a[48:51], v[124:127]
  ds_read_b128 a[36:39], v7 offset:16640
  v_add_f32 v27, 1.0, v27
  v_rcp_f32 v24, v24
  v_mfma_f32_16x16x32_bf16 v[132:135], a[148:151], a[52:55], v[132:135]
  s_addk_i32 s30, 4096
  buffer_load_dwordx4 a[152:155], v13, s[8:11], s30 offen offset:1024 sc1
  v_rcp_f32 v25, v25
  v_mfma_f32_16x16x32_bf16 v[136:139], a[144:147], a[40:43], v[136:139]
  v_rcp_f32 v26, v26
  v_mfma_f32_16x16x32_bf16 v[144:147], a[144:147], a[44:47], v[144:147]
  v_rcp_f32 v27, v27
  v_mfma_f32_16x16x32_bf16 v[152:155], a[144:147], a[48:51], v[152:155]
  v_mul_f32 v24, v24, v64
  v_mul_f32 v25, v25, v65
  v_mul_f32 v26, v26, v66
  v_mfma_f32_16x16x32_bf16 v[160:163], a[144:147], a[52:55], v[160:163]
  buffer_load_dwordx4 a[148:151], v13, s[8:11], s30 offen offset:1152 sc1
  v_mul_f32 v27, v27, v67
  v_cvt_pk_bf16_f32 v36, v24, v25
  v_mfma_f32_16x16x32_bf16 v[140:143], a[140:143], a[40:43], v[140:143]
  v_cvt_pk_bf16_f32 v37, v26, v27
  v_mul_f32 v28, v68, v68
  v_mfma_f32_16x16x32_bf16 v[148:151], a[140:143], a[44:47], v[148:151]
  v_mul_f32 v29, v69, v69
  v_mul_f32 v30, v70, v70
  v_mfma_f32_16x16x32_bf16 v[156:159], a[140:143], a[48:51], v[156:159]
  v_mul_f32 v31, v71, v71
  v_fma_f32 v28, v28, v23, v19
  v_fma_f32 v29, v29, v23, v19
  v_mfma_f32_16x16x32_bf16 v[164:167], a[140:143], a[52:55], v[164:167]
  buffer_load_dwordx4 a[144:147], v13, s[8:11], s30 offen offset:2048 sc1
  v_fma_f32 v30, v30, v23, v19
  v_fma_f32 v31, v31, v23, v19
  s_waitcnt vmcnt(28) lgkmcnt(0)
  v_mfma_f32_16x16x32_bf16 v[104:107], a[136:139], a[24:27], v[104:107]
  ds_read_b128 a[40:43], v6 offset:18432
  v_mul_f32 v28, v28, v68
  v_mul_f32 v29, v29, v69
  v_mfma_f32_16x16x32_bf16 v[112:115], a[136:139], a[28:31], v[112:115]
  v_mul_f32 v30, v30, v70
  v_mul_f32 v31, v31, v71
  v_mfma_f32_16x16x32_bf16 v[120:123], a[136:139], a[32:35], v[120:123]
  ds_read_b128 a[44:47], v6 offset:18688
  v_exp_f32 v28, v28
  v_mfma_f32_16x16x32_bf16 v[128:131], a[136:139], a[36:39], v[128:131]
  buffer_load_dwordx4 a[140:143], v13, s[8:11], s30 offen offset:2176 sc1
  v_exp_f32 v29, v29
  v_mfma_f32_16x16x32_bf16 v[108:111], a[132:135], a[24:27], v[108:111]
  ds_read_b128 a[48:51], v7 offset:18432
  v_exp_f32 v30, v30
  v_mfma_f32_16x16x32_bf16 v[116:119], a[132:135], a[28:31], v[116:119]
  v_exp_f32 v31, v31
  v_add_f32 v28, 1.0, v28
  v_mfma_f32_16x16x32_bf16 v[124:127], a[132:135], a[32:35], v[124:127]
  ds_read_b128 a[52:55], v7 offset:18688
  v_add_f32 v29, 1.0, v29
  v_add_f32 v30, 1.0, v30
  v_mfma_f32_16x16x32_bf16 v[132:135], a[132:135], a[36:39], v[132:135]
  s_addk_i32 s30, 4096
  buffer_load_dwordx4 a[136:139], v13, s[8:11], s30 offen offset:1024 sc1
  v_add_f32 v31, 1.0, v31
  v_rcp_f32 v28, v28
  v_mfma_f32_16x16x32_bf16 v[136:139], a[128:131], a[24:27], v[136:139]
  v_rcp_f32 v29, v29
  v_mfma_f32_16x16x32_bf16 v[144:147], a[128:131], a[28:31], v[144:147]
  v_rcp_f32 v30, v30
  v_mfma_f32_16x16x32_bf16 v[152:155], a[128:131], a[32:35], v[152:155]
  v_rcp_f32 v31, v31
  v_mfma_f32_16x16x32_bf16 v[160:163], a[128:131], a[36:39], v[160:163]
  buffer_load_dwordx4 a[132:135], v13, s[8:11], s30 offen offset:1152 sc1
  v_mul_f32 v28, v28, v68
  v_mul_f32 v29, v29, v69
  v_mul_f32 v30, v30, v70
  v_mfma_f32_16x16x32_bf16 v[140:143], a[252:255], a[24:27], v[140:143]
  v_mul_f32 v31, v31, v71
  v_cvt_pk_bf16_f32 v38, v28, v29
  v_mfma_f32_16x16x32_bf16 v[148:151], a[252:255], a[28:31], v[148:151]
  v_cvt_pk_bf16_f32 v39, v30, v31
  ds_write_b128 v11, v[36:39] offset:256
  v_mfma_f32_16x16x32_bf16 v[156:159], a[252:255], a[32:35], v[156:159]
  v_mul_f32 v24, v72, v72
  v_mul_f32 v25, v73, v73
  v_mfma_f32_16x16x32_bf16 v[164:167], a[252:255], a[36:39], v[164:167]
  buffer_load_dwordx4 a[128:131], v13, s[8:11], s30 offen offset:2048 sc1
  v_mul_f32 v26, v74, v74
  v_mul_f32 v27, v75, v75
  s_waitcnt vmcnt(28) lgkmcnt(1)
  v_mfma_f32_16x16x32_bf16 v[104:107], a[248:251], a[40:43], v[104:107]
  ds_read_b128 a[24:27], v6 offset:20480
  v_fma_f32 v24, v24, v20, v16
  v_fma_f32 v25, v25, v20, v16
  v_fma_f32 v26, v26, v20, v16
  v_mfma_f32_16x16x32_bf16 v[112:115], a[248:251], a[44:47], v[112:115]
  v_fma_f32 v27, v27, v20, v16
  v_mul_f32 v24, v24, v72
  v_mfma_f32_16x16x32_bf16 v[120:123], a[248:251], a[48:51], v[120:123]
  ds_read_b128 a[28:31], v6 offset:20736
  v_mul_f32 v25, v25, v73
  v_mul_f32 v26, v26, v74
  v_mfma_f32_16x16x32_bf16 v[128:131], a[248:251], a[52:55], v[128:131]
  buffer_load_dwordx4 a[252:255], v13, s[8:11], s30 offen offset:2176 sc1
  v_mul_f32 v27, v27, v75
  v_exp_f32 v24, v24
  v_mfma_f32_16x16x32_bf16 v[108:111], a[244:247], a[40:43], v[108:111]
  ds_read_b128 a[32:35], v7 offset:20480
  s_waitcnt vmcnt(17)
  v_xor_b32 v248, s3, v248
  v_xor_b32 v249, s3, v249
  v_exp_f32 v25, v25
  v_mfma_f32_16x16x32_bf16 v[116:119], a[244:247], a[44:47], v[116:119]
  v_xor_b32 v250, s3, v250
  v_xor_b32 v251, s3, v251
  v_exp_f32 v26, v26
  v_mfma_f32_16x16x32_bf16 v[124:127], a[244:247], a[48:51], v[124:127]
  ds_read_b128 a[36:39], v7 offset:20736
  v_or3_b32 v248, v248, v249, v250
  v_or_b32 v248, v248, v251
  v_exp_f32 v27, v27
  v_mfma_f32_16x16x32_bf16 v[132:135], a[244:247], a[52:55], v[132:135]
  s_addk_i32 s30, 4096
  buffer_load_dwordx4 a[248:251], v13, s[8:11], s30 offen offset:1024 sc1
  v_cmp_ne_u32 vcc, 0, v248
  v_add_f32 v24, 1.0, v24
  v_add_f32 v25, 1.0, v25
  v_mfma_f32_16x16x32_bf16 v[136:139], a[240:243], a[40:43], v[136:139]
  v_add_f32 v26, 1.0, v26
  v_add_f32 v27, 1.0, v27
  v_mfma_f32_16x16x32_bf16 v[144:147], a[240:243], a[44:47], v[144:147]
  s_cbranch_vccnz L_f4_w
L_f4_k:
  v_rcp_f32 v24, v24
  v_mfma_f32_16x16x32_bf16 v[152:155], a[240:243], a[48:51], v[152:155]
  v_rcp_f32 v25, v25
  v_rcp_f32 v26, v26
  v_mfma_f32_16x16x32_bf16 v[160:163], a[240:243], a[52:55], v[160:163]
  buffer_load_dwordx4 a[244:247], v13, s[8:11], s30 offen offset:1152 sc1
  v_rcp_f32 v27, v27
  v_mfma_f32_16x16x32_bf16 v[140:143], a[236:239], a[40:43], v[140:143]
  v_mul_f32 v24, v24, v72
  v_mfma_f32_16x16x32_bf16 v[148:151], a[236:239], a[44:47], v[148:151]
  v_mul_f32 v25, v25, v73
  v_mul_f32 v26, v26, v74
  v_mul_f32 v27, v27, v75
  v_mfma_f32_16x16x32_bf16 v[156:159], a[236:239], a[48:51], v[156:159]
  v_cvt_pk_bf16_f32 v32, v24, v25
  v_cvt_pk_bf16_f32 v33, v26, v27
  v_mfma_f32_16x16x32_bf16 v[164:167], a[236:239], a[52:55], v[164:167]
  buffer_load_dwordx4 a[240:243], v13, s[8:11], s30 offen offset:2048 sc1
  v_mul_f32 v28, v76, v76
  v_mul_f32 v29, v77, v77
  s_waitcnt lgkmcnt(0)
  v_mfma_f32_16x16x32_bf16 v[104:107], a[232:235], a[24:27], v[104:107]
  ds_read_b128 a[40:43], v6 offset:22528
  v_mul_f32 v30, v78, v78
  v_mul_f32 v31, v79, v79
  v_mfma_f32_16x16x32_bf16 v[112:115], a[232:235], a[28:31], v[112:115]
  v_fma_f32 v28, v28, v20, v16
  v_fma_f32 v29, v29, v20, v16
  v_fma_f32 v30, v30, v20, v16
  v_mfma_f32_16x16x32_bf16 v[120:123], a[232:235], a[32:35], v[120:123]
  ds_read_b128 a[44:47], v6 offset:22784
  v_fma_f32 v31, v31, v20, v16
  v_mul_f32 v28, v28, v76
  v_mfma_f32_16x16x32_bf16 v[128:131], a[232:235], a[36:39], v[128:131]
  buffer_load_dwordx4 a[236:239], v13, s[8:11], s30 offen offset:2176 sc1
  v_mul_f32 v29, v29, v77
  v_mul_f32 v30, v30, v78
  v_mfma_f32_16x16x32_bf16 v[108:111], a[228:231], a[24:27], v[108:111]
  ds_read_b128 a[48:51], v7 offset:22528
  v_mul_f32 v31, v31, v79
  v_exp_f32 v28, v28
  v_mfma_f32_16x16x32_bf16 v[116:119], a[228:231], a[28:31], v[116:119]
  v_exp_f32 v29, v29
  v_mfma_f32_16x16x32_bf16 v[124:127], a[228:231], a[32:35], v[124:127]
  ds_read_b128 a[52:55], v7 offset:22784
  v_exp_f32 v30, v30
  v_mfma_f32_16x16x32_bf16 v[132:135], a[228:231], a[36:39], v[132:135]
  s_addk_i32 s30, 4096
  buffer_load_dwordx2 a[232:233], v15, s[8:11], s30 offen offset:1024 sc1
  buffer_load_dwordx2 a[234:235], v15, s[8:11], s30 offen offset:1152 sc1
  v_exp_f32 v31, v31
  v_mfma_f32_16x16x32_bf16 v[136:139], a[224:227], a[24:27], v[136:139]
  v_add_f32 v28, 1.0, v28
  v_add_f32 v29, 1.0, v29
  v_mfma_f32_16x16x32_bf16 v[144:147], a[224:227], a[28:31], v[144:147]
  v_add_f32 v30, 1.0, v30
  v_add_f32 v31, 1.0, v31
  v_mfma_f32_16x16x32_bf16 v[152:155], a[224:227], a[32:35], v[152:155]
  v_rcp_f32 v28, v28
  v_mfma_f32_16x16x32_bf16 v[160:163], a[224:227], a[36:39], v[160:163]
  buffer_load_dwordx2 a[228:229], v15, s[8:11], s30 offen offset:2048 sc1
  buffer_load_dwordx2 a[230:231], v15, s[8:11], s30 offen offset:2176 sc1
  v_rcp_f32 v29, v29
  v_mfma_f32_16x16x32_bf16 v[140:143], a[220:223], a[24:27], v[140:143]
  v_rcp_f32 v30, v30
  v_rcp_f32 v31, v31
  v_mfma_f32_16x16x32_bf16 v[148:151], a[220:223], a[28:31], v[148:151]
  v_mul_f32 v28, v28, v76
  v_mfma_f32_16x16x32_bf16 v[156:159], a[220:223], a[32:35], v[156:159]
  v_mul_f32 v29, v29, v77
  v_mul_f32 v30, v30, v78
  v_mul_f32 v31, v31, v79
  v_mfma_f32_16x16x32_bf16 v[164:167], a[220:223], a[36:39], v[164:167]
  s_mov_b32 exec_lo, 0
  v_add_u32 v13, 3072, v13
  s_mov_b32 exec_lo, -1
  buffer_load_dwordx4 a[224:227], v13, s[8:11], s30 offen offset:3072 sc1
  v_cvt_pk_bf16_f32 v34, v28, v29
  v_cvt_pk_bf16_f32 v35, v30, v31
  s_waitcnt lgkmcnt(0)
  v_mfma_f32_16x16x32_bf16 v[104:107], a[216:219], a[40:43], v[104:107]
  ds_read_b128 a[24:27], v6 offset:24576
  ds_write_b128 v10, v[32:35] offset:8192
  v_mul_f32 v24, v80, v80
  v_mfma_f32_16x16x32_bf16 v[112:115], a[216:219], a[44:47], v[112:115]
  v_mul_f32 v25, v81, v81
  v_mul_f32 v26, v82, v82
  v_mfma_f32_16x16x32_bf16 v[120:123], a[216:219], a[48:51], v[120:123]
  ds_read_b128 a[28:31], v6 offset:24832
  v_mul_f32 v27, v83, v83
  v_fma_f32 v24, v24, v21, v17
  v_fma_f32 v25, v25, v21, v17
  v_mfma_f32_16x16x32_bf16 v[128:131], a[216:219], a[52:55], v[128:131]
  buffer_load_dwordx4 a[220:223], v13, s[8:11], s30 offen offset:3200 sc1
  v_fma_f32 v26, v26, v21, v17
  v_fma_f32 v27, v27, v21, v17
  v_mfma_f32_16x16x32_bf16 v[108:111], a[212:215], a[40:43], v[108:111]
  ds_read_b128 a[32:35], v7 offset:24576
  v_mul_f32 v24, v24, v80
  v_mul_f32 v25, v25, v81
  v_mfma_f32_16x16x32_bf16 v[116:119], a[212:215], a[44:47], v[116:119]
  v_mul_f32 v26, v26, v82
  v_mul_f32 v27, v27, v83
  v_mfma_f32_16x16x32_bf16 v[124:127], a[212:215], a[48:51], v[124:127]
  ds_read_b128 a[36:39], v7 offset:24832
  v_exp_f32 v24, v24
  v_mfma_f32_16x16x32_bf16 v[132:135], a[212:215], a[52:55], v[132:135]
  s_addk_i32 s30, 4096
  buffer_load_dwordx4 a[216:219], v13, s[8:11], s30 offen offset:0 sc1
  v_exp_f32 v25, v25
  v_mfma_f32_16x16x32_bf16 v[136:139], a[208:211], a[40:43], v[136:139]
  v_exp_f32 v26, v26
  v_mfma_f32_16x16x32_bf16 v[144:147], a[208:211], a[44:47], v[144:147]
  v_exp_f32 v27, v27
  v_add_f32 v24, 1.0, v24
  v_mfma_f32_16x16x32_bf16 v[152:155], a[208:211], a[48:51], v[152:155]
  v_add_f32 v25, 1.0, v25
  v_add_f32 v26, 1.0, v26
  v_mfma_f32_16x16x32_bf16 v[160:163], a[208:211], a[52:55], v[160:163]
  buffer_load_dwordx4 a[212:215], v13, s[8:11], s30 offen offset:128 sc1
  v_add_f32 v27, 1.0, v27
  v_rcp_f32 v24, v24
  v_mfma_f32_16x16x32_bf16 v[140:143], a[204:207], a[40:43], v[140:143]
  v_rcp_f32 v25, v25
  v_mfma_f32_16x16x32_bf16 v[148:151], a[204:207], a[44:47], v[148:151]
  v_rcp_f32 v26, v26
  v_mfma_f32_16x16x32_bf16 v[156:159], a[204:207], a[48:51], v[156:159]
  v_rcp_f32 v27, v27
  v_mfma_f32_16x16x32_bf16 v[164:167], a[204:207], a[52:55], v[164:167]
  buffer_load_dwordx4 a[208:211], v13, s[8:11], s30 offen offset:1024 sc1
  v_mul_f32 v24, v24, v80
  v_mul_f32 v25, v25, v81
  v_mul_f32 v26, v26, v82
  s_waitcnt vmcnt(29) lgkmcnt(0)
  v_mfma_f32_16x16x32_bf16 v[104:107], a[200:203], a[24:27], v[104:107]
  ds_read_b128 a[40:43], v6 offset:26624
  v_mul_f32 v27, v27, v83
  v_cvt_pk_bf16_f32 v36, v24, v25
  v_mfma_f32_16x16x32_bf16 v[112:115], a[200:203], a[28:31], v[112:115]
  v_cvt_pk_bf16_f32 v37, v26, v27
  v_mul_f32 v28, v84, v84
  v_mfma_f32_16x16x32_bf16 v[120:123], a[200:203], a[32:35], v[120:123]
  ds_read_b128 a[44:47], v6 offset:26880
  v_mul_f32 v29, v85, v85
  v_mul_f32 v30, v86, v86
  v_mfma_f32_16x16x32_bf16 v[128:131], a[200:203], a[36:39], v[128:131]
  buffer_load_dwordx4 a[204:207], v13, s[8:11], s30 offen offset:1152 sc1
  v_mul_f32 v31, v87, v87
  v_fma_f32 v28, v28, v21, v17
  v_fma_f32 v29, v29, v21, v17
  v_mfma_f32_16x16x32_bf16 v[108:111], a[196:199], a[24:27], v[108:111]
  ds_read_b128 a[48:51], v7 offset:26624
  v_fma_f32 v30, v30, v21, v17
  v_fma_f32 v31, v31, v21, v17
  v_mfma_f32_16x16x32_bf16 v[116:119], a[196:199], a[28:31], v[116:119]
  v_mul_f32 v28, v28, v84
  v_mul_f32 v29, v29, v85
  v_mfma_f32_16x16x32_bf16 v[124:127], a[196:199], a[32:35], v[124:127]
  ds_read_b128 a[52:55], v7 offset:26880
  v_mul_f32 v30, v30, v86
  v_mul_f32 v31, v31, v87
  v_mfma_f32_16x16x32_bf16 v[132:135], a[196:199], a[36:39], v[132:135]
  buffer_load_dwordx4 a[200:203], v13, s[8:11], s30 offen offset:2048 sc1
  v_exp_f32 v28, v28
  v_mfma_f32_16x16x32_bf16 v[136:139], a[192:195], a[24:27], v[136:139]
  v_exp_f32 v29, v29
  v_mfma_f32_16x16x32_bf16 v[144:147], a[192:195], a[28:31], v[144:147]
  v_exp_f32 v30, v30
  v_mfma_f32_16x16x32_bf16 v[152:155], a[192:195], a[32:35], v[152:155]
  v_exp_f32 v31, v31
  v_add_f32 v28, 1.0, v28
  v_mfma_f32_16x16x32_bf16 v[160:163], a[192:195], a[36:39], v[160:163]
  buffer_load_dwordx4 a[196:199], v13, s[8:11], s30 offen offset:2176 sc1
  v_add_f32 v29, 1.0, v29
  v_add_f32 v30, 1.0, v30
  v_mfma_f32_16x16x32_bf16 v[140:143], a[188:191], a[24:27], v[140:143]
  v_add_f32 v31, 1.0, v31
  v_rcp_f32 v28, v28
  v_mfma_f32_16x16x32_bf16 v[148:151], a[188:191], a[28:31], v[148:151]
  v_rcp_f32 v29, v29
  v_mfma_f32_16x16x32_bf16 v[156:159], a[188:191], a[32:35], v[156:159]
  v_rcp_f32 v30, v30
  v_mfma_f32_16x16x32_bf16 v[164:167], a[188:191], a[36:39], v[164:167]
  s_add_u32 s64, s64, 77824
  buffer_load_dwordx4 a[192:195], v1, s[8:11], s64 offen offset:3072 sc1
  v_rcp_f32 v31, v31
  s_waitcnt vmcnt(29) lgkmcnt(0)
  v_mfma_f32_16x16x32_bf16 v[104:107], a[184:187], a[40:43], v[104:107]
  ds_read_b128 a[24:27], v6 offset:28672
  v_mul_f32 v28, v28, v84
  v_mul_f32 v29, v29, v85
  v_mul_f32 v30, v30, v86
  v_mfma_f32_16x16x32_bf16 v[112:115], a[184:187], a[44:47], v[112:115]
  v_mul_f32 v31, v31, v87
  v_cvt_pk_bf16_f32 v38, v28, v29
  v_mfma_f32_16x16x32_bf16 v[120:123], a[184:187], a[48:51], v[120:123]
  ds_read_b128 a[28:31], v6 offset:28928
  v_cvt_pk_bf16_f32 v39, v30, v31
  ds_write_b128 v10, v[36:39] offset:8448
  v_mfma_f32_16x16x32_bf16 v[128:131], a[184:187], a[52:55], v[128:131]
  s_addk_i32 s30, 8192
  buffer_load_dwordx4 a[188:191], v13, s[8:11], s30 offen offset:0 sc1
  v_mul_f32 v24, v88, v88
  v_mul_f32 v25, v89, v89
  v_mfma_f32_16x16x32_bf16 v[108:111], a[180:183], a[40:43], v[108:111]
  ds_read_b128 a[32:35], v7 offset:28672
  v_mul_f32 v26, v90, v90
  v_mul_f32 v27, v91, v91
  v_mfma_f32_16x16x32_bf16 v[116:119], a[180:183], a[44:47], v[116:119]
  v_fma_f32 v24, v24, v22, v18
  v_fma_f32 v25, v25, v22, v18
  v_fma_f32 v26, v26, v22, v18
  v_mfma_f32_16x16x32_bf16 v[124:127], a[180:183], a[48:51], v[124:127]
  ds_read_b128 a[36:39], v7 offset:28928
  v_fma_f32 v27, v27, v22, v18
  v_mul_f32 v24, v24, v88
  v_mfma_f32_16x16x32_bf16 v[132:135], a[180:183], a[52:55], v[132:135]
  buffer_load_dwordx4 a[184:187], v13, s[8:11], s30 offen offset:128 sc1
  v_mul_f32 v25, v25, v89
  v_mul_f32 v26, v26, v90
  v_mfma_f32_16x16x32_bf16 v[136:139], a[176:179], a[40:43], v[136:139]
  v_mul_f32 v27, v27, v91
  v_exp_f32 v24, v24
  v_mfma_f32_16x16x32_bf16 v[144:147], a[176:179], a[44:47], v[144:147]
  v_exp_f32 v25, v25
  v_mfma_f32_16x16x32_bf16 v[152:155], a[176:179], a[48:51], v[152:155]
  v_exp_f32 v26, v26
  v_mfma_f32_16x16x32_bf16 v[160:163], a[176:179], a[52:55], v[160:163]
  buffer_load_dwordx4 a[180:183], v13, s[8:11], s30 offen offset:1024 sc1
  v_exp_f32 v27, v27
  v_mfma_f32_16x16x32_bf16 v[140:143], a[172:175], a[40:43], v[140:143]
  v_add_f32 v24, 1.0, v24
  v_add_f32 v25, 1.0, v25
  v_mfma_f32_16x16x32_bf16 v[148:151], a[172:175], a[44:47], v[148:151]
  v_add_f32 v26, 1.0, v26
  v_add_f32 v27, 1.0, v27
  v_mfma_f32_16x16x32_bf16 v[156:159], a[172:175], a[48:51], v[156:159]
  v_rcp_f32 v24, v24
  v_mfma_f32_16x16x32_bf16 v[164:167], a[172:175], a[52:55], v[164:167]
  buffer_load_dwordx4 a[176:179], v13, s[8:11], s30 offen offset:1152 sc1
  v_rcp_f32 v25, v25
  v_rcp_f32 v26, v26
  s_waitcnt vmcnt(29) lgkmcnt(0)
  v_mfma_f32_16x16x32_bf16 v[104:107], a[168:171], a[24:27], v[104:107]
  ds_read_b128 a[40:43], v6 offset:30720
  v_rcp_f32 v27, v27
  v_mfma_f32_16x16x32_bf16 v[112:115], a[168:171], a[28:31], v[112:115]
  v_mul_f32 v24, v24, v88
  v_mfma_f32_16x16x32_bf16 v[120:123], a[168:171], a[32:35], v[120:123]
  ds_read_b128 a[44:47], v6 offset:30976
  v_mul_f32 v25, v25, v89
  v_mul_f32 v26, v26, v90
  v_mul_f32 v27, v27, v91
  v_mfma_f32_16x16x32_bf16 v[128:131], a[168:171], a[36:39], v[128:131]
  buffer_load_dwordx4 a[172:175], v13, s[8:11], s30 offen offset:2048 sc1
  v_cvt_pk_bf16_f32 v32, v24, v25
  v_cvt_pk_bf16_f32 v33, v26, v27
  v_mfma_f32_16x16x32_bf16 v[108:111], a[164:167], a[24:27], v[108:111]
  ds_read_b128 a[48:51], v7 offset:30720
  v_mul_f32 v28, v92, v92
  v_mul_f32 v29, v93, v93
  v_mfma_f32_16x16x32_bf16 v[116:119], a[164:167], a[28:31], v[116:119]
  v_mul_f32 v30, v94, v94
  v_mul_f32 v31, v95, v95
  v_mfma_f32_16x16x32_bf16 v[124:127], a[164:167], a[32:35], v[124:127]
  ds_read_b128 a[52:55], v7 offset:30976
  v_fma_f32 v28, v28, v22, v18
  v_fma_f32 v29, v29, v22, v18
  v_fma_f32 v30, v30, v22, v18
  v_mfma_f32_16x16x32_bf16 v[132:135], a[164:167], a[36:39], v[132:135]
  buffer_load_dwordx4 a[168:171], v13, s[8:11], s30 offen offset:2176 sc1
  v_fma_f32 v31, v31, v22, v18
  v_mul_f32 v28, v28, v92
  v_mfma_f32_16x16x32_bf16 v[136:139], a[160:163], a[24:27], v[136:139]
  v_mul_f32 v29, v29, v93
  v_mul_f32 v30, v30, v94
  v_mfma_f32_16x16x32_bf16 v[144:147], a[160:163], a[28:31], v[144:147]
  v_mul_f32 v31, v31, v95
  v_exp_f32 v28, v28
  v_mfma_f32_16x16x32_bf16 v[152:155], a[160:163], a[32:35], v[152:155]
  v_exp_f32 v29, v29
  v_mfma_f32_16x16x32_bf16 v[160:163], a[160:163], a[36:39], v[160:163]
  buffer_load_dwordx4 a[164:167], v13, s[8:11], s30 offen offset:3072 sc1
  v_exp_f32 v30, v30
  v_mfma_f32_16x16x32_bf16 v[140:143], a[156:159], a[24:27], v[140:143]
  v_exp_f32 v31, v31
  v_mfma_f32_16x16x32_bf16 v[148:151], a[156:159], a[28:31], v[148:151]
  v_add_f32 v28, 1.0, v28
  v_add_f32 v29, 1.0, v29
  v_mfma_f32_16x16x32_bf16 v[156:159], a[156:159], a[32:35], v[156:159]
  v_add_f32 v30, 1.0, v30
  v_add_f32 v31, 1.0, v31
  v_mfma_f32_16x16x32_bf16 v[164:167], a[156:159], a[36:39], v[164:167]
  buffer_load_dwordx4 a[160:163], v13, s[8:11], s30 offen offset:3200 sc1
  v_rcp_f32 v28, v28
  s_waitcnt vmcnt(29) lgkmcnt(0)
  v_mfma_f32_16x16x32_bf16 v[104:107], a[152:155], a[40:43], v[104:107]
  ds_read_b128 a[24:27], v6 offset:32768
  v_rcp_f32 v29, v29
  v_mfma_f32_16x16x32_bf16 v[112:115], a[152:155], a[44:47], v[112:115]
  v_rcp_f32 v30, v30
  v_rcp_f32 v31, v31
  v_mfma_f32_16x16x32_bf16 v[120:123], a[152:155], a[48:51], v[120:123]
  ds_read_b128 a[28:31], v6 offset:33024
  v_mul_f32 v28, v28, v92
  v_mfma_f32_16x16x32_bf16 v[128:131], a[152:155], a[52:55], v[128:131]
  s_addk_i32 s64, 12288
  buffer_load_dwordx4 a[156:159], v1, s[8:11], s64 offen offset:0 sc1
  v_mul_f32 v29, v29, v93
  v_mul_f32 v30, v30, v94
  v_mul_f32 v31, v31, v95
  v_mfma_f32_16x16x32_bf16 v[108:111], a[148:151], a[40:43], v[108:111]
  ds_read_b128 a[32:35], v7 offset:32768
  v_cvt_pk_bf16_f32 v34, v28, v29
  v_cvt_pk_bf16_f32 v35, v30, v31
  v_mfma_f32_16x16x32_bf16 v[116:119], a[148:151], a[44:47], v[116:119]
  ds_write_b128 v11, v[32:35] offset:8192
  v_mul_f32 v24, v96, v96
  v_mfma_f32_16x16x32_bf16 v[124:127], a[148:151], a[48:51], v[124:127]
  ds_read_b128 a[36:39], v7 offset:33024
  v_mul_f32 v25, v97, v97
  v_mul_f32 v26, v98, v98
  v_mfma_f32_16x16x32_bf16 v[132:135], a[148:151], a[52:55], v[132:135]
  s_addk_i32 s30, 8192
  buffer_load_dwordx4 a[152:155], v13, s[8:11], s30 offen offset:1024 sc1
  v_mul_f32 v27, v99, v99
  v_fma_f32 v24, v24, v23, v19
  v_fma_f32 v25, v25, v23, v19
  v_mfma_f32_16x16x32_bf16 v[136:139], a[144:147], a[40:43], v[136:139]
  v_fma_f32 v26, v26, v23, v19
  v_fma_f32 v27, v27, v23, v19
  v_mfma_f32_16x16x32_bf16 v[144:147], a[144:147], a[44:47], v[144:147]
  v_mul_f32 v24, v24, v96
  v_mul_f32 v25, v25, v97
  v_mfma_f32_16x16x32_bf16 v[152:155], a[144:147], a[48:51], v[152:155]
  v_mul_f32 v26, v26, v98
  v_mul_f32 v27, v27, v99
  v_mfma_f32_16x16x32_bf16 v[160:163], a[144:147], a[52:55], v[160:163]
  buffer_load_dwordx4 a[148:151], v13, s[8:11], s30 offen offset:1152 sc1
  v_exp_f32 v24, v24
  v_mfma_f32_16x16x32_bf16 v[140:143], a[140:143], a[40:43], v[140:143]
  v_exp_f32 v25, v25
  v_mfma_f32_16x16x32_bf16 v[148:151], a[140:143], a[44:47], v[148:151]
  v_exp_f32 v26, v26
  v_mfma_f32_16x16x32_bf16 v[156:159], a[140:143], a[48:51], v[156:159]
  v_exp_f32 v27, v27
  v_add_f32 v24, 1.0, v24
  v_mfma_f32_16x16x32_bf16 v[164:167], a[140:143], a[52:55], v[164:167]
  buffer_load_dwordx4 a[144:147], v13, s[8:11], s30 offen offset:2048 sc1
  v_add_f32 v25, 1.0, v25
  v_add_f32 v26, 1.0, v26
  s_waitcnt vmcnt(29) lgkmcnt(0)
  v_mfma_f32_16x16x32_bf16 v[104:107], a[136:139], a[24:27], v[104:107]
  ds_read_b128 a[40:43], v6 offset:34816
  v_add_f32 v27, 1.0, v27
  v_rcp_f32 v24, v24
  v_mfma_f32_16x16x32_bf16 v[112:115], a[136:139], a[28:31], v[112:115]
  v_rcp_f32 v25, v25
  v_mfma_f32_16x16x32_bf16 v[120:123], a[136:139], a[32:35], v[120:123]
  ds_read_b128 a[44:47], v6 offset:35072
  v_rcp_f32 v26, v26
  v_mfma_f32_16x16x32_bf16 v[128:131], a[136:139], a[36:39], v[128:131]
  buffer_load_dwordx4 a[140:143], v13, s[8:11], s30 offen offset:2176 sc1
  v_rcp_f32 v27, v27
  v_mfma_f32_16x16x32_bf16 v[108:111], a[132:135], a[24:27], v[108:111]
  ds_read_b128 a[48:51], v7 offset:34816
  v_mul_f32 v24, v24, v96
  v_mul_f32 v25, v25, v97
  v_mul_f32 v26, v26, v98
  v_mfma_f32_16x16x32_bf16 v[116:119], a[132:135], a[28:31], v[116:119]
  v_mul_f32 v27, v27, v99
  v_cvt_pk_bf16_f32 v36, v24, v25
  v_mfma_f32_16x16x32_bf16 v[124:127], a[132:135], a[32:35], v[124:127]
  ds_read_b128 a[52:55], v7 offset:35072
  v_cvt_pk_bf16_f32 v37, v26, v27
  v_mul_f32 v28, v100, v100
  v_mfma_f32_16x16x32_bf16 v[132:135], a[132:135], a[36:39], v[132:135]
  buffer_load_dwordx4 a[136:139], v13, s[8:11], s30 offen offset:3072 sc1
  v_mul_f32 v29, v101, v101
  v_mul_f32 v30, v102, v102
  v_mfma_f32_16x16x32_bf16 v[136:139], a[128:131], a[24:27], v[136:139]
  v_mul_f32 v31, v103, v103
  v_fma_f32 v28, v28, v23, v19
  v_fma_f32 v29, v29, v23, v19
  v_mfma_f32_16x16x32_bf16 v[144:147], a[128:131], a[28:31], v[144:147]
  v_fma_f32 v30, v30, v23, v19
  v_fma_f32 v31, v31, v23, v19
  v_mfma_f32_16x16x32_bf16 v[152:155], a[128:131], a[32:35], v[152:155]
  v_mul_f32 v28, v28, v100
  v_mul_f32 v29, v29, v101
  v_mfma_f32_16x16x32_bf16 v[160:163], a[128:131], a[36:39], v[160:163]
  buffer_load_dwordx4 a[132:135], v13, s[8:11], s30 offen offset:3200 sc1
  v_mul_f32 v30, v30, v102
  v_mul_f32 v31, v31, v103
  v_mfma_f32_16x16x32_bf16 v[140:143], a[252:255], a[24:27], v[140:143]
  v_exp_f32 v28, v28
  v_mfma_f32_16x16x32_bf16 v[148:151], a[252:255], a[28:31], v[148:151]
  v_exp_f32 v29, v29
  v_mfma_f32_16x16x32_bf16 v[156:159], a[252:255], a[32:35], v[156:159]
  v_exp_f32 v30, v30
  v_mfma_f32_16x16x32_bf16 v[164:167], a[252:255], a[36:39], v[164:167]
  s_addk_i32 s30, 4096
  buffer_load_dwordx4 a[128:131], v13, s[8:11], s30 offen offset:0 sc1
  v_exp_f32 v31, v31
  v_add_f32 v28, 1.0, v28
  s_waitcnt vmcnt(29) lgkmcnt(0)
  v_mfma_f32_16x16x32_bf16 v[104:107], a[248:251], a[40:43], v[104:107]
  v_add_f32 v29, 1.0, v29
  v_add_f32 v30, 1.0, v30
  v_mfma_f32_16x16x32_bf16 v[112:115], a[248:251], a[44:47], v[112:115]
  v_add_f32 v31, 1.0, v31
  v_rcp_f32 v28, v28
  v_mfma_f32_16x16x32_bf16 v[120:123], a[248:251], a[48:51], v[120:123]
  v_rcp_f32 v29, v29
  v_mfma_f32_16x16x32_bf16 v[128:131], a[248:251], a[52:55], v[128:131]
  buffer_load_dwordx4 a[252:255], v13, s[8:11], s30 offen offset:128 sc1
  v_rcp_f32 v30, v30
  v_mfma_f32_16x16x32_bf16 v[108:111], a[244:247], a[40:43], v[108:111]
  v_rcp_f32 v31, v31
  v_mfma_f32_16x16x32_bf16 v[116:119], a[244:247], a[44:47], v[116:119]
  v_mul_f32 v28, v28, v100
  v_mul_f32 v29, v29, v101
  v_mul_f32 v30, v30, v102
  v_mfma_f32_16x16x32_bf16 v[124:127], a[244:247], a[48:51], v[124:127]
  v_mul_f32 v31, v31, v103
  v_cvt_pk_bf16_f32 v38, v28, v29
  v_mfma_f32_16x16x32_bf16 v[132:135], a[244:247], a[52:55], v[132:135]
  s_addk_i32 s64, 8192
  buffer_load_dwordx4 a[248:251], v1, s[8:11], s64 offen offset:1024 sc1
  v_cvt_pk_bf16_f32 v39, v30, v31
  ds_write_b128 v11, v[36:39] offset:8448
  v_mfma_f32_16x16x32_bf16 v[136:139], a[240:243], a[40:43], v[136:139]
  v_mul_f32 v24, v168, v168
  v_mul_f32 v25, v169, v169
  v_mfma_f32_16x16x32_bf16 v[144:147], a[240:243], a[44:47], v[144:147]
  v_mul_f32 v26, v170, v170
  v_mul_f32 v27, v171, v171
  v_mfma_f32_16x16x32_bf16 v[152:155], a[240:243], a[48:51], v[152:155]
  v_fma_f32 v24, v24, v20, v16
  v_fma_f32 v25, v25, v20, v16
  v_mfma_f32_16x16x32_bf16 v[160:163], a[240:243], a[52:55], v[160:163]
  s_addk_i32 s30, 4096
  buffer_load_dwordx4 a[244:247], v13, s[8:11], s30 offen offset:2048 sc1
  v_fma_f32 v26, v26, v20, v16
  v_mfma_f32_16x16x32_bf16 v[140:143], a[236:239], a[40:43], v[140:143]
  v_fma_f32 v27, v27, v20, v16
  v_mul_f32 v24, v24, v168
  v_mfma_f32_16x16x32_bf16 v[148:151], a[236:239], a[44:47], v[148:151]
  v_mul_f32 v25, v25, v169
  v_mul_f32 v26, v26, v170
  v_mfma_f32_16x16x32_bf16 v[156:159], a[236:239], a[48:51], v[156:159]
  v_mul_f32 v27, v27, v171
  v_mfma_f32_16x16x32_bf16 v[164:167], a[236:239], a[52:55], v[164:167]
  buffer_load_dwordx4 a[240:243], v13, s[8:11], s30 offen offset:2176 sc1
  v_exp_f32 v24, v24
  s_waitcnt vmcnt(29)
  v_mfma_f32_16x16x16_bf16 v[104:107], a[232:233], a[16:17], v[104:107]
  s_waitcnt lgkmcnt(0)
  s_barrier
  v_add_u32 v6, 73728, v6
  v_add_u32 v7, 73728, v7
  ds_read_b128 a[24:27], v6 offset:0
  v_exp_f32 v25, v25
  v_mfma_f32_16x16x16_bf16 v[112:115], a[232:233], a[18:19], v[112:115]
  v_exp_f32 v26, v26
  v_mfma_f32_16x16x16_bf16 v[120:123], a[232:233], a[20:21], v[120:123]
  ds_read_b128 a[28:31], v6 offset:256
  v_exp_f32 v27, v27
  v_mfma_f32_16x16x16_bf16 v[128:131], a[232:233], a[22:23], v[128:131]
  v_add_f32 v24, 1.0, v24
  v_add_f32 v25, 1.0, v25
  v_mfma_f32_16x16x16_bf16 v[108:111], a[234:235], a[16:17], v[108:111]
  ds_read_b128 a[32:35], v7 offset:0
  v_add_f32 v26, 1.0, v26
  v_add_f32 v27, 1.0, v27
  v_mfma_f32_16x16x16_bf16 v[116:119], a[234:235], a[18:19], v[116:119]
  v_rcp_f32 v24, v24
  v_mfma_f32_16x16x16_bf16 v[124:127], a[234:235], a[20:21], v[124:127]
  ds_read_b128 a[36:39], v7 offset:256
  v_rcp_f32 v25, v25
  v_mfma_f32_16x16x16_bf16 v[132:135], a[234:235], a[22:23], v[132:135]
  buffer_load_dwordx4 a[236:239], v13, s[8:11], s30 offen offset:3072 sc1
  v_rcp_f32 v26, v26
  v_mfma_f32_16x16x16_bf16 v[136:139], a[228:229], a[16:17], v[136:139]
  v_rcp_f32 v27, v27
  v_mfma_f32_16x16x16_bf16 v[144:147], a[228:229], a[18:19], v[144:147]
  v_mul_f32 v24, v24, v168
  v_mfma_f32_16x16x16_bf16 v[152:155], a[228:229], a[20:21], v[152:155]
  v_mul_f32 v25, v25, v169
  v_mul_f32 v26, v26, v170
  v_mfma_f32_16x16x16_bf16 v[160:163], a[228:229], a[22:23], v[160:163]
  v_mul_f32 v27, v27, v171
  v_cvt_pk_bf16_f32 v32, v24, v25
  v_mfma_f32_16x16x16_bf16 v[140:143], a[230:231], a[16:17], v[140:143]
  v_cvt_pk_bf16_f32 v33, v26, v27
  ds_write_b64 v12, v[32:33] offset:0
  v_mfma_f32_16x16x16_bf16 v[148:151], a[230:231], a[18:19], v[148:151]
  v_mul_f32 v28, v172, v172
  v_mfma_f32_16x16x16_bf16 v[156:159], a[230:231], a[20:21], v[156:159]
  v_mul_f32 v29, v173, v173
  v_mul_f32 v30, v174, v174
  v_mfma_f32_16x16x16_bf16 v[164:167], a[230:231], a[22:23], v[164:167]
  buffer_load_dwordx4 a[232:235], v13, s[8:11], s30 offen offset:3200 sc1
  v_mul_f32 v31, v175, v175
  v_fma_f32 v28, v28, v21, v17
  s_waitcnt vmcnt(26) lgkmcnt(1)
  v_mfma_f32_16x16x32_bf16 v[40:43], a[224:227], a[24:27], 0
  ds_read_b128 a[40:43], v6 offset:2048
  v_fma_f32 v29, v29, v21, v17
  v_fma_f32 v30, v30, v21, v17
  v_mfma_f32_16x16x32_bf16 v[48:51], a[224:227], a[28:31], 0
  v_fma_f32 v31, v31, v21, v17
  v_mul_f32 v28, v28, v172
  v_mfma_f32_16x16x32_bf16 v[56:59], a[224:227], a[32:35], 0
  ds_read_b128 a[44:47], v6 offset:2304
  v_mul_f32 v29, v29, v173
  v_mul_f32 v30, v30, v174
  v_mfma_f32_16x16x32_bf16 v[64:67], a[224:227], a[36:39], 0
  s_addk_i32 s30, 4096
  buffer_load_dwordx4 a[228:231], v13, s[8:11], s30 offen offset:0 sc1
  v_mul_f32 v31, v31, v175
  v_mfma_f32_16x16x32_bf16 v[44:47], a[220:223], a[24:27], 0
  ds_read_b128 a[48:51], v7 offset:2048
  v_exp_f32 v28, v28
  v_mfma_f32_16x16x32_bf16 v[52:55], a[220:223], a[28:31], 0
  v_exp_f32 v29, v29
  v_mfma_f32_16x16x32_bf16 v[60:63], a[220:223], a[32:35], 0
  ds_read_b128 a[52:55], v7 offset:2304
  v_exp_f32 v30, v30
  v_mfma_f32_16x16x32_bf16 v[68:71], a[220:223], a[36:39], 0
  buffer_load_dwordx4 a[224:227], v13, s[8:11], s30 offen offset:128 sc1
  v_exp_f32 v31, v31
  v_mfma_f32_16x16x32_bf16 v[72:75], a[216:219], a[24:27], 0
  v_add_f32 v28, 1.0, v28
  v_add_f32 v29, 1.0, v29
  v_mfma_f32_16x16x32_bf16 v[80:83], a[216:219], a[28:31], 0
  v_add_f32 v30, 1.0, v30
  v_mfma_f32_16x16x32_bf16 v[88:91], a[216:219], a[32:35], 0
  v_add_f32 v31, 1.0, v31
  v_rcp_f32 v28, v28
  v_mfma_f32_16x16x32_bf16 v[96:99], a[216:219], a[36:39], 0
  buffer_load_dwordx4 a[220:223], v13, s[8:11], s30 offen offset:1024 sc1
  v_rcp_f32 v29, v29
  v_mfma_f32_16x16x32_bf16 v[76:79], a[212:215], a[24:27], 0
  v_rcp_f32 v30, v30
  v_mfma_f32_16x16x32_bf16 v[84:87], a[212:215], a[28:31], 0
  v_mfma_f32_16x16x32_bf16 v[92:95], a[212:215], a[32:35], 0
  v_rcp_f32 v31, v31
  v_mul_f32 v28, v28, v172
  v_mfma_f32_16x16x32_bf16 v[100:103], a[212:215], a[36:39], 0
  buffer_load_dwordx4 a[216:219], v13, s[8:11], s30 offen offset:1152 sc1
  v_mul_f32 v29, v29, v173
  v_mul_f32 v30, v30, v174
  v_mfma_f32_16x16x32_bf16 v[184:187], a[208:211], a[24:27], 0
  v_mul_f32 v31, v31, v175
  v_mfma_f32_16x16x32_bf16 v[192:195], a[208:211], a[28:31], 0
  v_cvt_pk_bf16_f32 v36, v28, v29
  v_cvt_pk_bf16_f32 v37, v30, v31
  v_mfma_f32_16x16x32_bf16 v[200:203], a[208:211], a[32:35], 0
  ds_write_b64 v12, v[36:37] offset:256
  v_mul_f32 v24, v176, v176
  v_mfma_f32_16x16x32_bf16 v[208:211], a[208:211], a[36:39], 0
  s_addk_i32 s64, 8192
  buffer_load_dwordx4 a[212:215], v1, s[8:11], s64 offen offset:2048 sc1
  v_mul_f32 v25, v177, v177
  v_mul_f32 v26, v178, v178
  s_waitcnt vmcnt(27)
  v_mfma_f32_16x16x32_bf16 v[188:191], a[204:207], a[24:27], 0
  v_mul_f32 v27, v179, v179
  v_fma_f32 v24, v24, v22, v18
  v_mfma_f32_16x16x32_bf16 v[196:199], a[204:207], a[28:31], 0
  v_fma_f32 v25, v25, v22, v18
  v_fma_f32 v26, v26, v22, v18
  v_mfma_f32_16x16x32_bf16 v[204:207], a[204:207], a[32:35], 0
  v_fma_f32 v27, v27, v22, v18
  v_mfma_f32_16x16x32_bf16 v[212:215], a[204:207], a[36:39], 0
  s_addk_i32 s30, 4096
  buffer_load_dwordx4 a[208:211], v13, s[8:11], s30 offen offset:3072 sc1
  v_mul_f32 v24, v24, v176
  v_mul_f32 v25, v25, v177
  v_mfma_f32_16x16x32_bf16 v[216:219], a[200:203], a[24:27], 0
  v_mul_f32 v26, v26, v178
  v_mul_f32 v27, v27, v179
  v_mfma_f32_16x16x32_bf16 v[224:227], a[200:203], a[28:31], 0
  v_exp_f32 v24, v24
  v_mfma_f32_16x16x32_bf16 v[232:235], a[200:203], a[32:35], 0
  v_exp_f32 v25, v25
  v_mfma_f32_16x16x32_bf16 v[240:243], a[200:203], a[36:39], 0
  buffer_load_dwordx4 a[204:207], v13, s[8:11], s30 offen offset:3200 sc1
  v_exp_f32 v26, v26
  v_mfma_f32_16x16x32_bf16 v[220:223], a[196:199], a[24:27], 0
  v_exp_f32 v27, v27
  v_mfma_f32_16x16x32_bf16 v[228:231], a[196:199], a[28:31], 0
  v_add_f32 v24, 1.0, v24
  v_mfma_f32_16x16x32_bf16 v[236:239], a[196:199], a[32:35], 0
  v_add_f32 v25, 1.0, v25
  v_add_f32 v26, 1.0, v26
  v_mfma_f32_16x16x32_bf16 v[244:247], a[196:199], a[36:39], 0
  s_addk_i32 s30, 4096
  buffer_load_dwordx4 a[200:203], v13, s[8:11], s30 offen offset:0 sc1
  v_add_f32 v27, 1.0, v27
  v_mfma_f32_16x16x32_bf16 a[0:3], a[192:195], a[24:27], 0
  v_rcp_f32 v24, v24
  v_mfma_f32_16x16x32_bf16 a[4:7], a[192:195], a[28:31], 0
  v_rcp_f32 v25, v25
  v_mfma_f32_16x16x32_bf16 a[8:11], a[192:195], a[32:35], 0
  v_rcp_f32 v26, v26
  v_mfma_f32_16x16x32_bf16 a[12:15], a[192:195], a[36:39], 0
  buffer_load_dwordx4 a[196:199], v13, s[8:11], s30 offen offset:128 sc1
  v_rcp_f32 v27, v27
  s_waitcnt vmcnt(26) lgkmcnt(1)
  v_mfma_f32_16x16x32_bf16 v[40:43], a[188:191], a[40:43], v[40:43]
  ds_read_b128 a[24:27], v6 offset:4096
  v_mul_f32 v24, v24, v176
  v_mul_f32 v25, v25, v177
  v_mfma_f32_16x16x32_bf16 v[48:51], a[188:191], a[44:47], v[48:51]
  v_mul_f32 v26, v26, v178
  v_mul_f32 v27, v27, v179
  v_mfma_f32_16x16x32_bf16 v[56:59], a[188:191], a[48:51], v[56:59]
  ds_read_b128 a[28:31], v6 offset:4352
  v_cvt_pk_bf16_f32 v32, v24, v25
  v_cvt_pk_bf16_f32 v33, v26, v27
  v_mfma_f32_16x16x32_bf16 v[64:67], a[188:191], a[52:55], v[64:67]
  buffer_load_dwordx4 a[192:195], v13, s[8:11], s30 offen offset:1024 sc1
  ds_write_b64 v14, v[32:33] offset:0
  v_mul_f32 v28, v180, v180
  v_mfma_f32_16x16x32_bf16 v[44:47], a[184:187], a[40:43], v[44:47]
  ds_read_b128 a[32:35], v7 offset:4096
  v_mul_f32 v29, v181, v181
  v_mfma_f32_16x16x32_bf16 v[52:55], a[184:187], a[44:47], v[52:55]
  v_mul_f32 v30, v182, v182
  v_mul_f32 v31, v183, v183
  v_mfma_f32_16x16x32_bf16 v[60:63], a[184:187], a[48:51], v[60:63]
  ds_read_b128 a[36:39], v7 offset:4352
  v_fma_f32 v28, v28, v23, v19
  v_fma_f32 v29, v29, v23, v19
  v_mfma_f32_16x16x32_bf16 v[68:71], a[184:187], a[52:55], v[68:71]
  buffer_load_dwordx4 a[188:191], v13, s[8:11], s30 offen offset:1152 sc1
  v_fma_f32 v30, v30, v23, v19
  v_fma_f32 v31, v31, v23, v19
  v_mfma_f32_16x16x32_bf16 v[72:75], a[180:183], a[40:43], v[72:75]
  v_mul_f32 v28, v28, v180
  v_mul_f32 v29, v29, v181
  v_mfma_f32_16x16x32_bf16 v[80:83], a[180:183], a[44:47], v[80:83]
  v_mul_f32 v30, v30, v182
  v_mul_f32 v31, v31, v183
  v_mfma_f32_16x16x32_bf16 v[88:91], a[180:183], a[48:51], v[88:91]
  v_exp_f32 v28, v28
  v_mfma_f32_16x16x32_bf16 v[96:99], a[180:183], a[52:55], v[96:99]
  buffer_load_dwordx4 a[184:187], v13, s[8:11], s30 offen offset:2048 sc1
  v_exp_f32 v29, v29
  v_mfma_f32_16x16x32_bf16 v[76:79], a[176:179], a[40:43], v[76:79]
  v_exp_f32 v30, v30
  v_mfma_f32_16x16x32_bf16 v[84:87], a[176:179], a[44:47], v[84:87]
  v_exp_f32 v31, v31
  v_mfma_f32_16x16x32_bf16 v[92:95], a[176:179], a[48:51], v[92:95]
  v_add_f32 v28, 1.0, v28
  v_mfma_f32_16x16x32_bf16 v[100:103], a[176:179], a[52:55], v[100:103]
  buffer_load_dwordx4 a[180:183], v13, s[8:11], s30 offen offset:2176 sc1
  v_add_f32 v29, 1.0, v29
  v_add_f32 v30, 1.0, v30
  v_mfma_f32_16x16x32_bf16 v[184:187], a[172:175], a[40:43], v[184:187]
  v_add_f32 v31, 1.0, v31
  v_mfma_f32_16x16x32_bf16 v[192:195], a[172:175], a[44:47], v[192:195]
  v_rcp_f32 v28, v28
  v_mfma_f32_16x16x32_bf16 v[200:203], a[172:175], a[48:51], v[200:203]
  v_rcp_f32 v29, v29
  v_mfma_f32_16x16x32_bf16 v[208:211], a[172:175], a[52:55], v[208:211]
  s_addk_i32 s64, 8192
  buffer_load_dwordx4 a[176:179], v1, s[8:11], s64 offen offset:3072 sc1
  v_rcp_f32 v30, v30
  s_waitcnt vmcnt(27)
  v_mfma_f32_16x16x32_bf16 v[188:191], a[168:171], a[40:43], v[188:191]
  v_rcp_f32 v31, v31
  v_mfma_f32_16x16x32_bf16 v[196:199], a[168:171], a[44:47], v[196:199]
  v_mul_f32 v28, v28, v180
  v_mul_f32 v29, v29, v181
  v_mfma_f32_16x16x32_bf16 v[204:207], a[168:171], a[48:51], v[204:207]
  v_mul_f32 v30, v30, v182
  v_mul_f32 v31, v31, v183
  v_mfma_f32_16x16x32_bf16 v[212:215], a[168:171], a[52:55], v[212:215]
  s_addk_i32 s30, 8192
  buffer_load_dwordx4 a[172:175], v13, s[8:11], s30 offen offset:0 sc1
  v_cvt_pk_bf16_f32 v36, v28, v29
  v_mfma_f32_16x16x32_bf16 v[216:219], a[164:167], a[40:43], v[216:219]
  v_cvt_pk_bf16_f32 v37, v30, v31
  ds_write_b64 v14, v[36:37] offset:256
  v_mfma_f32_16x16x32_bf16 v[224:227], a[164:167], a[44:47], v[224:227]
  v_mul_f32 v24, v104, v104
  v_mul_f32 v25, v105, v105
  v_mfma_f32_16x16x32_bf16 v[232:235], a[164:167], a[48:51], v[232:235]
  v_mul_f32 v26, v106, v106
  v_mul_f32 v27, v107, v107
  v_mfma_f32_16x16x32_bf16 v[240:243], a[164:167], a[52:55], v[240:243]
  buffer_load_dwordx4 a[168:171], v13, s[8:11], s30 offen offset:128 sc1
  v_fma_f32 v24, v24, v20, v16
  v_fma_f32 v25, v25, v20, v16
  v_mfma_f32_16x16x32_bf16 v[220:223], a[160:163], a[40:43], v[220:223]
  v_fma_f32 v26, v26, v20, v16
  v_fma_f32 v27, v27, v20, v16
  v_mfma_f32_16x16x32_bf16 v[228:231], a[160:163], a[44:47], v[228:231]
  v_mul_f32 v24, v24, v104
  v_mfma_f32_16x16x32_bf16 v[236:239], a[160:163], a[48:51], v[236:239]
  v_mul_f32 v25, v25, v105
  v_mul_f32 v26, v26, v106
  v_mfma_f32_16x16x32_bf16 v[244:247], a[160:163], a[52:55], v[244:247]
  buffer_load_dwordx4 a[164:167], v13, s[8:11], s30 offen offset:1024 sc1
  v_mul_f32 v27, v27, v107
  v_exp_f32 v24, v24
  v_mfma_f32_16x16x32_bf16 a[0:3], a[156:159], a[40:43], a[0:3]
  v_mfma_f32_16x16x32_bf16 a[4:7], a[156:159], a[44:47], a[4:7]
  v_exp_f32 v25, v25
  v_mfma_f32_16x16x32_bf16 a[8:11], a[156:159], a[48:51], a[8:11]
  v_exp_f32 v26, v26
  v_mfma_f32_16x16x32_bf16 a[12:15], a[156:159], a[52:55], a[12:15]
  buffer_load_dwordx4 a[160:163], v13, s[8:11], s30 offen offset:1152 sc1
  v_exp_f32 v27, v27
  s_waitcnt vmcnt(26) lgkmcnt(1)
  v_mfma_f32_16x16x32_bf16 v[40:43], a[152:155], a[24:27], v[40:43]
  ds_read_b128 a[40:43], v6 offset:6144
  v_add_f32 v24, 1.0, v24
  v_add_f32 v25, 1.0, v25
  v_mfma_f32_16x16x32_bf16 v[48:51], a[152:155], a[28:31], v[48:51]
  v_add_f32 v26, 1.0, v26
  v_add_f32 v27, 1.0, v27
  v_mfma_f32_16x16x32_bf16 v[56:59], a[152:155], a[32:35], v[56:59]
  ds_read_b128 a[44:47], v6 offset:6400
  v_rcp_f32 v24, v24
  v_mfma_f32_16x16x32_bf16 v[64:67], a[152:155], a[36:39], v[64:67]
  buffer_load_dwordx4 a[156:159], v13, s[8:11], s30 offen offset:2048 sc1
  v_rcp_f32 v25, v25
  v_mfma_f32_16x16x32_bf16 v[44:47], a[148:151], a[24:27], v[44:47]
  ds_read_b128 a[48:51], v7 offset:6144
  v_rcp_f32 v26, v26
  v_mfma_f32_16x16x32_bf16 v[52:55], a[148:151], a[28:31], v[52:55]
  v_rcp_f32 v27, v27
  v_mfma_f32_16x16x32_bf16 v[60:63], a[148:151], a[32:35], v[60:63]
  ds_read_b128 a[52:55], v7 offset:6400
  v_mul_f32 v24, v24, v104
  v_mfma_f32_16x16x32_bf16 v[68:71], a[148:151], a[36:39], v[68:71]
  buffer_load_dwordx4 a[152:155], v13, s[8:11], s30 offen offset:2176 sc1
  v_mul_f32 v25, v25, v105
  v_mul_f32 v26, v26, v106
  v_mfma_f32_16x16x32_bf16 v[72:75], a[144:147], a[24:27], v[72:75]
  v_mul_f32 v27, v27, v107
  v_cvt_pk_bf16_f32 v32, v24, v25
  v_mfma_f32_16x16x32_bf16 v[80:83], a[144:147], a[28:31], v[80:83]
  v_cvt_pk_bf16_f32 v33, v26, v27
  v_mul_f32 v28, v108, v108
  v_mfma_f32_16x16x32_bf16 v[88:91], a[144:147], a[32:35], v[88:91]
  v_mul_f32 v29, v109, v109
  v_mul_f32 v30, v110, v110
  v_mfma_f32_16x16x32_bf16 v[96:99], a[144:147], a[36:39], v[96:99]
  buffer_load_dwordx4 a[148:151], v13, s[8:11], s30 offen offset:3072 sc1
  v_mul_f32 v31, v111, v111
  v_fma_f32 v28, v28, v20, v16
  v_mfma_f32_16x16x32_bf16 v[76:79], a[140:143], a[24:27], v[76:79]
  v_fma_f32 v29, v29, v20, v16
  v_mfma_f32_16x16x32_bf16 v[84:87], a[140:143], a[28:31], v[84:87]
  v_fma_f32 v30, v30, v20, v16
  v_fma_f32 v31, v31, v20, v16
  v_mfma_f32_16x16x32_bf16 v[92:95], a[140:143], a[32:35], v[92:95]
  v_mul_f32 v28, v28, v108
  v_mul_f32 v29, v29, v109
  v_mfma_f32_16x16x32_bf16 v[100:103], a[140:143], a[36:39], v[100:103]
  buffer_load_dwordx4 a[144:147], v13, s[8:11], s30 offen offset:3200 sc1
  v_mul_f32 v30, v30, v110
  v_mul_f32 v31, v31, v111
  v_mfma_f32_16x16x32_bf16 v[184:187], a[136:139], a[24:27], v[184:187]
  v_exp_f32 v28, v28
  v_mfma_f32_16x16x32_bf16 v[192:195], a[136:139], a[28:31], v[192:195]
  v_exp_f32 v29, v29
  v_mfma_f32_16x16x32_bf16 v[200:203], a[136:139], a[32:35], v[200:203]
  v_exp_f32 v30, v30
  v_mfma_f32_16x16x32_bf16 v[208:211], a[136:139], a[36:39], v[208:211]
  s_addk_i32 s64, 12288
  buffer_load_dwordx4 a[140:143], v1, s[8:11], s64 offen offset:0 sc1
  v_exp_f32 v31, v31
  s_waitcnt vmcnt(27)
  v_mfma_f32_16x16x32_bf16 v[188:191], a[132:135], a[24:27], v[188:191]
  v_add_f32 v28, 1.0, v28
  v_mfma_f32_16x16x32_bf16 v[196:199], a[132:135], a[28:31], v[196:199]
  v_add_f32 v29, 1.0, v29
  v_add_f32 v30, 1.0, v30
  v_mfma_f32_16x16x32_bf16 v[204:207], a[132:135], a[32:35], v[204:207]
  v_add_f32 v31, 1.0, v31
  v_mfma_f32_16x16x32_bf16 v[212:215], a[132:135], a[36:39], v[212:215]
  s_addk_i32 s30, 8192
  buffer_load_dwordx4 a[136:139], v13, s[8:11], s30 offen offset:1024 sc1
  v_rcp_f32 v28, v28
  v_mfma_f32_16x16x32_bf16 v[216:219], a[128:131], a[24:27], v[216:219]
  v_rcp_f32 v29, v29
  v_mfma_f32_16x16x32_bf16 v[224:227], a[128:131], a[28:31], v[224:227]
  v_rcp_f32 v30, v30
  v_mfma_f32_16x16x32_bf16 v[232:235], a[128:131], a[32:35], v[232:235]
  v_rcp_f32 v31, v31
  v_mfma_f32_16x16x32_bf16 v[240:243], a[128:131], a[36:39], v[240:243]
  buffer_load_dwordx4 a[132:135], v13, s[8:11], s30 offen offset:1152 sc1
  v_mul_f32 v28, v28, v108
  v_mul_f32 v29, v29, v109
  v_mfma_f32_16x16x32_bf16 v[220:223], a[252:255], a[24:27], v[220:223]
  v_mul_f32 v30, v30, v110
  v_mul_f32 v31, v31, v111
  v_mfma_f32_16x16x32_bf16 v[228:231], a[252:255], a[28:31], v[228:231]
  v_cvt_pk_bf16_f32 v34, v28, v29
  v_cvt_pk_bf16_f32 v35, v30, v31
  v_mfma_f32_16x16x32_bf16 v[236:239], a[252:255], a[32:35], v[236:239]
  ds_write_b128 v10, v[32:35] offset:16384
  v_mfma_f32_16x16x32_bf16 v[244:247], a[252:255], a[36:39], v[244:247]
  buffer_load_dwordx4 a[128:131], v13, s[8:11], s30 offen offset:2048 sc1
  v_mul_f32 v24, v112, v112
  v_mul_f32 v25, v113, v113
  v_mfma_f32_16x16x32_bf16 a[0:3], a[248:251], a[24:27], a[0:3]
  v_mul_f32 v26, v114, v114
  v_mul_f32 v27, v115, v115
  v_mfma_f32_16x16x32_bf16 a[4:7], a[248:251], a[28:31], a[4:7]
  v_fma_f32 v24, v24, v21, v17
  v_fma_f32 v25, v25, v21, v17
  v_mfma_f32_16x16x32_bf16 a[8:11], a[248:251], a[32:35], a[8:11]
  v_fma_f32 v26, v26, v21, v17
  v_fma_f32 v27, v27, v21, v17
  v_mfma_f32_16x16x32_bf16 a[12:15], a[248:251], a[36:39], a[12:15]
  buffer_load_dwordx4 a[252:255], v13, s[8:11], s30 offen offset:2176 sc1
  v_mul_f32 v24, v24, v112
  v_mul_f32 v25, v25, v113
  s_waitcnt vmcnt(26) lgkmcnt(1)
  v_mfma_f32_16x16x32_bf16 v[40:43], a[244:247], a[40:43], v[40:43]
  ds_read_b128 a[24:27], v6 offset:8192
  v_mul_f32 v26, v26, v114
  v_mfma_f32_16x16x32_bf16 v[48:51], a[244:247], a[44:47], v[48:51]
  v_mul_f32 v27, v27, v115
  v_exp_f32 v24, v24
  v_mfma_f32_16x16x32_bf16 v[56:59], a[244:247], a[48:51], v[56:59]
  ds_read_b128 a[28:31], v6 offset:8448
  v_exp_f32 v25, v25
  v_mfma_f32_16x16x32_bf16 v[64:67], a[244:247], a[52:55], v[64:67]
  buffer_load_dwordx4 a[248:251], v13, s[8:11], s30 offen offset:3072 sc1
  v_mfma_f32_16x16x32_bf16 v[44:47], a[240:243], a[40:43], v[44:47]
  ds_read_b128 a[32:35], v7 offset:8192
  v_exp_f32 v26, v26
  v_mfma_f32_16x16x32_bf16 v[52:55], a[240:243], a[44:47], v[52:55]
  v_exp_f32 v27, v27
  v_add_f32 v24, 1.0, v24
  v_mfma_f32_16x16x32_bf16 v[60:63], a[240:243], a[48:51], v[60:63]
  ds_read_b128 a[36:39], v7 offset:8448
  v_add_f32 v25, 1.0, v25
  v_mfma_f32_16x16x32_bf16 v[68:71], a[240:243], a[52:55], v[68:71]
  buffer_load_dwordx4 a[244:247], v13, s[8:11], s30 offen offset:3200 sc1
  v_add_f32 v26, 1.0, v26
  v_add_f32 v27, 1.0, v27
  v_mfma_f32_16x16x32_bf16 v[72:75], a[236:239], a[40:43], v[72:75]
  v_rcp_f32 v24, v24
  v_mfma_f32_16x16x32_bf16 v[80:83], a[236:239], a[44:47], v[80:83]
  v_rcp_f32 v25, v25
  v_mfma_f32_16x16x32_bf16 v[88:91], a[236:239], a[48:51], v[88:91]
  v_rcp_f32 v26, v26
  v_mfma_f32_16x16x32_bf16 v[96:99], a[236:239], a[52:55], v[96:99]
  s_addk_i32 s30, 4096
  buffer_load_dwordx4 a[240:243], v13, s[8:11], s30 offen offset:0 sc1
  v_rcp_f32 v27, v27
  v_mfma_f32_16x16x32_bf16 v[76:79], a[232:235], a[40:43], v[76:79]
  v_mul_f32 v24, v24, v112
  v_mul_f32 v25, v25, v113
  v_mfma_f32_16x16x32_bf16 v[84:87], a[232:235], a[44:47], v[84:87]
  v_mul_f32 v26, v26, v114
  v_mfma_f32_16x16x32_bf16 v[92:95], a[232:235], a[48:51], v[92:95]
  v_mul_f32 v27, v27, v115
  v_cvt_pk_bf16_f32 v36, v24, v25
  v_mfma_f32_16x16x32_bf16 v[100:103], a[232:235], a[52:55], v[100:103]
  buffer_load_dwordx4 a[236:239], v13, s[8:11], s30 offen offset:128 sc1
  v_cvt_pk_bf16_f32 v37, v26, v27
  v_mul_f32 v28, v116, v116
  v_mfma_f32_16x16x32_bf16 v[184:187], a[228:231], a[40:43], v[184:187]
  v_mul_f32 v29, v117, v117
  v_mul_f32 v30, v118, v118
  v_mfma_f32_16x16x32_bf16 v[192:195], a[228:231], a[44:47], v[192:195]
  v_mul_f32 v31, v119, v119
  v_fma_f32 v28, v28, v21, v17
  v_mfma_f32_16x16x32_bf16 v[200:203], a[228:231], a[48:51], v[200:203]
  v_fma_f32 v29, v29, v21, v17
  v_fma_f32 v30, v30, v21, v17
  v_mfma_f32_16x16x32_bf16 v[208:211], a[228:231], a[52:55], v[208:211]
  s_addk_i32 s64, 8192
  buffer_load_dwordx4 a[232:235], v1, s[8:11], s64 offen offset:1024 sc1
  v_fma_f32 v31, v31, v21, v17
  s_waitcnt vmcnt(27)
  v_mfma_f32_16x16x32_bf16 v[188:191], a[224:227], a[40:43], v[188:191]
  v_mul_f32 v28, v28, v116
  v_mul_f32 v29, v29, v117
  v_mfma_f32_16x16x32_bf16 v[196:199], a[224:227], a[44:47], v[196:199]
  v_mul_f32 v30, v30, v118
  v_mul_f32 v31, v31, v119
  v_mfma_f32_16x16x32_bf16 v[204:207], a[224:227], a[48:51], v[204:207]
  v_exp_f32 v28, v28
  v_mfma_f32_16x16x32_bf16 v[212:215], a[224:227], a[52:55], v[212:215]
  s_addk_i32 s30, 4096
  buffer_load_dwordx4 a[228:231], v13, s[8:11], s30 offen offset:2048 sc1
  v_exp_f32 v29, v29
  v_mfma_f32_16x16x32_bf16 v[216:219], a[220:223], a[40:43], v[216:219]
  v_exp_f32 v30, v30
  v_mfma_f32_16x16x32_bf16 v[224:227], a[220:223], a[44:47], v[224:227]
  v_exp_f32 v31, v31
  v_mfma_f32_16x16x32_bf16 v[232:235], a[220:223], a[48:51], v[232:235]
  v_add_f32 v28, 1.0, v28
  v_mfma_f32_16x16x32_bf16 v[240:243], a[220:223], a[52:55], v[240:243]
  buffer_load_dwordx4 a[224:227], v13, s[8:11], s30 offen offset:2176 sc1
  v_add_f32 v29, 1.0, v29
  v_add_f32 v30, 1.0, v30
  v_mfma_f32_16x16x32_bf16 v[220:223], a[216:219], a[40:43], v[220:223]
  v_add_f32 v31, 1.0, v31
  v_mfma_f32_16x16x32_bf16 v[228:231], a[216:219], a[44:47], v[228:231]
  v_rcp_f32 v28, v28
  v_mfma_f32_16x16x32_bf16 v[236:239], a[216:219], a[48:51], v[236:239]
  v_rcp_f32 v29, v29
  v_mfma_f32_16x16x32_bf16 v[244:247], a[216:219], a[52:55], v[244:247]
  buffer_load_dwordx4 a[220:223], v13, s[8:11], s30 offen offset:3072 sc1
  v_rcp_f32 v30, v30
  v_mfma_f32_16x16x32_bf16 a[0:3], a[212:215], a[40:43], a[0:3]
  v_rcp_f32 v31, v31
  v_mfma_f32_16x16x32_bf16 a[4:7], a[212:215], a[44:47], a[4:7]
  v_mul_f32 v28, v28, v116
  v_mul_f32 v29, v29, v117
  v_mfma_f32_16x16x32_bf16 a[8:11], a[212:215], a[48:51], a[8:11]
  v_mul_f32 v30, v30, v118
  v_mul_f32 v31, v31, v119
  v_mfma_f32_16x16x32_bf16 a[12:15], a[212:215], a[52:55], a[12:15]
  buffer_load_dwordx4 a[216:219], v13, s[8:11], s30 offen offset:3200 sc1
  v_cvt_pk_bf16_f32 v38, v28, v29
  v_cvt_pk_bf16_f32 v39, v30, v31
  s_waitcnt vmcnt(26) lgkmcnt(0)
  v_mfma_f32_16x16x32_bf16 v[40:43], a[208:211], a[24:27], v[40:43]
  ds_read_b128 a[40:43], v6 offset:10240
  ds_write_b128 v10, v[36:39] offset:16640
  v_mul_f32 v24, v120, v120
  v_mfma_f32_16x16x32_bf16 v[48:51], a[208:211], a[28:31], v[48:51]
  v_mul_f32 v25, v121, v121
  v_mfma_f32_16x16x32_bf16 v[56:59], a[208:211], a[32:35], v[56:59]
  ds_read_b128 a[44:47], v6 offset:10496
  v_mul_f32 v26, v122, v122
  v_mul_f32 v27, v123, v123
  v_mfma_f32_16x16x32_bf16 v[64:67], a[208:211], a[36:39], v[64:67]
  s_addk_i32 s30, 4096
  buffer_load_dwordx4 a[212:215], v13, s[8:11], s30 offen offset:0 sc1
  v_fma_f32 v24, v24, v22, v18
  v_fma_f32 v25, v25, v22, v18
  v_mfma_f32_16x16x32_bf16 v[44:47], a[204:207], a[24:27], v[44:47]
  ds_read_b128 a[48:51], v7 offset:10240
  v_fma_f32 v26, v26, v22, v18
  v_fma_f32 v27, v27, v22, v18
  v_mfma_f32_16x16x32_bf16 v[52:55], a[204:207], a[28:31], v[52:55]
  v_mul_f32 v24, v24, v120
  v_mul_f32 v25, v25, v121
  v_mfma_f32_16x16x32_bf16 v[60:63], a[204:207], a[32:35], v[60:63]
  ds_read_b128 a[52:55], v7 offset:10496
  v_mul_f32 v26, v26, v122
  v_mul_f32 v27, v27, v123
  v_mfma_f32_16x16x32_bf16 v[68:71], a[204:207], a[36:39], v[68:71]
  buffer_load_dwordx4 a[208:211], v13, s[8:11], s30 offen offset:128 sc1
  v_exp_f32 v24, v24
  v_mfma_f32_16x16x32_bf16 v[72:75], a[200:203], a[24:27], v[72:75]
  v_exp_f32 v25, v25
  v_mfma_f32_16x16x32_bf16 v[80:83], a[200:203], a[28:31], v[80:83]
  v_exp_f32 v26, v26
  v_mfma_f32_16x16x32_bf16 v[88:91], a[200:203], a[32:35], v[88:91]
  v_exp_f32 v27, v27
  v_mfma_f32_16x16x32_bf16 v[96:99], a[200:203], a[36:39], v[96:99]
  buffer_load_dwordx4 a[204:207], v13, s[8:11], s30 offen offset:1024 sc1
  v_add_f32 v24, 1.0, v24
  v_mfma_f32_16x16x32_bf16 v[76:79], a[196:199], a[24:27], v[76:79]
  v_add_f32 v25, 1.0, v25
  v_add_f32 v26, 1.0, v26
  v_mfma_f32_16x16x32_bf16 v[84:87], a[196:199], a[28:31], v[84:87]
  v_add_f32 v27, 1.0, v27
  v_mfma_f32_16x16x32_bf16 v[92:95], a[196:199], a[32:35], v[92:95]
  v_rcp_f32 v24, v24
  v_mfma_f32_16x16x32_bf16 v[100:103], a[196:199], a[36:39], v[100:103]
  buffer_load_dwordx4 a[200:203], v13, s[8:11], s30 offen offset:1152 sc1
  v_rcp_f32 v25, v25
  v_mfma_f32_16x16x32_bf16 v[184:187], a[192:195], a[24:27], v[184:187]
  v_rcp_f32 v26, v26
  v_mfma_f32_16x16x32_bf16 v[192:195], a[192:195], a[28:31], v[192:195]
  v_rcp_f32 v27, v27
  v_mfma_f32_16x16x32_bf16 v[200:203], a[192:195], a[32:35], v[200:203]
  v_mul_f32 v24, v24, v120
  v_mul_f32 v25, v25, v121
  v_mfma_f32_16x16x32_bf16 v[208:211], a[192:195], a[36:39], v[208:211]
  s_addk_i32 s64, 8192
  buffer_load_dwordx4 a[196:199], v1, s[8:11], s64 offen offset:2048 sc1
  v_mul_f32 v26, v26, v122
  v_mul_f32 v27, v27, v123
  s_waitcnt vmcnt(27)
  v_mfma_f32_16x16x32_bf16 v[188:191], a[188:191], a[24:27], v[188:191]
  v_cvt_pk_bf16_f32 v32, v24, v25
  v_mfma_f32_16x16x32_bf16 v[196:199], a[188:191], a[28:31], v[196:199]
  v_cvt_pk_bf16_f32 v33, v26, v27
  v_mul_f32 v28, v124, v124
  v_mfma_f32_16x16x32_bf16 v[204:207], a[188:191], a[32:35], v[204:207]
  v_mul_f32 v29, v125, v125
  v_mul_f32 v30, v126, v126
  v_mfma_f32_16x16x32_bf16 v[212:215], a[188:191], a[36:39], v[212:215]
  s_addk_i32 s30, 4096
  buffer_load_dwordx4 a[192:195], v13, s[8:11], s30 offen offset:3072 sc1
  v_mul_f32 v31, v127, v127
  v_fma_f32 v28, v28, v22, v18
  v_mfma_f32_16x16x32_bf16 v[216:219], a[184:187], a[24:27], v[216:219]
  v_fma_f32 v29, v29, v22, v18
  v_fma_f32 v30, v30, v22, v18
  v_mfma_f32_16x16x32_bf16 v[224:227], a[184:187], a[28:31], v[224:227]
  v_fma_f32 v31, v31, v22, v18
  v_mul_f32 v28, v28, v124
  v_mfma_f32_16x16x32_bf16 v[232:235], a[184:187], a[32:35], v[232:235]
  v_mul_f32 v29, v29, v125
  v_mfma_f32_16x16x32_bf16 v[240:243], a[184:187], a[36:39], v[240:243]
  buffer_load_dwordx4 a[188:191], v13, s[8:11], s30 offen offset:3200 sc1
  v_mul_f32 v30, v30, v126
  v_mul_f32 v31, v31, v127
  v_mfma_f32_16x16x32_bf16 v[220:223], a[180:183], a[24:27], v[220:223]
  v_exp_f32 v28, v28
  v_mfma_f32_16x16x32_bf16 v[228:231], a[180:183], a[28:31], v[228:231]
  v_exp_f32 v29, v29
  v_mfma_f32_16x16x32_bf16 v[236:239], a[180:183], a[32:35], v[236:239]
  v_exp_f32 v30, v30
  v_mfma_f32_16x16x32_bf16 v[244:247], a[180:183], a[36:39], v[244:247]
  s_addk_i32 s30, 4096
  buffer_load_dwordx4 a[184:187], v13, s[8:11], s30 offen offset:0 sc1
  v_exp_f32 v31, v31
  v_mfma_f32_16x16x32_bf16 a[0:3], a[176:179], a[24:27], a[0:3]
  v_add_f32 v28, 1.0, v28
  v_mfma_f32_16x16x32_bf16 a[4:7], a[176:179], a[28:31], a[4:7]
  v_add_f32 v29, 1.0, v29
  v_add_f32 v30, 1.0, v30
  v_mfma_f32_16x16x32_bf16 a[8:11], a[176:179], a[32:35], a[8:11]
  v_add_f32 v31, 1.0, v31
  v_rcp_f32 v28, v28
  v_mfma_f32_16x16x32_bf16 a[12:15], a[176:179], a[36:39], a[12:15]
  buffer_load_dwordx4 a[180:183], v13, s[8:11], s30 offen offset:128 sc1
  s_waitcnt vmcnt(26) lgkmcnt(0)
  v_mfma_f32_16x16x32_bf16 v[40:43], a[172:175], a[40:43], v[40:43]
  ds_read_b128 a[24:27], v6 offset:12288
  v_rcp_f32 v29, v29
  v_mfma_f32_16x16x32_bf16 v[48:51], a[172:175], a[44:47], v[48:51]
  v_rcp_f32 v30, v30
  v_mfma_f32_16x16x32_bf16 v[56:59], a[172:175], a[48:51], v[56:59]
  ds_read_b128 a[28:31], v6 offset:12544
  v_rcp_f32 v31, v31
  v_mfma_f32_16x16x32_bf16 v[64:67], a[172:175], a[52:55], v[64:67]
  buffer_load_dwordx4 a[176:179], v13, s[8:11], s30 offen offset:1024 sc1
  v_mul_f32 v28, v28, v124
  v_mul_f32 v29, v29, v125
  v_mfma_f32_16x16x32_bf16 v[44:47], a[168:171], a[40:43], v[44:47]
  ds_read_b128 a[32:35], v7 offset:12288
  v_mul_f32 v30, v30, v126
  v_mul_f32 v31, v31, v127
  v_mfma_f32_16x16x32_bf16 v[52:55], a[168:171], a[44:47], v[52:55]
  v_cvt_pk_bf16_f32 v34, v28, v29
  v_cvt_pk_bf16_f32 v35, v30, v31
  v_mfma_f32_16x16x32_bf16 v[60:63], a[168:171], a[48:51], v[60:63]
  ds_read_b128 a[36:39], v7 offset:12544
  ds_write_b128 v11, v[32:35] offset:16384
  v_mul_f32 v24, v128, v128
  v_mfma_f32_16x16x32_bf16 v[68:71], a[168:171], a[52:55], v[68:71]
  buffer_load_dwordx4 a[172:175], v13, s[8:11], s30 offen offset:1152 sc1
  v_mul_f32 v25, v129, v129
  v_mul_f32 v26, v130, v130
  v_mfma_f32_16x16x32_bf16 v[72:75], a[164:167], a[40:43], v[72:75]
  v_mul_f32 v27, v131, v131
  v_fma_f32 v24, v24, v23, v19
  v_mfma_f32_16x16x32_bf16 v[80:83], a[164:167], a[44:47], v[80:83]
  v_fma_f32 v25, v25, v23, v19
  v_mfma_f32_16x16x32_bf16 v[88:91], a[164:167], a[48:51], v[88:91]
  v_fma_f32 v26, v26, v23, v19
  v_fma_f32 v27, v27, v23, v19
  v_mfma_f32_16x16x32_bf16 v[96:99], a[164:167], a[52:55], v[96:99]
  buffer_load_dwordx4 a[168:171], v13, s[8:11], s30 offen offset:2048 sc1
  v_mul_f32 v24, v24, v128
  v_mul_f32 v25, v25, v129
  v_mfma_f32_16x16x32_bf16 v[76:79], a[160:163], a[40:43], v[76:79]
  v_mul_f32 v26, v26, v130
  v_mul_f32 v27, v27, v131
  v_mfma_f32_16x16x32_bf16 v[84:87], a[160:163], a[44:47], v[84:87]
  v_exp_f32 v24, v24
  v_mfma_f32_16x16x32_bf16 v[92:95], a[160:163], a[48:51], v[92:95]
  v_exp_f32 v25, v25
  v_mfma_f32_16x16x32_bf16 v[100:103], a[160:163], a[52:55], v[100:103]
  buffer_load_dwordx4 a[164:167], v13, s[8:11], s30 offen offset:2176 sc1
  v_exp_f32 v26, v26
  v_mfma_f32_16x16x32_bf16 v[184:187], a[156:159], a[40:43], v[184:187]
  v_exp_f32 v27, v27
  v_mfma_f32_16x16x32_bf16 v[192:195], a[156:159], a[44:47], v[192:195]
  v_add_f32 v24, 1.0, v24
  v_mfma_f32_16x16x32_bf16 v[200:203], a[156:159], a[48:51], v[200:203]
  v_add_f32 v25, 1.0, v25
  v_add_f32 v26, 1.0, v26
  v_mfma_f32_16x16x32_bf16 v[208:211], a[156:159], a[52:55], v[208:211]
  s_addk_i32 s64, 8192
  buffer_load_dwordx4 a[160:163], v1, s[8:11], s64 offen offset:3072 sc1
  v_add_f32 v27, 1.0, v27
  s_waitcnt vmcnt(27)
  v_mfma_f32_16x16x32_bf16 v[188:191], a[152:155], a[40:43], v[188:191]
  v_rcp_f32 v24, v24
  v_mfma_f32_16x16x32_bf16 v[196:199], a[152:155], a[44:47], v[196:199]
  v_rcp_f32 v25, v25
  v_mfma_f32_16x16x32_bf16 v[204:207], a[152:155], a[48:51], v[204:207]
  v_rcp_f32 v26, v26
  v_mfma_f32_16x16x32_bf16 v[212:215], a[152:155], a[52:55], v[212:215]
  s_addk_i32 s30, 8192
  buffer_load_dwordx4 a[156:159], v13, s[8:11], s30 offen offset:0 sc1
  v_rcp_f32 v27, v27
  v_mfma_f32_16x16x32_bf16 v[216:219], a[148:151], a[40:43], v[216:219]
  v_mul_f32 v24, v24, v128
  v_mul_f32 v25, v25, v129
  v_mfma_f32_16x16x32_bf16 v[224:227], a[148:151], a[44:47], v[224:227]
  v_mul_f32 v26, v26, v130
  v_mul_f32 v27, v27, v131
  v_mfma_f32_16x16x32_bf16 v[232:235], a[148:151], a[48:51], v[232:235]
  v_cvt_pk_bf16_f32 v36, v24, v25
  v_cvt_pk_bf16_f32 v37, v26, v27
  v_mfma_f32_16x16x32_bf16 v[240:243], a[148:151], a[52:55], v[240:243]
  buffer_load_dwordx4 a[152:155], v13, s[8:11], s30 offen offset:128 sc1
  v_mul_f32 v28, v132, v132
  v_mfma_f32_16x16x32_bf16 v[220:223], a[144:147], a[40:43], v[220:223]
  v_mul_f32 v29, v133, v133
  v_mul_f32 v30, v134, v134
  v_mfma_f32_16x16x32_bf16 v[228:231], a[144:147], a[44:47], v[228:231]
  v_mul_f32 v31, v135, v135
  v_fma_f32 v28, v28, v23, v19
  v_mfma_f32_16x16x32_bf16 v[236:239], a[144:147], a[48:51], v[236:239]
  v_fma_f32 v29, v29, v23, v19
  v_fma_f32 v30, v30, v23, v19
  v_mfma_f32_16x16x32_bf16 v[244:247], a[144:147], a[52:55], v[244:247]
  buffer_load_dwordx4 a[148:151], v13, s[8:11], s30 offen offset:1024 sc1
  v_fma_f32 v31, v31, v23, v19
  v_mul_f32 v28, v28, v132
  v_mfma_f32_16x16x32_bf16 a[0:3], a[140:143], a[40:43], a[0:3]
  v_mul_f32 v29, v29, v133
  v_mul_f32 v30, v30, v134
  v_mfma_f32_16x16x32_bf16 a[4:7], a[140:143], a[44:47], a[4:7]
  v_mul_f32 v31, v31, v135
  v_mfma_f32_16x16x32_bf16 a[8:11], a[140:143], a[48:51], a[8:11]
  v_exp_f32 v28, v28
  v_mfma_f32_16x16x32_bf16 a[12:15], a[140:143], a[52:55], a[12:15]
  buffer_load_dwordx4 a[144:147], v13, s[8:11], s30 offen offset:1152 sc1
  v_exp_f32 v29, v29
  s_waitcnt vmcnt(26) lgkmcnt(1)
  v_mfma_f32_16x16x32_bf16 v[40:43], a[136:139], a[24:27], v[40:43]
  ds_read_b128 a[40:43], v6 offset:14336
  v_exp_f32 v30, v30
  v_mfma_f32_16x16x32_bf16 v[48:51], a[136:139], a[28:31], v[48:51]
  v_exp_f32 v31, v31
  v_mfma_f32_16x16x32_bf16 v[56:59], a[136:139], a[32:35], v[56:59]
  ds_read_b128 a[44:47], v6 offset:14592
  v_add_f32 v28, 1.0, v28
  v_add_f32 v29, 1.0, v29
  v_mfma_f32_16x16x32_bf16 v[64:67], a[136:139], a[36:39], v[64:67]
  buffer_load_dwordx4 a[140:143], v13, s[8:11], s30 offen offset:2048 sc1
  v_add_f32 v30, 1.0, v30
  v_mfma_f32_16x16x32_bf16 v[44:47], a[132:135], a[24:27], v[44:47]
  ds_read_b128 a[48:51], v7 offset:14336
  v_add_f32 v31, 1.0, v31
  v_rcp_f32 v28, v28
  v_mfma_f32_16x16x32_bf16 v[52:55], a[132:135], a[28:31], v[52:55]
  v_rcp_f32 v29, v29
  v_mfma_f32_16x16x32_bf16 v[60:63], a[132:135], a[32:35], v[60:63]
  ds_read_b128 a[52:55], v7 offset:14592
  v_rcp_f32 v30, v30
  v_mfma_f32_16x16x32_bf16 v[68:71], a[132:135], a[36:39], v[68:71]
  buffer_load_dwordx4 a[136:139], v13, s[8:11], s30 offen offset:2176 sc1
  v_mfma_f32_16x16x32_bf16 v[72:75], a[128:131], a[24:27], v[72:75]
  v_rcp_f32 v31, v31
  v_mul_f32 v28, v28, v132
  v_mfma_f32_16x16x32_bf16 v[80:83], a[128:131], a[28:31], v[80:83]
  v_mul_f32 v29, v29, v133
  v_mul_f32 v30, v30, v134
  v_mfma_f32_16x16x32_bf16 v[88:91], a[128:131], a[32:35], v[88:91]
  v_mul_f32 v31, v31, v135
  v_mfma_f32_16x16x32_bf16 v[96:99], a[128:131], a[36:39], v[96:99]
  buffer_load_dwordx4 a[132:135], v13, s[8:11], s30 offen offset:3072 sc1
  v_cvt_pk_bf16_f32 v38, v28, v29
  v_cvt_pk_bf16_f32 v39, v30, v31
  v_mfma_f32_16x16x32_bf16 v[76:79], a[252:255], a[24:27], v[76:79]
  ds_write_b128 v11, v[36:39] offset:16640
  v_mul_f32 v24, v136, v136
  v_mfma_f32_16x16x32_bf16 v[84:87], a[252:255], a[28:31], v[84:87]
  v_mul_f32 v25, v137, v137
  v_mul_f32 v26, v138, v138
  v_mfma_f32_16x16x32_bf16 v[92:95], a[252:255], a[32:35], v[92:95]
  v_mul_f32 v27, v139, v139
  v_fma_f32 v24, v24, v20, v16
  v_mfma_f32_16x16x32_bf16 v[100:103], a[252:255], a[36:39], v[100:103]
  buffer_load_dwordx4 a[128:131], v13, s[8:11], s30 offen offset:3200 sc1
  v_fma_f32 v25, v25, v20, v16
  v_fma_f32 v26, v26, v20, v16
  v_mfma_f32_16x16x32_bf16 v[184:187], a[248:251], a[24:27], v[184:187]
  v_fma_f32 v27, v27, v20, v16
  v_mfma_f32_16x16x32_bf16 v[192:195], a[248:251], a[28:31], v[192:195]
  v_mul_f32 v24, v24, v136
  v_mul_f32 v25, v25, v137
  v_mfma_f32_16x16x32_bf16 v[200:203], a[248:251], a[32:35], v[200:203]
  v_mul_f32 v26, v26, v138
  v_mul_f32 v27, v27, v139
  v_mfma_f32_16x16x32_bf16 v[208:211], a[248:251], a[36:39], v[208:211]
  s_addk_i32 s64, 12288
  buffer_load_dwordx4 a[252:255], v1, s[8:11], s64 offen offset:0 sc1
  v_exp_f32 v24, v24
  s_waitcnt vmcnt(27)
  v_mfma_f32_16x16x32_bf16 v[188:191], a[244:247], a[24:27], v[188:191]
  v_exp_f32 v25, v25
  v_mfma_f32_16x16x32_bf16 v[196:199], a[244:247], a[28:31], v[196:199]
  v_exp_f32 v26, v26
  v_mfma_f32_16x16x32_bf16 v[204:207], a[244:247], a[32:35], v[204:207]
  v_exp_f32 v27, v27
  v_mfma_f32_16x16x32_bf16 v[212:215], a[244:247], a[36:39], v[212:215]
  s_addk_i32 s30, 16384
  s_mov_b32 exec_lo, 0
  v_add_u32 v13, 4294963200, v13
  s_mov_b32 exec_lo, -1
  buffer_load_dwordx4 a[248:251], v13, s[8:11], s30 offen offset:1024 sc1
  v_add_f32 v24, 1.0, v24
  v_mfma_f32_16x16x32_bf16 v[216:219], a[240:243], a[24:27], v[216:219]
  v_add_f32 v25, 1.0, v25
  v_add_f32 v26, 1.0, v26
  v_mfma_f32_16x16x32_bf16 v[224:227], a[240:243], a[28:31], v[224:227]
  v_add_f32 v27, 1.0, v27
  v_mfma_f32_16x16x32_bf16 v[232:235], a[240:243], a[32:35], v[232:235]
  v_rcp_f32 v24, v24
  v_mfma_f32_16x16x32_bf16 v[240:243], a[240:243], a[36:39], v[240:243]
  buffer_load_dwordx4 a[244:247], v13, s[8:11], s30 offen offset:1152 sc1
  v_rcp_f32 v25, v25
  v_mfma_f32_16x16x32_bf16 v[220:223], a[236:239], a[24:27], v[220:223]
  v_rcp_f32 v26, v26
  v_mfma_f32_16x16x32_bf16 v[228:231], a[236:239], a[28:31], v[228:231]
  v_rcp_f32 v27, v27
  v_mfma_f32_16x16x32_bf16 v[236:239], a[236:239], a[32:35], v[236:239]
  v_mul_f32 v24, v24, v136
  v_mul_f32 v25, v25, v137
  v_mfma_f32_16x16x32_bf16 v[244:247], a[236:239], a[36:39], v[244:247]
  s_addk_i32 s30, 16384
  buffer_load_dwordx4 a[240:243], v13, s[8:11], s30 offen offset:1024 sc1
  v_mul_f32 v26, v26, v138
  v_mul_f32 v27, v27, v139
  v_mfma_f32_16x16x32_bf16 a[0:3], a[232:235], a[24:27], a[0:3]
  v_cvt_pk_bf16_f32 v32, v24, v25
  v_cvt_pk_bf16_f32 v33, v26, v27
  v_mfma_f32_16x16x32_bf16 a[4:7], a[232:235], a[28:31], a[4:7]
  v_mul_f32 v28, v140, v140
  v_mul_f32 v29, v141, v141
  v_mfma_f32_16x16x32_bf16 a[8:11], a[232:235], a[32:35], a[8:11]
  v_mul_f32 v30, v142, v142
  v_mfma_f32_16x16x32_bf16 a[12:15], a[232:235], a[36:39], a[12:15]
  buffer_load_dwordx4 a[236:239], v13, s[8:11], s30 offen offset:1152 sc1
  v_mul_f32 v31, v143, v143
  v_fma_f32 v28, v28, v20, v16
  s_waitcnt vmcnt(26) lgkmcnt(1)
  v_mfma_f32_16x16x32_bf16 v[40:43], a[228:231], a[40:43], v[40:43]
  s_barrier
  ds_read_b128 a[24:27], v6 offset:32768
  v_fma_f32 v29, v29, v20, v16
  v_fma_f32 v30, v30, v20, v16
  v_mfma_f32_16x16x32_bf16 v[48:51], a[228:231], a[44:47], v[48:51]
  v_fma_f32 v31, v31, v20, v16
  v_mul_f32 v28, v28, v140
  v_mfma_f32_16x16x32_bf16 v[56:59], a[228:231], a[48:51], v[56:59]
  ds_read_b128 a[28:31], v6 offset:33024
  v_mul_f32 v29, v29, v141
  v_mul_f32 v30, v30, v142
  v_mfma_f32_16x16x32_bf16 v[64:67], a[228:231], a[52:55], v[64:67]
  s_addk_i32 s30, 16384
  buffer_load_dwordx4 a[232:235], v13, s[8:11], s30 offen offset:1024 sc1
  v_mul_f32 v31, v31, v143
  v_mfma_f32_16x16x32_bf16 v[44:47], a[224:227], a[40:43], v[44:47]
  ds_read_b128 a[32:35], v7 offset:32768
  v_exp_f32 v28, v28
  v_mfma_f32_16x16x32_bf16 v[52:55], a[224:227], a[44:47], v[52:55]
  v_exp_f32 v29, v29
  v_mfma_f32_16x16x32_bf16 v[60:63], a[224:227], a[48:51], v[60:63]
  ds_read_b128 a[36:39], v7 offset:33024
  v_exp_f32 v30, v30
  v_mfma_f32_16x16x32_bf16 v[68:71], a[224:227], a[52:55], v[68:71]
  buffer_load_dwordx4 a[228:231], v13, s[8:11], s30 offen offset:1152 sc1
  v_exp_f32 v31, v31
  v_mfma_f32_16x16x32_bf16 v[72:75], a[220:223], a[40:43], v[72:75]
  v_add_f32 v28, 1.0, v28
  v_add_f32 v29, 1.0, v29
  v_mfma_f32_16x16x32_bf16 v[80:83], a[220:223], a[44:47], v[80:83]
  v_add_f32 v30, 1.0, v30
  v_add_f32 v31, 1.0, v31
  v_mfma_f32_16x16x32_bf16 v[88:91], a[220:223], a[48:51], v[88:91]
  v_rcp_f32 v28, v28
  v_mfma_f32_16x16x32_bf16 v[96:99], a[220:223], a[52:55], v[96:99]
  s_addk_i32 s30, 16384
  buffer_load_dwordx4 a[224:227], v13, s[8:11], s30 offen offset:1024 sc1
  v_rcp_f32 v29, v29
  v_mfma_f32_16x16x32_bf16 v[76:79], a[216:219], a[40:43], v[76:79]
  v_rcp_f32 v30, v30
  v_mfma_f32_16x16x32_bf16 v[84:87], a[216:219], a[44:47], v[84:87]
  v_rcp_f32 v31, v31
  v_mfma_f32_16x16x32_bf16 v[92:95], a[216:219], a[48:51], v[92:95]
  v_mul_f32 v28, v28, v140
  v_mfma_f32_16x16x32_bf16 v[100:103], a[216:219], a[52:55], v[100:103]
  buffer_load_dwordx4 a[220:223], v13, s[8:11], s30 offen offset:1152 sc1
  v_mul_f32 v29, v29, v141
  v_mul_f32 v30, v30, v142
  v_mfma_f32_16x16x32_bf16 v[184:187], a[212:215], a[40:43], v[184:187]
  v_mul_f32 v31, v31, v143
  v_cvt_pk_bf16_f32 v34, v28, v29
  v_mfma_f32_16x16x32_bf16 v[192:195], a[212:215], a[44:47], v[192:195]
  v_cvt_pk_bf16_f32 v35, v30, v31
  v_mfma_f32_16x16x32_bf16 v[200:203], a[212:215], a[48:51], v[200:203]
  ds_write_b128 v10, v[32:35] offset:24576
  v_mul_f32 v24, v144, v144
  v_mfma_f32_16x16x32_bf16 v[208:211], a[212:215], a[52:55], v[208:211]
  s_addk_i32 s64, 4096
  buffer_load_dwordx4 a[216:219], v1, s[8:11], s64 offen offset:1024 sc1
  v_mul_f32 v25, v145, v145
  v_mul_f32 v26, v146, v146
  s_waitcnt vmcnt(27)
  v_mfma_f32_16x16x32_bf16 v[188:191], a[208:211], a[40:43], v[188:191]
  v_mul_f32 v27, v147, v147
  v_fma_f32 v24, v24, v21, v17
  v_mfma_f32_16x16x32_bf16 v[196:199], a[208:211], a[44:47], v[196:199]
  v_fma_f32 v25, v25, v21, v17
  v_fma_f32 v26, v26, v21, v17
  v_mfma_f32_16x16x32_bf16 v[204:207], a[208:211], a[48:51], v[204:207]
  v_fma_f32 v27, v27, v21, v17
  v_mul_f32 v24, v24, v144
  v_mfma_f32_16x16x32_bf16 v[212:215], a[208:211], a[52:55], v[212:215]
  s_add_u32 s30, s30, 4294918144
  buffer_load_dwordx4 a[212:215], v13, s[8:11], s30 offen offset:3072 sc1
  v_mul_f32 v25, v25, v145
  v_mfma_f32_16x16x32_bf16 v[216:219], a[204:207], a[40:43], v[216:219]
  v_mul_f32 v26, v26, v146
  v_mul_f32 v27, v27, v147
  v_mfma_f32_16x16x32_bf16 v[224:227], a[204:207], a[44:47], v[224:227]
  v_exp_f32 v24, v24
  v_mfma_f32_16x16x32_bf16 v[232:235], a[204:207], a[48:51], v[232:235]
  v_exp_f32 v25, v25
  v_mfma_f32_16x16x32_bf16 v[240:243], a[204:207], a[52:55], v[240:243]
  buffer_load_dwordx4 a[208:211], v13, s[8:11], s30 offen offset:3200 sc1
  v_exp_f32 v26, v26
  v_mfma_f32_16x16x32_bf16 v[220:223], a[200:203], a[40:43], v[220:223]
  v_exp_f32 v27, v27
  v_mfma_f32_16x16x32_bf16 v[228:231], a[200:203], a[44:47], v[228:231]
  v_add_f32 v24, 1.0, v24
  v_mfma_f32_16x16x32_bf16 v[236:239], a[200:203], a[48:51], v[236:239]
  v_add_f32 v25, 1.0, v25
  v_add_f32 v26, 1.0, v26
  v_mfma_f32_16x16x32_bf16 v[244:247], a[200:203], a[52:55], v[244:247]
  s_addk_i32 s30, 16384
  buffer_load_dwordx4 a[204:207], v13, s[8:11], s30 offen offset:3072 sc1
  v_add_f32 v27, 1.0, v27
  v_rcp_f32 v24, v24
  v_mfma_f32_16x16x32_bf16 a[0:3], a[196:199], a[40:43], a[0:3]
  v_mfma_f32_16x16x32_bf16 a[4:7], a[196:199], a[44:47], a[4:7]
  v_rcp_f32 v25, v25
  v_mfma_f32_16x16x32_bf16 a[8:11], a[196:199], a[48:51], a[8:11]
  v_rcp_f32 v26, v26
  v_mfma_f32_16x16x32_bf16 a[12:15], a[196:199], a[52:55], a[12:15]
  buffer_load_dwordx4 a[200:203], v13, s[8:11], s30 offen offset:3200 sc1
  v_rcp_f32 v27, v27
  s_waitcnt vmcnt(26) lgkmcnt(1)
  v_mfma_f32_16x16x32_bf16 v[40:43], a[192:195], a[24:27], v[40:43]
  ds_read_b128 a[40:43], v6 offset:34816
  v_mul_f32 v24, v24, v144
  v_mul_f32 v25, v25, v145
  v_mfma_f32_16x16x32_bf16 v[48:51], a[192:195], a[28:31], v[48:51]
  v_mul_f32 v26, v26, v146
  v_mul_f32 v27, v27, v147
  v_mfma_f32_16x16x32_bf16 v[56:59], a[192:195], a[32:35], v[56:59]
  ds_read_b128 a[44:47], v6 offset:35072
  v_cvt_pk_bf16_f32 v36, v24, v25
  v_cvt_pk_bf16_f32 v37, v26, v27
  v_mfma_f32_16x16x32_bf16 v[64:67], a[192:195], a[36:39], v[64:67]
  s_addk_i32 s30, 16384
  buffer_load_dwordx4 a[196:199], v13, s[8:11], s30 offen offset:3072 sc1
  v_mul_f32 v28, v148, v148
  v_mul_f32 v29, v149, v149
  v_mfma_f32_16x16x32_bf16 v[44:47], a[188:191], a[24:27], v[44:47]
  ds_read_b128 a[48:51], v7 offset:34816
  v_mul_f32 v30, v150, v150
  v_mul_f32 v31, v151, v151
  v_mfma_f32_16x16x32_bf16 v[52:55], a[188:191], a[28:31], v[52:55]
  v_fma_f32 v28, v28, v21, v17
  v_fma_f32 v29, v29, v21, v17
  v_mfma_f32_16x16x32_bf16 v[60:63], a[188:191], a[32:35], v[60:63]
  ds_read_b128 a[52:55], v7 offset:35072
  v_fma_f32 v30, v30, v21, v17
  v_mfma_f32_16x16x32_bf16 v[68:71], a[188:191], a[36:39], v[68:71]
  buffer_load_dwordx4 a[192:195], v13, s[8:11], s30 offen offset:3200 sc1
  v_fma_f32 v31, v31, v21, v17
  v_mul_f32 v28, v28, v148
  v_mfma_f32_16x16x32_bf16 v[72:75], a[184:187], a[24:27], v[72:75]
  v_mul_f32 v29, v29, v149
  v_mul_f32 v30, v30, v150
  v_mfma_f32_16x16x32_bf16 v[80:83], a[184:187], a[28:31], v[80:83]
  v_mul_f32 v31, v31, v151
  v_mfma_f32_16x16x32_bf16 v[88:91], a[184:187], a[32:35], v[88:91]
  v_exp_f32 v28, v28
  v_mfma_f32_16x16x32_bf16 v[96:99], a[184:187], a[36:39], v[96:99]
  s_addk_i32 s30, 16384
  buffer_load_dwordx4 a[188:191], v13, s[8:11], s30 offen offset:3072 sc1
  v_exp_f32 v29, v29
  v_mfma_f32_16x16x32_bf16 v[76:79], a[180:183], a[24:27], v[76:79]
  v_exp_f32 v30, v30
  v_mfma_f32_16x16x32_bf16 v[84:87], a[180:183], a[28:31], v[84:87]
  v_exp_f32 v31, v31
  v_mfma_f32_16x16x32_bf16 v[92:95], a[180:183], a[32:35], v[92:95]
  v_add_f32 v28, 1.0, v28
  v_add_f32 v29, 1.0, v29
  v_mfma_f32_16x16x32_bf16 v[100:103], a[180:183], a[36:39], v[100:103]
  buffer_load_dwordx4 a[184:187], v13, s[8:11], s30 offen offset:3200 sc1
  v_add_f32 v30, 1.0, v30
  v_add_f32 v31, 1.0, v31
  v_mfma_f32_16x16x32_bf16 v[184:187], a[176:179], a[24:27], v[184:187]
  v_rcp_f32 v28, v28
  v_mfma_f32_16x16x32_bf16 v[192:195], a[176:179], a[28:31], v[192:195]
  v_rcp_f32 v29, v29
  v_mfma_f32_16x16x32_bf16 v[200:203], a[176:179], a[32:35], v[200:203]
  v_rcp_f32 v30, v30
  v_mfma_f32_16x16x32_bf16 v[208:211], a[176:179], a[36:39], v[208:211]
  buffer_load_dwordx4 a[180:183], v1, s[8:11], s64 offen offset:2048 sc1
  v_rcp_f32 v31, v31
  s_waitcnt vmcnt(27)
  v_mfma_f32_16x16x32_bf16 v[188:191], a[172:175], a[24:27], v[188:191]
  v_mul_f32 v28, v28, v148
  v_mfma_f32_16x16x32_bf16 v[196:199], a[172:175], a[28:31], v[196:199]
  v_mul_f32 v29, v29, v149
  v_mul_f32 v30, v30, v150
  v_mfma_f32_16x16x32_bf16 v[204:207], a[172:175], a[32:35], v[204:207]
  v_mul_f32 v31, v31, v151
  v_cvt_pk_bf16_f32 v38, v28, v29
  v_mfma_f32_16x16x32_bf16 v[212:215], a[172:175], a[36:39], v[212:215]
  buffer_load_dwordx4 a[176:179], v1, s[8:11], s64 offen offset:3072 sc1
  v_cvt_pk_bf16_f32 v39, v30, v31
  ds_write_b128 v10, v[36:39] offset:24832
  v_mfma_f32_16x16x32_bf16 v[216:219], a[168:171], a[24:27], v[216:219]
  v_mul_f32 v24, v152, v152
  v_mfma_f32_16x16x32_bf16 v[224:227], a[168:171], a[28:31], v[224:227]
  v_mul_f32 v25, v153, v153
  v_mul_f32 v26, v154, v154
  v_mfma_f32_16x16x32_bf16 v[232:235], a[168:171], a[32:35], v[232:235]
  v_mul_f32 v27, v155, v155
  v_fma_f32 v24, v24, v22, v18
  v_mfma_f32_16x16x32_bf16 v[240:243], a[168:171], a[36:39], v[240:243]
  s_addk_i32 s64, 4096
  buffer_load_dwordx4 a[172:175], v1, s[8:11], s64 offen offset:0 sc1
  v_fma_f32 v25, v25, v22, v18
  v_fma_f32 v26, v26, v22, v18
  v_mfma_f32_16x16x32_bf16 v[220:223], a[164:167], a[24:27], v[220:223]
  v_fma_f32 v27, v27, v22, v18
  v_mul_f32 v24, v24, v152
  v_mfma_f32_16x16x32_bf16 v[228:231], a[164:167], a[28:31], v[228:231]
  v_mul_f32 v25, v25, v153
  v_mul_f32 v26, v26, v154
  v_mfma_f32_16x16x32_bf16 v[236:239], a[164:167], a[32:35], v[236:239]
  v_mul_f32 v27, v27, v155
  v_mfma_f32_16x16x32_bf16 v[244:247], a[164:167], a[36:39], v[244:247]
  buffer_load_dwordx4 a[168:171], v1, s[8:11], s64 offen offset:1024 sc1
  v_exp_f32 v24, v24
  v_mfma_f32_16x16x32_bf16 a[0:3], a[160:163], a[24:27], a[0:3]
  v_exp_f32 v25, v25
  v_mfma_f32_16x16x32_bf16 a[4:7], a[160:163], a[28:31], a[4:7]
  v_exp_f32 v26, v26
  v_mfma_f32_16x16x32_bf16 a[8:11], a[160:163], a[32:35], a[8:11]
  v_exp_f32 v27, v27
  v_mfma_f32_16x16x32_bf16 a[12:15], a[160:163], a[36:39], a[12:15]
  buffer_load_dwordx4 a[164:167], v1, s[8:11], s64 offen offset:2048 sc1
  v_add_f32 v24, 1.0, v24
  v_add_f32 v25, 1.0, v25
  s_waitcnt vmcnt(26) lgkmcnt(1)
  v_mfma_f32_16x16x32_bf16 v[40:43], a[156:159], a[40:43], v[40:43]
  s_barrier
  ds_read_b128 a[24:27], v6 offset:16384
  v_add_f32 v26, 1.0, v26
  v_mfma_f32_16x16x32_bf16 v[48:51], a[156:159], a[44:47], v[48:51]
  v_add_f32 v27, 1.0, v27
  v_rcp_f32 v24, v24
  v_mfma_f32_16x16x32_bf16 v[56:59], a[156:159], a[48:51], v[56:59]
  ds_read_b128 a[28:31], v6 offset:16640
  v_rcp_f32 v25, v25
  v_mfma_f32_16x16x32_bf16 v[64:67], a[156:159], a[52:55], v[64:67]
  buffer_load_dwordx4 a[160:163], v1, s[8:11], s64 offen offset:3072 sc1
  v_rcp_f32 v26, v26
  v_mfma_f32_16x16x32_bf16 v[44:47], a[152:155], a[40:43], v[44:47]
  ds_read_b128 a[32:35], v7 offset:16384
  v_mfma_f32_16x16x32_bf16 v[52:55], a[152:155], a[44:47], v[52:55]
  v_rcp_f32 v27, v27
  v_mul_f32 v24, v24, v152
  v_mfma_f32_16x16x32_bf16 v[60:63], a[152:155], a[48:51], v[60:63]
  ds_read_b128 a[36:39], v7 offset:16640
  v_mul_f32 v25, v25, v153
  v_mul_f32 v26, v26, v154
  v_mfma_f32_16x16x32_bf16 v[68:71], a[152:155], a[52:55], v[68:71]
  s_addk_i32 s64, 4096
  buffer_load_dwordx4 a[156:159], v1, s[8:11], s64 offen offset:0 sc1
  v_mul_f32 v27, v27, v155
  v_mfma_f32_16x16x32_bf16 v[72:75], a[148:151], a[40:43], v[72:75]
  v_cvt_pk_bf16_f32 v32, v24, v25
  v_cvt_pk_bf16_f32 v33, v26, v27
  v_mfma_f32_16x16x32_bf16 v[80:83], a[148:151], a[44:47], v[80:83]
  v_mul_f32 v28, v156, v156
  v_mul_f32 v29, v157, v157
  v_mfma_f32_16x16x32_bf16 v[88:91], a[148:151], a[48:51], v[88:91]
  v_mul_f32 v30, v158, v158
  v_mul_f32 v31, v159, v159
  v_mfma_f32_16x16x32_bf16 v[96:99], a[148:151], a[52:55], v[96:99]
  s_add_u32 s30, s30, 4294922240
  buffer_load_dwordx4 a[152:155], v13, s[8:11], s30 offen offset:1024 sc1
  v_fma_f32 v28, v28, v22, v18
  v_fma_f32 v29, v29, v22, v18
  v_mfma_f32_16x16x32_bf16 v[76:79], a[144:147], a[40:43], v[76:79]
  v_fma_f32 v30, v30, v22, v18
  v_fma_f32 v31, v31, v22, v18
  v_mfma_f32_16x16x32_bf16 v[84:87], a[144:147], a[44:47], v[84:87]
  v_mul_f32 v28, v28, v156
  v_mfma_f32_16x16x32_bf16 v[92:95], a[144:147], a[48:51], v[92:95]
  v_mul_f32 v29, v29, v157
  v_mul_f32 v30, v30, v158
  v_mfma_f32_16x16x32_bf16 v[100:103], a[144:147], a[52:55], v[100:103]
  buffer_load_dwordx4 a[148:151], v13, s[8:11], s30 offen offset:1152 sc1
  v_mul_f32 v31, v31, v159
  v_exp_f32 v28, v28
  v_mfma_f32_16x16x32_bf16 v[184:187], a[140:143], a[40:43], v[184:187]
  v_mfma_f32_16x16x32_bf16 v[192:195], a[140:143], a[44:47], v[192:195]
  v_exp_f32 v29, v29
  v_mfma_f32_16x16x32_bf16 v[200:203], a[140:143], a[48:51], v[200:203]
  v_exp_f32 v30, v30
  v_mfma_f32_16x16x32_bf16 v[208:211], a[140:143], a[52:55], v[208:211]
  buffer_load_dwordx4 a[144:147], v13, s[8:11], s30 offen offset:3072 sc1
  v_exp_f32 v31, v31
  s_waitcnt vmcnt(27)
  v_mfma_f32_16x16x32_bf16 v[188:191], a[136:139], a[40:43], v[188:191]
  v_add_f32 v28, 1.0, v28
  v_add_f32 v29, 1.0, v29
  v_mfma_f32_16x16x32_bf16 v[196:199], a[136:139], a[44:47], v[196:199]
  v_add_f32 v30, 1.0, v30
  v_add_f32 v31, 1.0, v31
  v_mfma_f32_16x16x32_bf16 v[204:207], a[136:139], a[48:51], v[204:207]
  v_rcp_f32 v28, v28
  v_mfma_f32_16x16x32_bf16 v[212:215], a[136:139], a[52:55], v[212:215]
  buffer_load_dwordx4 a[140:143], v13, s[8:11], s30 offen offset:3200 sc1
  v_rcp_f32 v29, v29
  v_mfma_f32_16x16x32_bf16 v[216:219], a[132:135], a[40:43], v[216:219]
  v_rcp_f32 v30, v30
  v_mfma_f32_16x16x32_bf16 v[224:227], a[132:135], a[44:47], v[224:227]
  v_rcp_f32 v31, v31
  v_mfma_f32_16x16x32_bf16 v[232:235], a[132:135], a[48:51], v[232:235]
  v_mul_f32 v28, v28, v156
  v_mfma_f32_16x16x32_bf16 v[240:243], a[132:135], a[52:55], v[240:243]
  s_addk_i32 s30, 4096
  buffer_load_dwordx4 a[136:139], v13, s[8:11], s30 offen offset:1024 sc1
  v_mul_f32 v29, v29, v157
  v_mul_f32 v30, v30, v158
  v_mfma_f32_16x16x32_bf16 v[220:223], a[128:131], a[40:43], v[220:223]
  v_mul_f32 v31, v31, v159
  v_cvt_pk_bf16_f32 v34, v28, v29
  v_mfma_f32_16x16x32_bf16 v[228:231], a[128:131], a[44:47], v[228:231]
  v_cvt_pk_bf16_f32 v35, v30, v31
  ds_write_b128 v11, v[32:35] offset:24576
  v_mfma_f32_16x16x32_bf16 v[236:239], a[128:131], a[48:51], v[236:239]
  v_mul_f32 v24, v160, v160
  v_mul_f32 v25, v161, v161
  v_mfma_f32_16x16x32_bf16 v[244:247], a[128:131], a[52:55], v[244:247]
  buffer_load_dwordx4 a[132:135], v13, s[8:11], s30 offen offset:1152 sc1
  v_mul_f32 v26, v162, v162
  v_mfma_f32_16x16x32_bf16 a[0:3], a[252:255], a[40:43], a[0:3]
  v_mul_f32 v27, v163, v163
  v_fma_f32 v24, v24, v23, v19
  v_mfma_f32_16x16x32_bf16 a[4:7], a[252:255], a[44:47], a[4:7]
  v_fma_f32 v25, v25, v23, v19
  v_fma_f32 v26, v26, v23, v19
  v_mfma_f32_16x16x32_bf16 a[8:11], a[252:255], a[48:51], a[8:11]
  v_fma_f32 v27, v27, v23, v19
  v_mul_f32 v24, v24, v160
  v_mfma_f32_16x16x32_bf16 a[12:15], a[252:255], a[52:55], a[12:15]
  buffer_load_dwordx4 a[128:131], v13, s[8:11], s30 offen offset:3072 sc1
  v_mul_f32 v25, v25, v161
  v_mul_f32 v26, v26, v162
  s_waitcnt vmcnt(26) lgkmcnt(1)
  v_mfma_f32_16x16x32_bf16 v[216:219], a[248:251], a[24:27], v[216:219]
  ds_read_b128 a[40:43], v6 offset:18432
  v_mul_f32 v27, v27, v163
  v_mfma_f32_16x16x32_bf16 v[224:227], a[248:251], a[28:31], v[224:227]
  v_exp_f32 v24, v24
  v_mfma_f32_16x16x32_bf16 v[232:235], a[248:251], a[32:35], v[232:235]
  ds_read_b128 a[44:47], v6 offset:18688
  v_exp_f32 v25, v25
  v_mfma_f32_16x16x32_bf16 v[240:243], a[248:251], a[36:39], v[240:243]
  buffer_load_dwordx4 a[252:255], v13, s[8:11], s30 offen offset:3200 sc1
  v_exp_f32 v26, v26
  v_mfma_f32_16x16x32_bf16 v[220:223], a[244:247], a[24:27], v[220:223]
  ds_read_b128 a[48:51], v7 offset:18432
  v_exp_f32 v27, v27
  v_mfma_f32_16x16x32_bf16 v[228:231], a[244:247], a[28:31], v[228:231]
  v_add_f32 v24, 1.0, v24
  v_add_f32 v25, 1.0, v25
  v_mfma_f32_16x16x32_bf16 v[236:239], a[244:247], a[32:35], v[236:239]
  ds_read_b128 a[52:55], v7 offset:18688
  v_add_f32 v26, 1.0, v26
  v_add_f32 v27, 1.0, v27
  v_mfma_f32_16x16x32_bf16 v[244:247], a[244:247], a[36:39], v[244:247]
  s_addk_i32 s30, 4096
  buffer_load_dwordx4 a[248:251], v13, s[8:11], s30 offen offset:1024 sc1
  v_rcp_f32 v24, v24
  v_mfma_f32_16x16x32_bf16 v[40:43], a[240:243], a[24:27], v[40:43]
  v_rcp_f32 v25, v25
  v_mfma_f32_16x16x32_bf16 v[48:51], a[240:243], a[28:31], v[48:51]
  v_rcp_f32 v26, v26
  v_mfma_f32_16x16x32_bf16 v[56:59], a[240:243], a[32:35], v[56:59]
  v_rcp_f32 v27, v27
  v_mfma_f32_16x16x32_bf16 v[64:67], a[240:243], a[36:39], v[64:67]
  buffer_load_dwordx4 a[244:247], v13, s[8:11], s30 offen offset:1152 sc1
  v_mul_f32 v24, v24, v160
  v_mfma_f32_16x16x32_bf16 v[44:47], a[236:239], a[24:27], v[44:47]
  v_mul_f32 v25, v25, v161
  v_mul_f32 v26, v26, v162
  v_mfma_f32_16x16x32_bf16 v[52:55], a[236:239], a[28:31], v[52:55]
  v_mul_f32 v27, v27, v163
  v_cvt_pk_bf16_f32 v36, v24, v25
  v_mfma_f32_16x16x32_bf16 v[60:63], a[236:239], a[32:35], v[60:63]
  v_cvt_pk_bf16_f32 v37, v26, v27
  v_mfma_f32_16x16x32_bf16 v[68:71], a[236:239], a[36:39], v[68:71]
  buffer_load_dwordx4 a[240:243], v13, s[8:11], s30 offen offset:3072 sc1
  v_mul_f32 v28, v164, v164
  v_mul_f32 v29, v165, v165
  v_mfma_f32_16x16x32_bf16 v[72:75], a[232:235], a[24:27], v[72:75]
  v_mul_f32 v30, v166, v166
  v_mul_f32 v31, v167, v167
  v_mfma_f32_16x16x32_bf16 v[80:83], a[232:235], a[28:31], v[80:83]
  v_fma_f32 v28, v28, v23, v19
  v_fma_f32 v29, v29, v23, v19
  v_mfma_f32_16x16x32_bf16 v[88:91], a[232:235], a[32:35], v[88:91]
  v_fma_f32 v30, v30, v23, v19
  v_fma_f32 v31, v31, v23, v19
  v_mfma_f32_16x16x32_bf16 v[96:99], a[232:235], a[36:39], v[96:99]
  buffer_load_dwordx4 a[236:239], v13, s[8:11], s30 offen offset:3200 sc1
  v_mul_f32 v28, v28, v164
  v_mul_f32 v29, v29, v165
  s_waitcnt vmcnt(27)
  v_mfma_f32_16x16x32_bf16 v[76:79], a[228:231], a[24:27], v[76:79]
  v_mul_f32 v30, v30, v166
  v_mfma_f32_16x16x32_bf16 v[84:87], a[228:231], a[28:31], v[84:87]
  v_mul_f32 v31, v31, v167
  v_exp_f32 v28, v28
  v_mfma_f32_16x16x32_bf16 v[92:95], a[228:231], a[32:35], v[92:95]
  v_exp_f32 v29, v29
  v_mfma_f32_16x16x32_bf16 v[100:103], a[228:231], a[36:39], v[100:103]
  s_addk_i32 s30, 8192
  buffer_load_dwordx4 a[232:235], v13, s[8:11], s30 offen offset:1024 sc1
  v_mfma_f32_16x16x32_bf16 v[184:187], a[224:227], a[24:27], v[184:187]
  v_exp_f32 v30, v30
  v_mfma_f32_16x16x32_bf16 v[192:195], a[224:227], a[28:31], v[192:195]
  v_exp_f32 v31, v31
  v_add_f32 v28, 1.0, v28
  v_mfma_f32_16x16x32_bf16 v[200:203], a[224:227], a[32:35], v[200:203]
  v_add_f32 v29, 1.0, v29
  v_mfma_f32_16x16x32_bf16 v[208:211], a[224:227], a[36:39], v[208:211]
  buffer_load_dwordx4 a[228:231], v13, s[8:11], s30 offen offset:1152 sc1
  v_add_f32 v30, 1.0, v30
  v_add_f32 v31, 1.0, v31
  v_mfma_f32_16x16x32_bf16 v[188:191], a[220:223], a[24:27], v[188:191]
  v_rcp_f32 v28, v28
  v_mfma_f32_16x16x32_bf16 v[196:199], a[220:223], a[28:31], v[196:199]
  v_rcp_f32 v29, v29
  v_mfma_f32_16x16x32_bf16 v[204:207], a[220:223], a[32:35], v[204:207]
  v_rcp_f32 v30, v30
  v_mfma_f32_16x16x32_bf16 v[212:215], a[220:223], a[36:39], v[212:215]
  buffer_load_dwordx4 a[224:227], v13, s[8:11], s30 offen offset:3072 sc1
  v_rcp_f32 v31, v31
  v_mfma_f32_16x16x32_bf16 a[0:3], a[216:219], a[24:27], a[0:3]
  v_mul_f32 v28, v28, v164
  v_mfma_f32_16x16x32_bf16 a[4:7], a[216:219], a[28:31], a[4:7]
  v_mul_f32 v29, v29, v165
  v_mul_f32 v30, v30, v166
  v_mfma_f32_16x16x32_bf16 a[8:11], a[216:219], a[32:35], a[8:11]
  v_mul_f32 v31, v31, v167
  v_cvt_pk_bf16_f32 v38, v28, v29
  v_mfma_f32_16x16x32_bf16 a[12:15], a[216:219], a[36:39], a[12:15]
  buffer_load_dwordx4 a[220:223], v13, s[8:11], s30 offen offset:3200 sc1
  v_cvt_pk_bf16_f32 v39, v30, v31
  ds_write_b128 v11, v[36:39] offset:24832
  s_waitcnt vmcnt(26) lgkmcnt(1)
  v_mfma_f32_16x16x32_bf16 v[216:219], a[212:215], a[40:43], v[216:219]
  s_waitcnt lgkmcnt(0)
  s_barrier
  v_mfma_f32_16x16x32_bf16 v[224:227], a[212:215], a[44:47], v[224:227]
  ds_read_b128 a[64:67], v6 offset:20480
  v_mfma_f32_16x16x32_bf16 v[232:235], a[212:215], a[48:51], v[232:235]
  ds_read_b128 a[68:71], v6 offset:20736
  v_mfma_f32_16x16x32_bf16 v[240:243], a[212:215], a[52:55], v[240:243]
  s_addk_i32 s30, 4096
  buffer_load_dwordx4 a[216:219], v13, s[8:11], s30 offen offset:1024 sc1
  v_mfma_f32_16x16x32_bf16 v[220:223], a[208:211], a[40:43], v[220:223]
  ds_read_b128 a[72:75], v7 offset:20480
  v_mfma_f32_16x16x32_bf16 v[228:231], a[208:211], a[44:47], v[228:231]
  ds_read_b128 a[76:79], v7 offset:20736
  v_mfma_f32_16x16x32_bf16 v[236:239], a[208:211], a[48:51], v[236:239]
  v_mfma_f32_16x16x32_bf16 v[244:247], a[208:211], a[52:55], v[244:247]
  buffer_load_dwordx4 a[212:215], v13, s[8:11], s30 offen offset:1152 sc1
  ds_read_b128 v[104:107], v6 offset:22528
  v_mfma_f32_16x16x32_bf16 v[40:43], a[204:207], a[40:43], v[40:43]
  ds_read_b128 v[108:111], v6 offset:22784
  v_mfma_f32_16x16x32_bf16 v[48:51], a[204:207], a[44:47], v[48:51]
  v_mfma_f32_16x16x32_bf16 v[56:59], a[204:207], a[48:51], v[56:59]
  ds_read_b128 v[112:115], v7 offset:22528
  v_mfma_f32_16x16x32_bf16 v[64:67], a[204:207], a[52:55], v[64:67]
  buffer_load_dwordx4 a[208:211], v13, s[8:11], s30 offen offset:3072 sc1
  ds_read_b128 v[116:119], v7 offset:22784
  v_mfma_f32_16x16x32_bf16 v[44:47], a[200:203], a[40:43], v[44:47]
  v_mfma_f32_16x16x32_bf16 v[52:55], a[200:203], a[44:47], v[52:55]
  ds_read_b128 a[80:83], v6 offset:24576
  v_mfma_f32_16x16x32_bf16 v[60:63], a[200:203], a[48:51], v[60:63]
  ds_read_b128 a[84:87], v6 offset:24832
  v_mfma_f32_16x16x32_bf16 v[68:71], a[200:203], a[52:55], v[68:71]
  buffer_load_dwordx4 a[204:207], v13, s[8:11], s30 offen offset:3200 sc1
  v_mfma_f32_16x16x32_bf16 v[72:75], a[196:199], a[40:43], v[72:75]
  ds_read_b128 a[88:91], v7 offset:24576
  v_mfma_f32_16x16x32_bf16 v[80:83], a[196:199], a[44:47], v[80:83]
  ds_read_b128 a[92:95], v7 offset:24832
  v_mfma_f32_16x16x32_bf16 v[88:91], a[196:199], a[48:51], v[88:91]
  v_mfma_f32_16x16x32_bf16 v[96:99], a[196:199], a[52:55], v[96:99]
  s_addk_i32 s30, 4096
  buffer_load_dwordx4 a[200:203], v13, s[8:11], s30 offen offset:1024 sc1
  ds_read_b128 v[120:123], v6 offset:26624
  s_waitcnt vmcnt(27)
  v_mfma_f32_16x16x32_bf16 v[76:79], a[192:195], a[40:43], v[76:79]
  ds_read_b128 v[124:127], v6 offset:26880
  v_mfma_f32_16x16x32_bf16 v[84:87], a[192:195], a[44:47], v[84:87]
  v_mfma_f32_16x16x32_bf16 v[92:95], a[192:195], a[48:51], v[92:95]
  ds_read_b128 v[128:131], v7 offset:26624
  v_mfma_f32_16x16x32_bf16 v[100:103], a[192:195], a[52:55], v[100:103]
  buffer_load_dwordx4 a[196:199], v13, s[8:11], s30 offen offset:1152 sc1
  ds_read_b128 v[132:135], v7 offset:26880
  v_mfma_f32_16x16x32_bf16 v[184:187], a[188:191], a[40:43], v[184:187]
  v_mfma_f32_16x16x32_bf16 v[192:195], a[188:191], a[44:47], v[192:195]
  ds_read_b128 a[96:99], v6 offset:28672
  v_mfma_f32_16x16x32_bf16 v[200:203], a[188:191], a[48:51], v[200:203]
  ds_read_b128 a[100:103], v6 offset:28928
  v_mfma_f32_16x16x32_bf16 v[208:211], a[188:191], a[52:55], v[208:211]
  buffer_load_dwordx4 a[192:195], v13, s[8:11], s30 offen offset:3072 sc1
  v_mfma_f32_16x16x32_bf16 v[188:191], a[184:187], a[40:43], v[188:191]
  ds_read_b128 a[104:107], v7 offset:28672
  v_mfma_f32_16x16x32_bf16 v[196:199], a[184:187], a[44:47], v[196:199]
  ds_read_b128 a[108:111], v7 offset:28928
  v_mfma_f32_16x16x32_bf16 v[204:207], a[184:187], a[48:51], v[204:207]
  v_mfma_f32_16x16x32_bf16 v[212:215], a[184:187], a[52:55], v[212:215]
  buffer_load_dwordx4 a[188:191], v13, s[8:11], s30 offen offset:3200 sc1
  ds_read_b128 v[136:139], v6 offset:30720
  v_mfma_f32_16x16x32_bf16 a[0:3], a[180:183], a[40:43], a[0:3]
  ds_read_b128 v[140:143], v6 offset:30976
  v_mfma_f32_16x16x32_bf16 a[4:7], a[180:183], a[44:47], a[4:7]
  v_mfma_f32_16x16x32_bf16 a[8:11], a[180:183], a[48:51], a[8:11]
  ds_read_b128 v[144:147], v7 offset:30720
  v_mfma_f32_16x16x32_bf16 a[12:15], a[180:183], a[52:55], a[12:15]
  s_addk_i32 s30, 8192
  buffer_load_dwordx4 a[184:187], v13, s[8:11], s30 offen offset:1024 sc1
  ds_read_b128 v[148:151], v7 offset:30976
  s_waitcnt vmcnt(27) lgkmcnt(15)
  v_mfma_f32_16x16x32_bf16 a[0:3], a[176:179], a[64:67], a[0:3]
  v_mfma_f32_16x16x32_bf16 a[4:7], a[176:179], a[68:71], a[4:7]
  v_mfma_f32_16x16x32_bf16 a[8:11], a[176:179], a[72:75], a[8:11]
  v_mfma_f32_16x16x32_bf16 a[12:15], a[176:179], a[76:79], a[12:15]
  buffer_load_dwordx4 a[180:183], v13, s[8:11], s30 offen offset:1152 sc1
  v_mfma_f32_16x16x32_bf16 a[0:3], a[172:175], v[104:107], a[0:3]
  v_mfma_f32_16x16x32_bf16 a[4:7], a[172:175], v[108:111], a[4:7]
  v_mfma_f32_16x16x32_bf16 a[8:11], a[172:175], v[112:115], a[8:11]
  v_mfma_f32_16x16x32_bf16 a[12:15], a[172:175], v[116:119], a[12:15]
  buffer_load_dwordx4 a[176:179], v13, s[8:11], s30 offen offset:3072 sc1
  v_mfma_f32_16x16x32_bf16 a[0:3], a[168:171], a[80:83], a[0:3]
  s_waitcnt lgkmcnt(14)
  v_mfma_f32_16x16x32_bf16 a[4:7], a[168:171], a[84:87], a[4:7]
  s_waitcnt lgkmcnt(13)
  v_mfma_f32_16x16x32_bf16 a[8:11], a[168:171], a[88:91], a[8:11]
  s_waitcnt lgkmcnt(12)
  v_mfma_f32_16x16x32_bf16 a[12:15], a[168:171], a[92:95], a[12:15]
  buffer_load_dwordx4 a[172:175], v13, s[8:11], s30 offen offset:3200 sc1
  s_waitcnt lgkmcnt(11)
  v_mfma_f32_16x16x32_bf16 a[0:3], a[164:167], v[120:123], a[0:3]
  s_waitcnt lgkmcnt(10)
  v_mfma_f32_16x16x32_bf16 a[4:7], a[164:167], v[124:127], a[4:7]
  s_waitcnt lgkmcnt(9)
  v_mfma_f32_16x16x32_bf16 a[8:11], a[164:167], v[128:131], a[8:11]
  s_waitcnt lgkmcnt(8)
  v_mfma_f32_16x16x32_bf16 a[12:15], a[164:167], v[132:135], a[12:15]
  s_addk_i32 s30, 4096
  buffer_load_dwordx4 a[168:171], v13, s[8:11], s30 offen offset:1024 sc1
  s_waitcnt vmcnt(29) lgkmcnt(7)
  v_mfma_f32_16x16x32_bf16 a[0:3], a[160:163], a[96:99], a[0:3]
  s_waitcnt lgkmcnt(6)
  v_mfma_f32_16x16x32_bf16 a[4:7], a[160:163], a[100:103], a[4:7]
  s_waitcnt lgkmcnt(5)
  v_mfma_f32_16x16x32_bf16 a[8:11], a[160:163], a[104:107], a[8:11]
  s_waitcnt lgkmcnt(4)
  v_mfma_f32_16x16x32_bf16 a[12:15], a[160:163], a[108:111], a[12:15]
  buffer_load_dwordx4 a[164:167], v13, s[8:11], s30 offen offset:1152 sc1
  s_waitcnt lgkmcnt(3)
  v_mfma_f32_16x16x32_bf16 a[0:3], a[156:159], v[136:139], a[0:3]
  s_waitcnt lgkmcnt(2)
  v_mfma_f32_16x16x32_bf16 a[4:7], a[156:159], v[140:143], a[4:7]
  s_waitcnt lgkmcnt(1)
  v_mfma_f32_16x16x32_bf16 a[8:11], a[156:159], v[144:147], a[8:11]
  s_waitcnt lgkmcnt(0)
  v_mfma_f32_16x16x32_bf16 a[12:15], a[156:159], v[148:151], a[12:15]
  buffer_load_dwordx4 a[160:163], v13, s[8:11], s30 offen offset:3072 sc1
  s_waitcnt vmcnt(27)
  v_mfma_f32_16x16x32_bf16 v[216:219], a[152:155], a[64:67], v[216:219]
  v_mfma_f32_16x16x32_bf16 v[224:227], a[152:155], a[68:71], v[224:227]
  v_mfma_f32_16x16x32_bf16 v[232:235], a[152:155], a[72:75], v[232:235]
  v_mfma_f32_16x16x32_bf16 v[240:243], a[152:155], a[76:79], v[240:243]
  buffer_load_dwordx4 a[156:159], v13, s[8:11], s30 offen offset:3200 sc1
  v_mfma_f32_16x16x32_bf16 v[220:223], a[148:151], a[64:67], v[220:223]
  v_lshrrev_b32 v24, 5, v2
  v_mfma_f32_16x16x32_bf16 v[228:231], a[148:151], a[68:71], v[228:231]
  v_and_b32 v25, 31, v2
  v_lshlrev_b32 v25, 4, v25
  v_mfma_f32_16x16x32_bf16 v[236:239], a[148:151], a[72:75], v[236:239]
  v_lshl_add_u32 v24, v24, 10, v25
  v_mfma_f32_16x16x32_bf16 v[244:247], a[148:151], a[76:79], v[244:247]
  s_addk_i32 s30, 4096
  buffer_load_dwordx4 a[152:155], v13, s[8:11], s30 offen offset:1024 sc1
  s_lshl_b32 s50, s19, 9
  v_mfma_f32_16x16x32_bf16 v[216:219], a[144:147], v[104:107], v[216:219]
  v_add_u32 v24, s50, v24
  v_mfma_f32_16x16x32_bf16 v[224:227], a[144:147], v[108:111], v[224:227]
  v_mfma_f32_16x16x32_bf16 v[232:235], a[144:147], v[112:115], v[232:235]
  v_mfma_f32_16x16x32_bf16 v[240:243], a[144:147], v[116:119], v[240:243]
  buffer_load_dwordx4 a[148:151], v13, s[8:11], s30 offen offset:1152 sc1
  v_mfma_f32_16x16x32_bf16 v[220:223], a[140:143], v[104:107], v[220:223]
  v_bfe_u32 v25, v2, 3, 2
  s_and_b32 s50, s17, 3
  v_cmp_eq_u32 vcc, s50, v25
  v_mov_b32 v25, 0x40000000
  s_nop 0
  v_cndmask_b32 v25, v24, v25, vcc
  s_cmp_lt_u32 s44, 2
  s_cselect_b64 vcc, -1, 0
  v_cndmask_b32 v26, v24, v25, vcc
  v_cndmask_b32 v27, v25, v24, vcc
  v_mfma_f32_16x16x32_bf16 v[228:231], a[140:143], v[108:111], v[228:231]
  v_mfma_f32_16x16x32_bf16 v[236:239], a[140:143], v[112:115], v[236:239]
  v_mfma_f32_16x16x32_bf16 v[244:247], a[140:143], v[116:119], v[244:247]
  buffer_load_dwordx4 a[144:147], v13, s[8:11], s30 offen offset:3072 sc1
  s_waitcnt vmcnt(27)
  v_mfma_f32_16x16x32_bf16 v[216:219], a[136:139], a[80:83], v[216:219]
  s_lshl_b32 s50, s20, 11
  v_mfma_f32_16x16x32_bf16 v[224:227], a[136:139], a[84:87], v[224:227]
  s_add_u32 s50, s50, 106496
  s_mul_i32 s51, s19, 36864
  v_mfma_f32_16x16x32_bf16 v[232:235], a[136:139], a[88:91], v[232:235]
  s_add_u32 s51, s51, s50
  v_mfma_f32_16x16x32_bf16 v[240:243], a[136:139], a[92:95], v[240:243]
  buffer_load_dwordx4 a[140:143], v13, s[8:11], s30 offen offset:3200 sc1
  v_add_u32 v28, s51, v24
  v_mfma_f32_16x16x32_bf16 v[220:223], a[132:135], a[80:83], v[220:223]
  s_mul_i32 s51, s29, 36864
  v_mfma_f32_16x16x32_bf16 v[228:231], a[132:135], a[84:87], v[228:231]
  s_add_u32 s51, s51, s50
  v_add_u32 v29, s51, v24
  v_mfma_f32_16x16x32_bf16 v[236:239], a[132:135], a[88:91], v[236:239]
  v_accvgpr_read_b32 v168, a0
  v_mfma_f32_16x16x32_bf16 v[244:247], a[132:135], a[92:95], v[244:247]
  s_addk_i32 s30, 8192
  buffer_load_dwordx4 a[136:139], v13, s[8:11], s30 offen offset:1024 sc1
  v_accvgpr_read_b32 v169, a1
  v_mfma_f32_16x16x32_bf16 v[216:219], a[128:131], v[120:123], v[216:219]
  v_accvgpr_read_b32 v170, a2
  v_mfma_f32_16x16x32_bf16 v[224:227], a[128:131], v[124:127], v[224:227]
  v_accvgpr_read_b32 v171, a3
  v_accvgpr_read_b32 v172, a4
  v_mfma_f32_16x16x32_bf16 v[232:235], a[128:131], v[128:131], v[232:235]
  v_accvgpr_read_b32 v173, a5
  v_mfma_f32_16x16x32_bf16 v[240:243], a[128:131], v[132:135], v[240:243]
  buffer_load_dwordx4 a[132:135], v13, s[8:11], s30 offen offset:1152 sc1
  v_accvgpr_read_b32 v174, a6
  v_mfma_f32_16x16x32_bf16 v[220:223], a[252:255], v[120:123], v[220:223]
  v_accvgpr_read_b32 v175, a7
  v_mfma_f32_16x16x32_bf16 v[228:231], a[252:255], v[124:127], v[228:231]
  v_accvgpr_read_b32 v176, a8
  v_accvgpr_read_b32 v177, a9
  v_mfma_f32_16x16x32_bf16 v[236:239], a[252:255], v[128:131], v[236:239]
  v_accvgpr_read_b32 v178, a10
  v_mfma_f32_16x16x32_bf16 v[244:247], a[252:255], v[132:135], v[244:247]
  buffer_load_dwordx4 a[128:131], v13, s[8:11], s30 offen offset:3072 sc1
  v_accvgpr_read_b32 v179, a11
  s_waitcnt vmcnt(27)
  v_mfma_f32_16x16x32_bf16 v[216:219], a[248:251], a[96:99], v[216:219]
  v_accvgpr_read_b32 v180, a12
  v_mfma_f32_16x16x32_bf16 v[224:227], a[248:251], a[100:103], v[224:227]
  v_accvgpr_read_b32 v181, a13
  v_accvgpr_read_b32 v182, a14
  v_mfma_f32_16x16x32_bf16 v[232:235], a[248:251], a[104:107], v[232:235]
  v_accvgpr_read_b32 v183, a15
  v_mfma_f32_16x16x32_bf16 v[240:243], a[248:251], a[108:111], v[240:243]
  buffer_load_dwordx4 a[252:255], v13, s[8:11], s30 offen offset:3200 sc1
  v_cvt_pk_bf16_f32 v32, v168, v169
  v_mfma_f32_16x16x32_bf16 v[220:223], a[244:247], a[96:99], v[220:223]
  v_cvt_pk_bf16_f32 v33, v170, v171
  v_mfma_f32_16x16x32_bf16 v[228:231], a[244:247], a[100:103], v[228:231]
  v_cvt_pk_bf16_f32 v34, v172, v173
  v_cvt_pk_bf16_f32 v35, v174, v175
  v_mfma_f32_16x16x32_bf16 v[236:239], a[244:247], a[104:107], v[236:239]
  v_permlane16_swap_b32 v32, v34
  v_mfma_f32_16x16x32_bf16 v[244:247], a[244:247], a[108:111], v[244:247]
  s_addk_i32 s30, 4096
  buffer_load_dwordx4 a[248:251], v13, s[8:11], s30 offen offset:1024 sc1
  v_permlane16_swap_b32 v33, v35
  v_mfma_f32_16x16x32_bf16 v[216:219], a[240:243], v[136:139], v[216:219]
  buffer_store_dwordx4 v[32:35], v26, s[8:11], s57 offen sc1
  v_mfma_f32_16x16x32_bf16 v[224:227], a[240:243], v[140:143], v[224:227]
  ds_write_b128 v28, v[32:35]
  v_cvt_pk_bf16_f32 v36, v176, v177
  v_mfma_f32_16x16x32_bf16 v[232:235], a[240:243], v[144:147], v[232:235]
  v_cvt_pk_bf16_f32 v37, v178, v179
  v_mfma_f32_16x16x32_bf16 v[240:243], a[240:243], v[148:151], v[240:243]
  buffer_load_dwordx4 a[244:247], v13, s[8:11], s30 offen offset:1152 sc1
  v_cvt_pk_bf16_f32 v38, v180, v181
  v_mfma_f32_16x16x32_bf16 v[220:223], a[236:239], v[136:139], v[220:223]
  v_cvt_pk_bf16_f32 v39, v182, v183
  v_mfma_f32_16x16x32_bf16 v[228:231], a[236:239], v[140:143], v[228:231]
  v_permlane16_swap_b32 v36, v38
  v_permlane16_swap_b32 v37, v39
  v_mfma_f32_16x16x32_bf16 v[236:239], a[236:239], v[144:147], v[236:239]
  buffer_store_dwordx4 v[36:39], v27, s[8:11], s54 offen sc1
  v_mfma_f32_16x16x32_bf16 v[244:247], a[236:239], v[148:151], v[244:247]
  buffer_load_dwordx4 a[240:243], v13, s[8:11], s30 offen offset:3072 sc1
  ds_write_b128 v29, v[36:39]
  s_waitcnt vmcnt(29)
  v_mfma_f32_16x16x32_bf16 v[40:43], a[232:235], a[64:67], v[40:43]
  v_mfma_f32_16x16x32_bf16 v[48:51], a[232:235], a[68:71], v[48:51]
  v_mfma_f32_16x16x32_bf16 v[56:59], a[232:235], a[72:75], v[56:59]
  v_mfma_f32_16x16x32_bf16 v[64:67], a[232:235], a[76:79], v[64:67]
  buffer_load_dwordx4 a[236:239], v13, s[8:11], s30 offen offset:3200 sc1
  v_mfma_f32_16x16x32_bf16 v[44:47], a[228:231], a[64:67], v[44:47]
  v_mfma_f32_16x16x32_bf16 v[52:55], a[228:231], a[68:71], v[52:55]
  v_mfma_f32_16x16x32_bf16 v[60:63], a[228:231], a[72:75], v[60:63]
  v_mfma_f32_16x16x32_bf16 v[68:71], a[228:231], a[76:79], v[68:71]
  s_addk_i32 s30, 4096
  buffer_load_dwordx4 a[232:235], v13, s[8:11], s30 offen offset:1024 sc1
  v_mfma_f32_16x16x32_bf16 v[40:43], a[224:227], v[104:107], v[40:43]
  v_mfma_f32_16x16x32_bf16 v[48:51], a[224:227], v[108:111], v[48:51]
  v_mfma_f32_16x16x32_bf16 v[56:59], a[224:227], v[112:115], v[56:59]
  v_mfma_f32_16x16x32_bf16 v[64:67], a[224:227], v[116:119], v[64:67]
  buffer_load_dwordx4 a[228:231], v13, s[8:11], s30 offen offset:1152 sc1
  v_mfma_f32_16x16x32_bf16 v[44:47], a[220:223], v[104:107], v[44:47]
  v_mfma_f32_16x16x32_bf16 v[52:55], a[220:223], v[108:111], v[52:55]
  v_mfma_f32_16x16x32_bf16 v[60:63], a[220:223], v[112:115], v[60:63]
  v_mfma_f32_16x16x32_bf16 v[68:71], a[220:223], v[116:119], v[68:71]
  buffer_load_dwordx4 a[224:227], v13, s[8:11], s30 offen offset:3072 sc1
  s_waitcnt vmcnt(29)
  v_mfma_f32_16x16x32_bf16 v[40:43], a[216:219], a[80:83], v[40:43]
  v_mfma_f32_16x16x32_bf16 v[48:51], a[216:219], a[84:87], v[48:51]
  v_mfma_f32_16x16x32_bf16 v[56:59], a[216:219], a[88:91], v[56:59]
  v_mfma_f32_16x16x32_bf16 v[64:67], a[216:219], a[92:95], v[64:67]
  buffer_load_dwordx4 a[220:223], v13, s[8:11], s30 offen offset:3200 sc1
  v_mfma_f32_16x16x32_bf16 v[44:47], a[212:215], a[80:83], v[44:47]
  s_add_u32 s58, s55, 24576
  v_mfma_f32_16x16x32_bf16 v[52:55], a[212:215], a[84:87], v[52:55]
  s_add_u32 s59, s56, 24576
  v_mfma_f32_16x16x32_bf16 v[60:63], a[212:215], a[88:91], v[60:63]
  v_cvt_pk_bf16_f32 v32, v216, v217
  v_mfma_f32_16x16x32_bf16 v[68:71], a[212:215], a[92:95], v[68:71]
  v_cvt_pk_bf16_f32 v33, v218, v219
  v_mfma_f32_16x16x32_bf16 v[40:43], a[208:211], v[120:123], v[40:43]
  v_cvt_pk_bf16_f32 v34, v220, v221
  v_mfma_f32_16x16x32_bf16 v[48:51], a[208:211], v[124:127], v[48:51]
  v_cvt_pk_bf16_f32 v35, v222, v223
  v_mfma_f32_16x16x32_bf16 v[56:59], a[208:211], v[128:131], v[56:59]
  v_permlane16_swap_b32 v32, v34
  v_mfma_f32_16x16x32_bf16 v[64:67], a[208:211], v[132:135], v[64:67]
  v_permlane16_swap_b32 v33, v35
  buffer_store_dwordx4 v[32:35], v4, s[8:11], s58 offen offset:0 sc1
  v_mfma_f32_16x16x32_bf16 v[44:47], a[204:207], v[120:123], v[44:47]
  ds_write_b128 v10, v[32:35] offset:24576
  v_mfma_f32_16x16x32_bf16 v[52:55], a[204:207], v[124:127], v[52:55]
  v_cvt_pk_bf16_f32 v36, v224, v225
  v_mfma_f32_16x16x32_bf16 v[60:63], a[204:207], v[128:131], v[60:63]
  v_cvt_pk_bf16_f32 v37, v226, v227
  v_mfma_f32_16x16x32_bf16 v[68:71], a[204:207], v[132:135], v[68:71]
  v_cvt_pk_bf16_f32 v38, v228, v229
  s_waitcnt vmcnt(27)
  v_mfma_f32_16x16x32_bf16 v[40:43], a[200:203], a[96:99], v[40:43]
  v_cvt_pk_bf16_f32 v39, v230, v231
  v_mfma_f32_16x16x32_bf16 v[48:51], a[200:203], a[100:103], v[48:51]
  v_permlane16_swap_b32 v36, v38
  v_mfma_f32_16x16x32_bf16 v[56:59], a[200:203], a[104:107], v[56:59]
  v_permlane16_swap_b32 v37, v39
  v_mfma_f32_16x16x32_bf16 v[64:67], a[200:203], a[108:111], v[64:67]
  buffer_store_dwordx4 v[36:39], v5, s[8:11], s58 offen offset:256 sc1
  v_mfma_f32_16x16x32_bf16 v[44:47], a[196:199], a[96:99], v[44:47]
  ds_write_b128 v10, v[36:39] offset:24832
  v_mfma_f32_16x16x32_bf16 v[52:55], a[196:199], a[100:103], v[52:55]
  v_cvt_pk_bf16_f32 v32, v232, v233
  v_mfma_f32_16x16x32_bf16 v[60:63], a[196:199], a[104:107], v[60:63]
  v_cvt_pk_bf16_f32 v33, v234, v235
  v_mfma_f32_16x16x32_bf16 v[68:71], a[196:199], a[108:111], v[68:71]
  v_cvt_pk_bf16_f32 v34, v236, v237
  v_mfma_f32_16x16x32_bf16 v[40:43], a[192:195], v[136:139], v[40:43]
  v_cvt_pk_bf16_f32 v35, v238, v239
  v_mfma_f32_16x16x32_bf16 v[48:51], a[192:195], v[140:143], v[48:51]
  v_permlane16_swap_b32 v32, v34
  v_mfma_f32_16x16x32_bf16 v[56:59], a[192:195], v[144:147], v[56:59]
  v_permlane16_swap_b32 v33, v35
  v_mfma_f32_16x16x32_bf16 v[64:67], a[192:195], v[148:151], v[64:67]
  buffer_store_dwordx4 v[32:35], v8, s[8:11], s59 offen offset:0 sc1
  ds_write_b128 v11, v[32:35] offset:24576
  v_mfma_f32_16x16x32_bf16 v[44:47], a[188:191], v[136:139], v[44:47]
  v_cvt_pk_bf16_f32 v36, v240, v241
  v_mfma_f32_16x16x32_bf16 v[52:55], a[188:191], v[140:143], v[52:55]
  v_cvt_pk_bf16_f32 v37, v242, v243
  v_mfma_f32_16x16x32_bf16 v[60:63], a[188:191], v[144:147], v[60:63]
  v_cvt_pk_bf16_f32 v38, v244, v245
  v_mfma_f32_16x16x32_bf16 v[68:71], a[188:191], v[148:151], v[68:71]
  v_cvt_pk_bf16_f32 v39, v246, v247
  s_waitcnt vmcnt(25)
  v_mfma_f32_16x16x32_bf16 v[72:75], a[184:187], a[64:67], v[72:75]
  v_permlane16_swap_b32 v36, v38
  v_mfma_f32_16x16x32_bf16 v[80:83], a[184:187], a[68:71], v[80:83]
  v_permlane16_swap_b32 v37, v39
  v_mfma_f32_16x16x32_bf16 v[88:91], a[184:187], a[72:75], v[88:91]
  buffer_store_dwordx4 v[36:39], v9, s[8:11], s59 offen offset:256 sc1
  v_mfma_f32_16x16x32_bf16 v[96:99], a[184:187], a[76:79], v[96:99]
  ds_write_b128 v11, v[36:39] offset:24832
  v_mfma_f32_16x16x32_bf16 v[76:79], a[180:183], a[64:67], v[76:79]
  s_add_u32 s58, s55, 0
  s_add_u32 s59, s56, 0
  v_mfma_f32_16x16x32_bf16 v[84:87], a[180:183], a[68:71], v[84:87]
  v_cvt_pk_bf16_f32 v32, v40, v41
  v_cvt_pk_bf16_f32 v33, v42, v43
  v_mfma_f32_16x16x32_bf16 v[92:95], a[180:183], a[72:75], v[92:95]
  v_cvt_pk_bf16_f32 v34, v44, v45
  v_cvt_pk_bf16_f32 v35, v46, v47
  v_mfma_f32_16x16x32_bf16 v[100:103], a[180:183], a[76:79], v[100:103]
  v_permlane16_swap_b32 v32, v34
  v_permlane16_swap_b32 v33, v35
  buffer_store_dwordx4 v[32:35], v4, s[8:11], s58 offen offset:0 sc1
  v_mfma_f32_16x16x32_bf16 v[72:75], a[176:179], v[104:107], v[72:75]
  ds_write_b128 v10, v[32:35] offset:0
  v_cvt_pk_bf16_f32 v36, v48, v49
  v_mfma_f32_16x16x32_bf16 v[80:83], a[176:179], v[108:111], v[80:83]
  v_cvt_pk_bf16_f32 v37, v50, v51
  v_cvt_pk_bf16_f32 v38, v52, v53
  v_mfma_f32_16x16x32_bf16 v[88:91], a[176:179], v[112:115], v[88:91]
  v_cvt_pk_bf16_f32 v39, v54, v55
  v_permlane16_swap_b32 v36, v38
  v_mfma_f32_16x16x32_bf16 v[96:99], a[176:179], v[116:119], v[96:99]
  v_permlane16_swap_b32 v37, v39
  buffer_store_dwordx4 v[36:39], v5, s[8:11], s58 offen offset:256 sc1
  v_mfma_f32_16x16x32_bf16 v[76:79], a[172:175], v[104:107], v[76:79]
  ds_write_b128 v10, v[36:39] offset:256
  v_cvt_pk_bf16_f32 v32, v56, v57
  v_mfma_f32_16x16x32_bf16 v[84:87], a[172:175], v[108:111], v[84:87]
  v_cvt_pk_bf16_f32 v33, v58, v59
  v_cvt_pk_bf16_f32 v34, v60, v61
  v_mfma_f32_16x16x32_bf16 v[92:95], a[172:175], v[112:115], v[92:95]
  v_cvt_pk_bf16_f32 v35, v62, v63
  v_permlane16_swap_b32 v32, v34
  v_mfma_f32_16x16x32_bf16 v[100:103], a[172:175], v[116:119], v[100:103]
  v_permlane16_swap_b32 v33, v35
  buffer_store_dwordx4 v[32:35], v8, s[8:11], s59 offen offset:0 sc1
  ds_write_b128 v11, v[32:35] offset:0
  s_waitcnt vmcnt(25)
  v_mfma_f32_16x16x32_bf16 v[72:75], a[168:171], a[80:83], v[72:75]
  v_cvt_pk_bf16_f32 v36, v64, v65
  v_cvt_pk_bf16_f32 v37, v66, v67
  v_mfma_f32_16x16x32_bf16 v[80:83], a[168:171], a[84:87], v[80:83]
  v_cvt_pk_bf16_f32 v38, v68, v69
  v_cvt_pk_bf16_f32 v39, v70, v71
  v_mfma_f32_16x16x32_bf16 v[88:91], a[168:171], a[88:91], v[88:91]
  v_permlane16_swap_b32 v36, v38
  v_permlane16_swap_b32 v37, v39
  v_mfma_f32_16x16x32_bf16 v[96:99], a[168:171], a[92:95], v[96:99]
  buffer_store_dwordx4 v[36:39], v9, s[8:11], s59 offen offset:256 sc1
  ds_write_b128 v11, v[36:39] offset:256
  v_mfma_f32_16x16x32_bf16 v[76:79], a[164:167], a[80:83], v[76:79]
  v_mfma_f32_16x16x32_bf16 v[84:87], a[164:167], a[84:87], v[84:87]
  v_mfma_f32_16x16x32_bf16 v[92:95], a[164:167], a[88:91], v[92:95]
  v_mfma_f32_16x16x32_bf16 v[100:103], a[164:167], a[92:95], v[100:103]
  v_mfma_f32_16x16x32_bf16 v[72:75], a[160:163], v[120:123], v[72:75]
  v_mfma_f32_16x16x32_bf16 v[80:83], a[160:163], v[124:127], v[80:83]
  v_mfma_f32_16x16x32_bf16 v[88:91], a[160:163], v[128:131], v[88:91]
  v_mfma_f32_16x16x32_bf16 v[96:99], a[160:163], v[132:135], v[96:99]
  v_mfma_f32_16x16x32_bf16 v[76:79], a[156:159], v[120:123], v[76:79]
  v_mfma_f32_16x16x32_bf16 v[84:87], a[156:159], v[124:127], v[84:87]
  v_mfma_f32_16x16x32_bf16 v[92:95], a[156:159], v[128:131], v[92:95]
  v_mfma_f32_16x16x32_bf16 v[100:103], a[156:159], v[132:135], v[100:103]
  s_waitcnt vmcnt(22)
  v_mfma_f32_16x16x32_bf16 v[72:75], a[152:155], a[96:99], v[72:75]
  v_mfma_f32_16x16x32_bf16 v[80:83], a[152:155], a[100:103], v[80:83]
  v_mfma_f32_16x16x32_bf16 v[88:91], a[152:155], a[104:107], v[88:91]
  v_mfma_f32_16x16x32_bf16 v[96:99], a[152:155], a[108:111], v[96:99]
  v_mfma_f32_16x16x32_bf16 v[76:79], a[148:151], a[96:99], v[76:79]
  v_mfma_f32_16x16x32_bf16 v[84:87], a[148:151], a[100:103], v[84:87]
  v_mfma_f32_16x16x32_bf16 v[92:95], a[148:151], a[104:107], v[92:95]
  v_mfma_f32_16x16x32_bf16 v[100:103], a[148:151], a[108:111], v[100:103]
  v_mfma_f32_16x16x32_bf16 v[72:75], a[144:147], v[136:139], v[72:75]
  v_mfma_f32_16x16x32_bf16 v[80:83], a[144:147], v[140:143], v[80:83]
  v_mfma_f32_16x16x32_bf16 v[88:91], a[144:147], v[144:147], v[88:91]
  v_mfma_f32_16x16x32_bf16 v[96:99], a[144:147], v[148:151], v[96:99]
  v_mfma_f32_16x16x32_bf16 v[76:79], a[140:143], v[136:139], v[76:79]
  v_mfma_f32_16x16x32_bf16 v[84:87], a[140:143], v[140:143], v[84:87]
  v_mfma_f32_16x16x32_bf16 v[92:95], a[140:143], v[144:147], v[92:95]
  v_mfma_f32_16x16x32_bf16 v[100:103], a[140:143], v[148:151], v[100:103]
  s_waitcnt vmcnt(18)
  v_mfma_f32_16x16x32_bf16 v[184:187], a[136:139], a[64:67], v[184:187]
  v_mfma_f32_16x16x32_bf16 v[192:195], a[136:139], a[68:71], v[192:195]
  v_mfma_f32_16x16x32_bf16 v[200:203], a[136:139], a[72:75], v[200:203]
  v_mfma_f32_16x16x32_bf16 v[208:211], a[136:139], a[76:79], v[208:211]
  v_mfma_f32_16x16x32_bf16 v[188:191], a[132:135], a[64:67], v[188:191]
  s_add_u32 s58, s55, 8192
  s_add_u32 s59, s56, 8192
  v_mfma_f32_16x16x32_bf16 v[196:199], a[132:135], a[68:71], v[196:199]
  v_cvt_pk_bf16_f32 v32, v72, v73
  v_mfma_f32_16x16x32_bf16 v[204:207], a[132:135], a[72:75], v[204:207]
  v_cvt_pk_bf16_f32 v33, v74, v75
  v_cvt_pk_bf16_f32 v34, v76, v77
  v_mfma_f32_16x16x32_bf16 v[212:215], a[132:135], a[76:79], v[212:215]
  v_cvt_pk_bf16_f32 v35, v78, v79
  v_permlane16_swap_b32 v32, v34
  v_mfma_f32_16x16x32_bf16 v[184:187], a[128:131], v[104:107], v[184:187]
  v_permlane16_swap_b32 v33, v35
  buffer_store_dwordx4 v[32:35], v4, s[8:11], s58 offen offset:0 sc1
  v_mfma_f32_16x16x32_bf16 v[192:195], a[128:131], v[108:111], v[192:195]
  ds_write_b128 v10, v[32:35] offset:8192
  v_mfma_f32_16x16x32_bf16 v[200:203], a[128:131], v[112:115], v[200:203]
  v_cvt_pk_bf16_f32 v36, v80, v81
  v_cvt_pk_bf16_f32 v37, v82, v83
  v_mfma_f32_16x16x32_bf16 v[208:211], a[128:131], v[116:119], v[208:211]
  v_cvt_pk_bf16_f32 v38, v84, v85
  v_cvt_pk_bf16_f32 v39, v86, v87
  v_mfma_f32_16x16x32_bf16 v[188:191], a[252:255], v[104:107], v[188:191]
  v_permlane16_swap_b32 v36, v38
  v_mfma_f32_16x16x32_bf16 v[196:199], a[252:255], v[108:111], v[196:199]
  v_permlane16_swap_b32 v37, v39
  buffer_store_dwordx4 v[36:39], v5, s[8:11], s58 offen offset:256 sc1
  v_mfma_f32_16x16x32_bf16 v[204:207], a[252:255], v[112:115], v[204:207]
  ds_write_b128 v10, v[36:39] offset:8448
  v_cvt_pk_bf16_f32 v32, v88, v89
  v_mfma_f32_16x16x32_bf16 v[212:215], a[252:255], v[116:119], v[212:215]
  v_cvt_pk_bf16_f32 v33, v90, v91
  s_waitcnt vmcnt(14)
  v_mfma_f32_16x16x32_bf16 v[184:187], a[248:251], a[80:83], v[184:187]
  v_cvt_pk_bf16_f32 v34, v92, v93
  v_cvt_pk_bf16_f32 v35, v94, v95
  v_mfma_f32_16x16x32_bf16 v[192:195], a[248:251], a[84:87], v[192:195]
  v_permlane16_swap_b32 v32, v34
  v_permlane16_swap_b32 v33, v35
  v_mfma_f32_16x16x32_bf16 v[200:203], a[248:251], a[88:91], v[200:203]
  buffer_store_dwordx4 v[32:35], v8, s[8:11], s59 offen offset:0 sc1
  ds_write_b128 v11, v[32:35] offset:8192
  v_mfma_f32_16x16x32_bf16 v[208:211], a[248:251], a[92:95], v[208:211]
  v_cvt_pk_bf16_f32 v36, v96, v97
  v_mfma_f32_16x16x32_bf16 v[188:191], a[244:247], a[80:83], v[188:191]
  v_lshlrev_b32 v20, 14, v2
  v_mov_b32 v21, 1
  s_mov_b64 exec, 1
  s_waitcnt vmcnt(3)
  buffer_atomic_add v21, v20, s[8:11], s66 offen
  s_mov_b64 exec, -1
  v_cvt_pk_bf16_f32 v37, v98, v99
  v_cvt_pk_bf16_f32 v38, v100, v101
  v_mfma_f32_16x16x32_bf16 v[196:199], a[244:247], a[84:87], v[196:199]
  v_cvt_pk_bf16_f32 v39, v102, v103
  v_permlane16_swap_b32 v36, v38
  v_mfma_f32_16x16x32_bf16 v[204:207], a[244:247], a[88:91], v[204:207]
  v_permlane16_swap_b32 v37, v39
  v_mfma_f32_16x16x32_bf16 v[212:215], a[244:247], a[92:95], v[212:215]
  buffer_store_dwordx4 v[36:39], v9, s[8:11], s59 offen offset:256 sc1
  ds_write_b128 v11, v[36:39] offset:8448
  v_mfma_f32_16x16x32_bf16 v[184:187], a[240:243], v[120:123], v[184:187]
  v_mfma_f32_16x16x32_bf16 v[192:195], a[240:243], v[124:127], v[192:195]
  v_mfma_f32_16x16x32_bf16 v[200:203], a[240:243], v[128:131], v[200:203]
  v_mfma_f32_16x16x32_bf16 v[208:211], a[240:243], v[132:135], v[208:211]
  v_mfma_f32_16x16x32_bf16 v[188:191], a[236:239], v[120:123], v[188:191]
  v_mfma_f32_16x16x32_bf16 v[196:199], a[236:239], v[124:127], v[196:199]
  v_mfma_f32_16x16x32_bf16 v[204:207], a[236:239], v[128:131], v[204:207]
  v_mfma_f32_16x16x32_bf16 v[212:215], a[236:239], v[132:135], v[212:215]
  v_mfma_f32_16x16x32_bf16 v[184:187], a[232:235], a[96:99], v[184:187]
  v_mfma_f32_16x16x32_bf16 v[192:195], a[232:235], a[100:103], v[192:195]
  v_mfma_f32_16x16x32_bf16 v[200:203], a[232:235], a[104:107], v[200:203]
  v_mfma_f32_16x16x32_bf16 v[208:211], a[232:235], a[108:111], v[208:211]
  v_mfma_f32_16x16x32_bf16 v[188:191], a[228:231], a[96:99], v[188:191]
  v_mfma_f32_16x16x32_bf16 v[196:199], a[228:231], a[100:103], v[196:199]
  v_mfma_f32_16x16x32_bf16 v[204:207], a[228:231], a[104:107], v[204:207]
  v_mfma_f32_16x16x32_bf16 v[212:215], a[228:231], a[108:111], v[212:215]
  v_mfma_f32_16x16x32_bf16 v[184:187], a[224:227], v[136:139], v[184:187]
  v_mfma_f32_16x16x32_bf16 v[192:195], a[224:227], v[140:143], v[192:195]
  v_mfma_f32_16x16x32_bf16 v[200:203], a[224:227], v[144:147], v[200:203]
  v_mfma_f32_16x16x32_bf16 v[208:211], a[224:227], v[148:151], v[208:211]
  v_mfma_f32_16x16x32_bf16 v[188:191], a[220:223], v[136:139], v[188:191]
  v_mfma_f32_16x16x32_bf16 v[196:199], a[220:223], v[140:143], v[196:199]
  v_mfma_f32_16x16x32_bf16 v[204:207], a[220:223], v[144:147], v[204:207]
  v_mfma_f32_16x16x32_bf16 v[212:215], a[220:223], v[148:151], v[212:215]
  s_add_u32 s58, s55, 16384
  s_add_u32 s59, s56, 16384
  v_cvt_pk_bf16_f32 v32, v184, v185
  v_cvt_pk_bf16_f32 v33, v186, v187
  s_nop 0
  v_cvt_pk_bf16_f32 v34, v188, v189
  v_cvt_pk_bf16_f32 v35, v190, v191
  s_nop 0
  v_permlane16_swap_b32 v32, v34
  v_permlane16_swap_b32 v33, v35
  buffer_store_dwordx4 v[32:35], v4, s[8:11], s58 offen offset:0 sc1
  ds_write_b128 v10, v[32:35] offset:16384
  v_cvt_pk_bf16_f32 v36, v192, v193
  v_cvt_pk_bf16_f32 v37, v194, v195
  v_cvt_pk_bf16_f32 v38, v196, v197
  v_cvt_pk_bf16_f32 v39, v198, v199
  s_nop 0
  v_permlane16_swap_b32 v36, v38
  v_permlane16_swap_b32 v37, v39
  buffer_store_dwordx4 v[36:39], v5, s[8:11], s58 offen offset:256 sc1
  ds_write_b128 v10, v[36:39] offset:16640
  v_cvt_pk_bf16_f32 v32, v200, v201
  v_cvt_pk_bf16_f32 v33, v202, v203
  v_cvt_pk_bf16_f32 v34, v204, v205
  v_cvt_pk_bf16_f32 v35, v206, v207
  s_nop 0
  v_permlane16_swap_b32 v32, v34
  v_permlane16_swap_b32 v33, v35
  buffer_store_dwordx4 v[32:35], v8, s[8:11], s59 offen offset:0 sc1
  ds_write_b128 v11, v[32:35] offset:16384
  v_cvt_pk_bf16_f32 v36, v208, v209
  v_cvt_pk_bf16_f32 v37, v210, v211
  v_cvt_pk_bf16_f32 v38, v212, v213
  v_cvt_pk_bf16_f32 v39, v214, v215
  s_nop 0
  v_permlane16_swap_b32 v36, v38
  v_permlane16_swap_b32 v37, v39
  buffer_store_dwordx4 v[36:39], v9, s[8:11], s59 offen offset:256 sc1
  ds_write_b128 v11, v[36:39] offset:16640
  s_lshr_b32 s20, s17, 2
  s_lshl_b32 s21, s18, 1
  s_add_u32 s20, s20, s21
  s_and_b32 s21, s17, 3
  s_mul_i32 s22, s20, 36864
  s_lshl_b32 s23, s21, 7
  s_add_u32 s22, s22, s23
  s_add_u32 s22, s22, s63
  s_lshl_b32 s24, s20, 8
  s_lshl_b32 s25, s21, 5
  s_add_u32 s24, s24, s25
  s_add_u32 s24, s24, 9781248
  s_add_u32 s24, s24, s63
  s_lshl_b32 s25, s20, 5
  s_lshl_b32 s26, s21, 3
  s_add_u32 s25, s25, s26
  s_mul_i32 s25, s25, 1152
  s_lshl_b32 s26, s18, 9
  s_add_u32 s26, s26, 9797632
  s_add_u32 s26, s26, s63
  s_lshl_b32 s36, s16, 7
  s_add_u32 s36, s36, s26
  s_and_b32 s27, s2, 0
  s_lshl_b32 s27, s27, 14
  s_add_u32 s26, s26, s27
  v_and_b32 v4, 7, v0
  v_lshrrev_b32 v5, 3, v0
  v_lshlrev_b32 v6, 9, v5
  v_lshl_add_u32 v6, v4, 4, v6
  v_add_u32 v7, 8192, v6
  v_lshrrev_b32 v8, 2, v5
  v_lshlrev_b32 v8, 9, v8
  v_lshl_add_u32 v8, v4, 4, v8
  v_and_b32 v9, 3, v5
  v_lshl_add_u32 v8, v9, 2, v8
  v_add_u32 v8, 32768, v8
  v_lshlrev_b32 v9, 4, v5
  v_lshlrev_b32 v10, 2, v5
  v_lshlrev_b32 v11, 2, v4
  s_add_u32 s27, s22, 4718592
  s_lshr_b32 s37, s16, 1
  s_lshl_b32 s37, s37, 9
  v_add_u32 v18, s37, v9
  s_lshl_b32 s37, s37, 5
  v_add_u32 v6, s37, v6
  s_lshl_b32 s37, s18, 9
  s_add_u32 s37, s37, 9814016
  s_add_u32 s37, s37, s63
  s_mov_b32 s12, s40
  s_mov_b32 s13, s41
  s_mov_b32 s14, 1152
  s_mov_b32 s15, 0x20000
  buffer_load_dword v24, v11, s[8:11], s24 offen sc1
  buffer_load_dword v25, v11, s[8:11], s24 offen offset:128 sc1
  buffer_load_dwordx4 v[112:115], v6, s[8:11], s27 offen sc1
  buffer_load_dwordx4 v[116:119], v7, s[8:11], s27 offen sc1
  buffer_load_dword v120, v8, s[8:11], s27 offen sc1
  buffer_load_dwordx4 v[124:127], v18, s[12:15], 0 offen
  buffer_load_dwordx4 v[128:131], v9, s[12:15], 0 offen offset:256
  buffer_load_dword v132, v10, s[12:15], 0 offen offset:1024
  v_lshlrev_b32 v12, 14, v2
  v_mov_b32 v13, 1
  s_mov_b32 s49, 0x40000
  s_add_u32 s28, s22, 10485760
  s_lshr_b32 s29, s17, 2
  s_mul_i32 s29, s29, 36864
  s_add_u32 s29, s29, s23
  s_add_u32 s29, s29, 73728
  v_add_u32 v20, s29, v6
  v_add_u32 v21, s29, v7
  v_add_u32 v28, s29, v8
  s_add_u32 s29, s17, 1
  s_and_b32 s29, s29, 7
  s_mul_i32 s29, s29, 2359296
  s_add_u32 s29, s29, s28
  s_add_u32 s30, s17, 2
  s_and_b32 s30, s30, 7
  s_mul_i32 s30, s30, 2359296
  s_add_u32 s30, s30, s28
  s_add_u32 s31, s17, 3
  s_and_b32 s31, s31, 7
  s_mul_i32 s31, s31, 2359296
  s_add_u32 s31, s31, s28
  s_add_u32 s32, s17, 4
  s_and_b32 s32, s32, 7
  s_mul_i32 s32, s32, 2359296
  s_add_u32 s32, s32, s28
  s_add_u32 s33, s17, 5
  s_and_b32 s33, s33, 7
  s_mul_i32 s33, s33, 2359296
  s_add_u32 s33, s33, s28
  s_add_u32 s34, s17, 6
  s_and_b32 s34, s34, 7
  s_mul_i32 s34, s34, 2359296
  s_add_u32 s34, s34, s28
  s_add_u32 s35, s17, 7
  s_and_b32 s35, s35, 7
  s_mul_i32 s35, s35, 2359296
  s_add_u32 s35, s35, s28
  s_waitcnt lgkmcnt(0)
  v_lshlrev_b32 v22, 7, v2
  s_mov_b64 exec, 15
  buffer_load_dword v23, v22, s[8:11], s37 offen sc1
  s_mov_b64 exec, -1
  s_waitcnt vmcnt(9)
  s_mov_b64 exec, 1
  buffer_atomic_add v13, v12, s[8:11], s36 offen
  s_mov_b64 exec, -1
  v_lshlrev_b32 v12, 7, v2
  s_cmp_eq_u32 s16, 0
  s_cbranch_scc0 L_ca_go
  s_waitcnt vmcnt(1)
  s_mov_b64 exec, 15
  v_cmp_gt_u32 vcc, 8, v23
  s_nop 4
  s_cbranch_vccz L_ca_ok
  s_mov_b64 exec, 15
L_ca_poll:
  buffer_load_dword v250, v12, s[8:11], s37 offen sc1
  s_waitcnt vmcnt(0)
  v_cmp_gt_u32 vcc, 8, v250
  s_nop 4
  s_cbranch_vccz L_ca_ok
  s_sub_u32 s49, s49, 1
  s_cmp_eq_u32 s49, 0
  s_cbranch_scc0 L_ca_poll
L_ca_ok:
  s_mov_b64 exec, -1
  buffer_load_dwordx4 v[36:39], v6, s[8:11], s29 offen sc1
  buffer_load_dwordx4 v[40:43], v6, s[8:11], s30 offen sc1
  buffer_load_dwordx4 v[44:47], v6, s[8:11], s31 offen sc1
  buffer_load_dwordx4 v[48:51], v6, s[8:11], s32 offen sc1
  buffer_load_dwordx4 v[52:55], v6, s[8:11], s33 offen sc1
  buffer_load_dwordx4 v[56:59], v6, s[8:11], s34 offen sc1
  buffer_load_dwordx4 v[60:63], v6, s[8:11], s35 offen sc1
  buffer_load_dword v97, v8, s[8:11], s29 offen sc1
  buffer_load_dword v98, v8, s[8:11], s30 offen sc1
  buffer_load_dword v99, v8, s[8:11], s31 offen sc1
  buffer_load_dword v100, v8, s[8:11], s32 offen sc1
  buffer_load_dword v101, v8, s[8:11], s33 offen sc1
  buffer_load_dword v102, v8, s[8:11], s34 offen sc1
  buffer_load_dword v103, v8, s[8:11], s35 offen sc1
  s_barrier
  s_branch L_cd_w0
L_ca_go:
  s_barrier
  buffer_load_dwordx4 v[36:39], v6, s[8:11], s29 offen sc1
  buffer_load_dwordx4 v[40:43], v6, s[8:11], s30 offen sc1
  buffer_load_dwordx4 v[44:47], v6, s[8:11], s31 offen sc1
  buffer_load_dwordx4 v[48:51], v6, s[8:11], s32 offen sc1
  buffer_load_dwordx4 v[52:55], v6, s[8:11], s33 offen sc1
  buffer_load_dwordx4 v[56:59], v6, s[8:11], s34 offen sc1
  buffer_load_dwordx4 v[60:63], v6, s[8:11], s35 offen sc1
  buffer_load_dword v97, v8, s[8:11], s29 offen sc1
  buffer_load_dword v98, v8, s[8:11], s30 offen sc1
  buffer_load_dword v99, v8, s[8:11], s31 offen sc1
  buffer_load_dword v100, v8, s[8:11], s32 offen sc1
  buffer_load_dword v101, v8, s[8:11], s33 offen sc1
  buffer_load_dword v102, v8, s[8:11], s34 offen sc1
  buffer_load_dword v103, v8, s[8:11], s35 offen sc1
L_cd_w0:
  ds_read_b128 v[32:35], v20
  ds_read_b32 v96, v28
  ds_read_b128 v[64:67], v21
  s_waitcnt vmcnt(23)
  v_mul_f32 v24, 0x3ae38e39, v24
  s_waitcnt vmcnt(22)
  v_mul_f32 v25, 0x3ae38e39, v25
  v_fma_f32 v25, -v24, v24, v25
  v_max_f32 v25, 0, v25
  v_mov_b32 v26, 0x3f800054
  v_mov_b32 v27, 0x2edbe6ff
  v_fma_f32 v25, v25, v26, v27
  v_rsq_f32 v25, v25
  v_mov_b32 v14, 0x3f80
  v_mov_b32 v15, 0x3f800000
  v_mul_u32_u24 v16, 1152, v4
  v_add_u32 v17, v16, v10
  v_add_u32 v19, v16, v9
  v_add_u32 v18, v16, v18
  s_waitcnt vmcnt(21)
  v_lshlrev_b32 v160, 16, v112
  v_and_b32 v161, 0xffff0000, v112
  s_waitcnt vmcnt(18)
  v_lshlrev_b32 v112, 16, v124
  v_and_b32 v124, 0xffff0000, v124
  v_add_f32 v160, v160, v112
  v_add_f32 v161, v161, v124
  v_lshlrev_b32 v162, 16, v113
  v_and_b32 v163, 0xffff0000, v113
  v_lshlrev_b32 v113, 16, v125
  v_and_b32 v125, 0xffff0000, v125
  v_add_f32 v162, v162, v113
  v_add_f32 v163, v163, v125
  v_lshlrev_b32 v164, 16, v114
  v_and_b32 v165, 0xffff0000, v114
  v_lshlrev_b32 v114, 16, v126
  v_and_b32 v126, 0xffff0000, v126
  v_add_f32 v164, v164, v114
  v_add_f32 v165, v165, v126
  v_lshlrev_b32 v166, 16, v115
  v_and_b32 v167, 0xffff0000, v115
  v_lshlrev_b32 v115, 16, v127
  v_and_b32 v127, 0xffff0000, v127
  v_add_f32 v166, v166, v115
  v_add_f32 v167, v167, v127
  v_lshlrev_b32 v168, 16, v116
  v_and_b32 v169, 0xffff0000, v116
  s_waitcnt vmcnt(17)
  v_lshlrev_b32 v116, 16, v128
  v_and_b32 v128, 0xffff0000, v128
  v_add_f32 v168, v168, v116
  v_add_f32 v169, v169, v128
  v_lshlrev_b32 v170, 16, v117
  v_and_b32 v171, 0xffff0000, v117
  v_lshlrev_b32 v117, 16, v129
  v_and_b32 v129, 0xffff0000, v129
  v_add_f32 v170, v170, v117
  v_add_f32 v171, v171, v129
  v_lshlrev_b32 v172, 16, v118
  v_and_b32 v173, 0xffff0000, v118
  v_lshlrev_b32 v118, 16, v130
  v_and_b32 v130, 0xffff0000, v130
  v_add_f32 v172, v172, v118
  v_add_f32 v173, v173, v130
  v_lshlrev_b32 v174, 16, v119
  v_and_b32 v175, 0xffff0000, v119
  v_lshlrev_b32 v119, 16, v131
  v_and_b32 v131, 0xffff0000, v131
  v_add_f32 v174, v174, v119
  v_add_f32 v175, v175, v131
  v_lshlrev_b32 v176, 16, v120
  v_and_b32 v177, 0xffff0000, v120
  s_waitcnt vmcnt(16)
  v_lshlrev_b32 v120, 16, v132
  v_and_b32 v132, 0xffff0000, v132
  v_add_f32 v176, v176, v120
  v_add_f32 v177, v177, v132
  s_waitcnt lgkmcnt(0)
  s_cmp_eq_u32 s16, 0
  s_cbranch_scc0 L_cd_go
  s_mov_b64 exec, 15
L_cd_poll:
  buffer_load_dword v250, v12, s[8:11], s26 offen sc1
  s_waitcnt vmcnt(0)
  v_cmp_gt_u32 vcc, 8, v250
  s_nop 4
  s_cbranch_vccz L_cd_ok
  s_sub_u32 s49, s49, 1
  s_cmp_eq_u32 s49, 0
  s_cbranch_scc0 L_cd_poll
L_cd_ok:
  s_mov_b64 exec, -1
L_cd_go:
  s_barrier
  buffer_load_dwordx4 v[68:71], v7, s[8:11], s29 offen sc1
  buffer_load_dwordx4 v[72:75], v7, s[8:11], s30 offen sc1
  buffer_load_dwordx4 v[76:79], v7, s[8:11], s31 offen sc1
  buffer_load_dwordx4 v[80:83], v7, s[8:11], s32 offen sc1
  buffer_load_dwordx4 v[84:87], v7, s[8:11], s33 offen sc1
  buffer_load_dwordx4 v[88:91], v7, s[8:11], s34 offen sc1
  buffer_load_dwordx4 v[92:95], v7, s[8:11], s35 offen sc1
  v_lshlrev_b32 v136, 16, v32
  v_and_b32 v137, 0xffff0000, v32
  v_lshlrev_b32 v138, 16, v33
  v_and_b32 v139, 0xffff0000, v33
  v_lshlrev_b32 v140, 16, v34
  v_and_b32 v141, 0xffff0000, v34
  v_lshlrev_b32 v142, 16, v35
  v_and_b32 v143, 0xffff0000, v35
  s_waitcnt vmcnt(20)
  v_dot2c_f32_bf16 v136, v36, v14
  v_dot2c_f32_bf16 v137, v36, v15
  v_dot2c_f32_bf16 v138, v37, v14
  v_dot2c_f32_bf16 v139, v37, v15
  v_dot2c_f32_bf16 v140, v38, v14
  v_dot2c_f32_bf16 v141, v38, v15
  v_dot2c_f32_bf16 v142, v39, v14
  v_dot2c_f32_bf16 v143, v39, v15
  s_waitcnt vmcnt(19)
  v_dot2c_f32_bf16 v136, v40, v14
  v_dot2c_f32_bf16 v137, v40, v15
  v_dot2c_f32_bf16 v138, v41, v14
  v_dot2c_f32_bf16 v139, v41, v15
  v_dot2c_f32_bf16 v140, v42, v14
  v_dot2c_f32_bf16 v141, v42, v15
  v_dot2c_f32_bf16 v142, v43, v14
  v_dot2c_f32_bf16 v143, v43, v15
  s_waitcnt vmcnt(18)
  v_dot2c_f32_bf16 v136, v44, v14
  v_dot2c_f32_bf16 v137, v44, v15
  v_dot2c_f32_bf16 v138, v45, v14
  v_dot2c_f32_bf16 v139, v45, v15
  v_dot2c_f32_bf16 v140, v46, v14
  v_dot2c_f32_bf16 v141, v46, v15
  v_dot2c_f32_bf16 v142, v47, v14
  v_dot2c_f32_bf16 v143, v47, v15
  s_waitcnt vmcnt(17)
  v_dot2c_f32_bf16 v136, v48, v14
  v_dot2c_f32_bf16 v137, v48, v15
  v_dot2c_f32_bf16 v138, v49, v14
  v_dot2c_f32_bf16 v139, v49, v15
  v_dot2c_f32_bf16 v140, v50, v14
  v_dot2c_f32_bf16 v141, v50, v15
  v_dot2c_f32_bf16 v142, v51, v14
  v_dot2c_f32_bf16 v143, v51, v15
  s_waitcnt vmcnt(16)
  v_dot2c_f32_bf16 v136, v52, v14
  v_dot2c_f32_bf16 v137, v52, v15
  v_dot2c_f32_bf16 v138, v53, v14
  v_dot2c_f32_bf16 v139, v53, v15
  v_dot2c_f32_bf16 v140, v54, v14
  v_dot2c_f32_bf16 v141, v54, v15
  v_dot2c_f32_bf16 v142, v55, v14
  v_dot2c_f32_bf16 v143, v55, v15
  s_waitcnt vmcnt(15)
  v_dot2c_f32_bf16 v136, v56, v14
  v_dot2c_f32_bf16 v137, v56, v15
  v_dot2c_f32_bf16 v138, v57, v14
  v_dot2c_f32_bf16 v139, v57, v15
  v_dot2c_f32_bf16 v140, v58, v14
  v_dot2c_f32_bf16 v141, v58, v15
  v_dot2c_f32_bf16 v142, v59, v14
  v_dot2c_f32_bf16 v143, v59, v15
  s_waitcnt vmcnt(14)
  v_dot2c_f32_bf16 v136, v60, v14
  v_dot2c_f32_bf16 v137, v60, v15
  v_dot2c_f32_bf16 v138, v61, v14
  v_dot2c_f32_bf16 v139, v61, v15
  v_dot2c_f32_bf16 v140, v62, v14
  v_dot2c_f32_bf16 v141, v62, v15
  v_dot2c_f32_bf16 v142, v63, v14
  v_dot2c_f32_bf16 v143, v63, v15
  v_fma_f32 v136, v136, v25, v160
  v_fma_f32 v137, v137, v25, v161
  v_fma_f32 v138, v138, v25, v162
  v_fma_f32 v139, v139, v25, v163
  v_fma_f32 v140, v140, v25, v164
  v_fma_f32 v141, v141, v25, v165
  v_fma_f32 v142, v142, v25, v166
  v_fma_f32 v143, v143, v25, v167
  v_cvt_pk_bf16_f32 v32, v136, v137
  v_cvt_pk_bf16_f32 v33, v138, v139
  v_cvt_pk_bf16_f32 v34, v140, v141
  v_cvt_pk_bf16_f32 v35, v142, v143
  v_lshlrev_b32 v152, 16, v96
  v_and_b32 v153, 0xffff0000, v96
  s_waitcnt vmcnt(13)
  v_dot2c_f32_bf16 v152, v97, v14
  v_dot2c_f32_bf16 v153, v97, v15
  s_waitcnt vmcnt(12)
  v_dot2c_f32_bf16 v152, v98, v14
  v_dot2c_f32_bf16 v153, v98, v15
  s_waitcnt vmcnt(11)
  v_dot2c_f32_bf16 v152, v99, v14
  v_dot2c_f32_bf16 v153, v99, v15
  s_waitcnt vmcnt(10)
  v_dot2c_f32_bf16 v152, v100, v14
  v_dot2c_f32_bf16 v153, v100, v15
  s_waitcnt vmcnt(9)
  v_dot2c_f32_bf16 v152, v101, v14
  v_dot2c_f32_bf16 v153, v101, v15
  s_waitcnt vmcnt(8)
  v_dot2c_f32_bf16 v152, v102, v14
  v_dot2c_f32_bf16 v153, v102, v15
  s_waitcnt vmcnt(7)
  v_dot2c_f32_bf16 v152, v103, v14
  v_dot2c_f32_bf16 v153, v103, v15
  s_nop 1
  v_fma_f32 v152, v152, v25, v176
  v_fma_f32 v153, v153, v25, v177
  v_cvt_pk_bf16_f32 v96, v152, v153
  v_lshlrev_b32 v144, 16, v64
  v_and_b32 v145, 0xffff0000, v64
  v_lshlrev_b32 v146, 16, v65
  v_and_b32 v147, 0xffff0000, v65
  v_lshlrev_b32 v148, 16, v66
  v_and_b32 v149, 0xffff0000, v66
  v_lshlrev_b32 v150, 16, v67
  v_and_b32 v151, 0xffff0000, v67
  s_waitcnt vmcnt(6)
  v_dot2c_f32_bf16 v144, v68, v14
  v_dot2c_f32_bf16 v145, v68, v15
  v_dot2c_f32_bf16 v146, v69, v14
  v_dot2c_f32_bf16 v147, v69, v15
  v_dot2c_f32_bf16 v148, v70, v14
  v_dot2c_f32_bf16 v149, v70, v15
  v_dot2c_f32_bf16 v150, v71, v14
  v_dot2c_f32_bf16 v151, v71, v15
  s_waitcnt vmcnt(5)
  v_dot2c_f32_bf16 v144, v72, v14
  v_dot2c_f32_bf16 v145, v72, v15
  v_dot2c_f32_bf16 v146, v73, v14
  v_dot2c_f32_bf16 v147, v73, v15
  v_dot2c_f32_bf16 v148, v74, v14
  v_dot2c_f32_bf16 v149, v74, v15
  v_dot2c_f32_bf16 v150, v75, v14
  v_dot2c_f32_bf16 v151, v75, v15
  s_waitcnt vmcnt(4)
  v_dot2c_f32_bf16 v144, v76, v14
  v_dot2c_f32_bf16 v145, v76, v15
  v_dot2c_f32_bf16 v146, v77, v14
  v_dot2c_f32_bf16 v147, v77, v15
  v_dot2c_f32_bf16 v148, v78, v14
  v_dot2c_f32_bf16 v149, v78, v15
  v_dot2c_f32_bf16 v150, v79, v14
  v_dot2c_f32_bf16 v151, v79, v15
  s_waitcnt vmcnt(3)
  v_dot2c_f32_bf16 v144, v80, v14
  v_dot2c_f32_bf16 v145, v80, v15
  v_dot2c_f32_bf16 v146, v81, v14
  v_dot2c_f32_bf16 v147, v81, v15
  v_dot2c_f32_bf16 v148, v82, v14
  v_dot2c_f32_bf16 v149, v82, v15
  v_dot2c_f32_bf16 v150, v83, v14
  v_dot2c_f32_bf16 v151, v83, v15
  s_waitcnt vmcnt(2)
  v_dot2c_f32_bf16 v144, v84, v14
  v_dot2c_f32_bf16 v145, v84, v15
  v_dot2c_f32_bf16 v146, v85, v14
  v_dot2c_f32_bf16 v147, v85, v15
  v_dot2c_f32_bf16 v148, v86, v14
  v_dot2c_f32_bf16 v149, v86, v15
  v_dot2c_f32_bf16 v150, v87, v14
  v_dot2c_f32_bf16 v151, v87, v15
  s_waitcnt vmcnt(1)
  v_dot2c_f32_bf16 v144, v88, v14
  v_dot2c_f32_bf16 v145, v88, v15
  v_dot2c_f32_bf16 v146, v89, v14
  v_dot2c_f32_bf16 v147, v89, v15
  v_dot2c_f32_bf16 v148, v90, v14
  v_dot2c_f32_bf16 v149, v90, v15
  v_dot2c_f32_bf16 v150, v91, v14
  v_dot2c_f32_bf16 v151, v91, v15
  s_waitcnt vmcnt(0)
  v_dot2c_f32_bf16 v144, v92, v14
  v_dot2c_f32_bf16 v145, v92, v15
  v_dot2c_f32_bf16 v146, v93, v14
  v_dot2c_f32_bf16 v147, v93, v15
  v_dot2c_f32_bf16 v148, v94, v14
  v_dot2c_f32_bf16 v149, v94, v15
  v_dot2c_f32_bf16 v150, v95, v14
  v_dot2c_f32_bf16 v151, v95, v15
  v_fma_f32 v144, v144, v25, v168
  v_fma_f32 v145, v145, v25, v169
  v_fma_f32 v146, v146, v25, v170
  v_fma_f32 v147, v147, v25, v171
  v_fma_f32 v148, v148, v25, v172
  v_fma_f32 v149, v149, v25, v173
  v_fma_f32 v150, v150, v25, v174
  v_fma_f32 v151, v151, v25, v175
  v_cvt_pk_bf16_f32 v64, v144, v145
  v_cvt_pk_bf16_f32 v65, v146, v147
  v_cvt_pk_bf16_f32 v66, v148, v149
  v_cvt_pk_bf16_f32 v67, v150, v151
  s_cmp_eq_u32 s63, 0
  s_cbranch_scc1 L_cd_mid
  s_mov_b32 s12, s42
  s_mov_b32 s13, s43
  s_mov_b32 s14, 2359296
  s_mov_b32 s15, 0x20000
  buffer_store_dwordx4 v[32:35], v18, s[12:15], s25 offen
  buffer_store_dwordx4 v[64:67], v19, s[12:15], s25 offen offset:256
  buffer_store_dword v96, v17, s[12:15], s25 offen offset:1024
  s_mov_b32 s36, s6
  s_mov_b32 s37, s7
  s_mov_b32 s38, 256
  s_mov_b32 s39, 0x20000
  s_or_b32 s60, s2, s16
  s_cmp_eq_u32 s60, 0
  s_cbranch_scc0 L_d_nt
  v_mov_b32 v20, 0
  s_mov_b64 exec, 1
  buffer_store_dword v20, v20, s[36:39], 0 offen
  s_mov_b64 exec, -1
L_d_nt:
  s_endpgm
L_cd_mid:
  s_add_u32 s27, s22, 35913728
  s_add_u32 s28, s22, 33554432
  v_lshlrev_b32 v136, 16, v32
  v_and_b32 v137, 0xffff0000, v32
  v_lshlrev_b32 v138, 16, v33
  v_and_b32 v139, 0xffff0000, v33
  v_lshlrev_b32 v140, 16, v34
  v_and_b32 v141, 0xffff0000, v34
  v_lshlrev_b32 v142, 16, v35
  v_and_b32 v143, 0xffff0000, v35
  v_lshlrev_b32 v144, 16, v64
  v_and_b32 v145, 0xffff0000, v64
  v_lshlrev_b32 v146, 16, v65
  v_and_b32 v147, 0xffff0000, v65
  v_lshlrev_b32 v148, 16, v66
  v_and_b32 v149, 0xffff0000, v66
  v_lshlrev_b32 v150, 16, v67
  v_and_b32 v151, 0xffff0000, v67
  v_lshlrev_b32 v152, 16, v96
  v_and_b32 v153, 0xffff0000, v96
  v_add_f32 v24, v136, v137
  v_add_f32 v26, v138, v139
  v_mul_f32 v25, v136, v136
  v_mul_f32 v27, v137, v137
  v_add_f32 v24, v24, v140
  v_add_f32 v26, v26, v141
  v_add_f32 v24, v24, v142
  v_add_f32 v26, v26, v143
  v_add_f32 v24, v24, v144
  v_add_f32 v26, v26, v145
  v_add_f32 v24, v24, v146
  v_add_f32 v26, v26, v147
  v_add_f32 v24, v24, v148
  v_add_f32 v26, v26, v149
  v_add_f32 v24, v24, v150
  v_add_f32 v26, v26, v151
  v_add_f32 v24, v24, v152
  v_add_f32 v26, v26, v153
  v_fmac_f32 v25, v138, v138
  v_fmac_f32 v27, v139, v139
  v_fmac_f32 v25, v140, v140
  v_fmac_f32 v27, v141, v141
  v_fmac_f32 v25, v142, v142
  v_fmac_f32 v27, v143, v143
  v_fmac_f32 v25, v144, v144
  v_fmac_f32 v27, v145, v145
  v_fmac_f32 v25, v146, v146
  v_fmac_f32 v27, v147, v147
  v_fmac_f32 v25, v148, v148
  v_fmac_f32 v27, v149, v149
  v_fmac_f32 v25, v150, v150
  v_fmac_f32 v27, v151, v151
  v_fmac_f32 v25, v152, v152
  v_fmac_f32 v27, v153, v153
  v_add_f32 v24, v24, v26
  v_add_f32 v25, v25, v27
  s_nop 1
  v_permlane32_swap_b32 v24, v25
  v_add_f32 v24, v24, v25
  v_mov_b32 v25, v24
  s_nop 1
  v_permlane16_swap_b32 v24, v25
  v_add_f32 v24, v24, v25
  s_nop 1
  v_add_f32 v24, v24, v24 row_ror:8
  v_bfe_u32 v27, v0, 5, 1
  v_lshl_add_u32 v27, v4, 1, v27
  v_lshlrev_b32 v27, 4, v27
  s_lshl_b32 s29, s16, 2
  s_add_u32 s29, s29, 131072
  v_add_u32 v27, s29, v27
  v_and_b32 v28, 24, v0
  v_cmp_eq_u32 vcc, 0, v28
  s_nop 0
  s_and_saveexec_b64 s[30:31], vcc
  ds_write_b32 v27, v24
  s_mov_b64 exec, -1
  v_lshlrev_b32 v27, 5, v4
  v_add_u32 v27, 131072, v27
  s_lshr_b32 s29, s18, 2
  s_lshl_b32 s29, s29, 4
  s_and_b32 s36, s18, 3
  s_add_u32 s29, s29, s36
  s_lshl_b32 s29, s29, 7
  s_add_u32 s29, s29, 43384832
  s_waitcnt lgkmcnt(0)
  s_barrier
  ds_read_b128 v[20:23], v27
  ds_read_b128 v[28:31], v27 offset:16
  s_waitcnt lgkmcnt(1)
  v_add_f32 v20, v20, v21
  v_add_f32 v22, v22, v23
  s_waitcnt lgkmcnt(0)
  v_add_f32 v28, v28, v29
  v_add_f32 v30, v30, v31
  v_add_f32 v20, v20, v22
  v_add_f32 v28, v28, v30
  v_mul_f32 v20, 0x3ae38e39, v20
  v_mul_f32 v28, 0x3ae38e39, v28
  v_fma_f32 v28, -v20, v20, v28
  v_max_f32 v28, 0, v28
  v_add_f32 v28, 0x3727c5ac, v28
  v_rsq_f32 v28, v28
  v_sub_f32 v136, v136, v20
  v_sub_f32 v137, v137, v20
  v_sub_f32 v138, v138, v20
  v_sub_f32 v139, v139, v20
  v_sub_f32 v140, v140, v20
  v_sub_f32 v141, v141, v20
  v_sub_f32 v142, v142, v20
  v_sub_f32 v143, v143, v20
  v_sub_f32 v144, v144, v20
  v_sub_f32 v145, v145, v20
  v_sub_f32 v146, v146, v20
  v_sub_f32 v147, v147, v20
  v_sub_f32 v148, v148, v20
  v_sub_f32 v149, v149, v20
  v_sub_f32 v150, v150, v20
  v_sub_f32 v151, v151, v20
  v_sub_f32 v152, v152, v20
  v_sub_f32 v153, v153, v20
  v_mul_f32 v136, v136, v28
  v_mul_f32 v137, v137, v28
  v_mul_f32 v138, v138, v28
  v_mul_f32 v139, v139, v28
  v_mul_f32 v140, v140, v28
  v_mul_f32 v141, v141, v28
  v_mul_f32 v142, v142, v28
  v_mul_f32 v143, v143, v28
  v_mul_f32 v144, v144, v28
  v_mul_f32 v145, v145, v28
  v_mul_f32 v146, v146, v28
  v_mul_f32 v147, v147, v28
  v_mul_f32 v148, v148, v28
  v_mul_f32 v149, v149, v28
  v_mul_f32 v150, v150, v28
  v_mul_f32 v151, v151, v28
  v_mul_f32 v152, v152, v28
  v_mul_f32 v153, v153, v28
  v_cvt_pk_bf16_f32 v160, v136, v137
  v_cvt_pk_bf16_f32 v161, v138, v139
  v_cvt_pk_bf16_f32 v162, v140, v141
  v_cvt_pk_bf16_f32 v163, v142, v143
  v_cvt_pk_bf16_f32 v164, v144, v145
  v_cvt_pk_bf16_f32 v165, v146, v147
  v_cvt_pk_bf16_f32 v166, v148, v149
  v_cvt_pk_bf16_f32 v167, v150, v151
  v_cvt_pk_bf16_f32 v168, v152, v153
  buffer_store_dwordx4 v[160:163], v6, s[8:11], s28 offen sc1
  buffer_store_dwordx4 v[164:167], v7, s[8:11], s28 offen sc1
  buffer_store_dword v168, v8, s[8:11], s28 offen sc1
  v_lshlrev_b32 v12, 9, v2
  s_waitcnt vmcnt(0)
  s_barrier
  s_cmp_eq_u32 s16, 0
  s_cbranch_scc0 L_da_ns
  s_mov_b64 exec, 15
  buffer_atomic_add v13, v12, s[8:11], s29 offen
  s_mov_b64 exec, -1
L_da_ns:
  buffer_store_dwordx4 v[32:35], v6, s[8:11], s27 offen sc1
  buffer_store_dwordx4 v[64:67], v7, s[8:11], s27 offen sc1
  buffer_store_dword v96, v8, s[8:11], s27 offen sc1
  s_mov_b32 s12, s4
  s_mov_b32 s13, s5
  s_mov_b32 s14, 268435456
  s_mov_b32 s15, 0x20000
  s_mov_b32 s63, 33554432
  s_branch L_a1
L_f3_w:
  s_mov_b32 s49, 0x40000
L_f3_l:
  s_nop 15
  s_nop 15
  s_nop 15
  s_nop 15
  s_nop 15
  s_nop 15
  s_nop 15
  s_nop 15
  buffer_load_dwordx4 v[248:251], v3, s[8:11], s60 offen sc1
  s_waitcnt vmcnt(0)
  v_xor_b32 v248, s3, v248
  v_xor_b32 v249, s3, v249
  v_xor_b32 v250, s3, v250
  v_xor_b32 v251, s3, v251
  v_or3_b32 v248, v248, v249, v250
  v_or_b32 v248, v248, v251
  v_cmp_ne_u32 vcc, 0, v248
  s_sub_u32 s49, s49, 1
  s_cmp_eq_u32 s49, 0
  s_cbranch_scc1 L_f3_k
  s_nop 2
  s_cbranch_vccnz L_f3_l
  s_branch L_f3_k
L_f4_w:
  s_mov_b32 s49, 0x40000
L_f4_l:
  s_nop 15
  s_nop 15
  s_nop 15
  s_nop 15
  s_nop 15
  s_nop 15
  s_nop 15
  s_nop 15
  buffer_load_dwordx4 v[248:251], v3, s[8:11], s60 offen sc1
  s_waitcnt vmcnt(0)
  v_xor_b32 v248, s3, v248
  v_xor_b32 v249, s3, v249
  v_xor_b32 v250, s3, v250
  v_xor_b32 v251, s3, v251
  v_or3_b32 v248, v248, v249, v250
  v_or_b32 v248, v248, v251
  v_cmp_ne_u32 vcc, 0, v248
  s_sub_u32 s49, s49, 1
  s_cmp_eq_u32 s49, 0
  s_cbranch_scc1 L_f4_k
  s_nop 2
  s_cbranch_vccnz L_f4_l
  s_branch L_f4_k
  s_endpgm
L_kend:
.section .rodata,"a"
.p2align 6
.amdhsa_kernel interleave_layers__linear_attn_block__mixer_channel_mlp__prompt_kernel
  .amdhsa_next_free_vgpr 512
  .amdhsa_next_free_sgpr 102
  .amdhsa_accum_offset 256
  .amdhsa_group_segment_fixed_size 0
  .amdhsa_kernarg_size 88
  .amdhsa_user_sgpr_count 2
  .amdhsa_user_sgpr_kernarg_segment_ptr 1
  .amdhsa_system_sgpr_workgroup_id_x 1
.end_amdhsa_kernel
```
